```python
import torch

def _softmax(x, axis=-1):
    return torch.softmax(x, dim=axis)

def _gelu(x):
    return torch.nn.functional.gelu(x, approximate='tanh')

def _silu(x):
    return torch.nn.functional.silu(x)

def _sigmoid(x):
    return torch.sigmoid(x)

def _layernorm(x, axis=-1, eps=1e-05):
    m = x.mean(dim=axis, keepdim=True)
    v = x.var(dim=axis, keepdim=True, unbiased=False)
    return (x - m) / torch.sqrt(v + eps)

def _scatter_add(tgt, idx, src, axis=0):
    return tgt.clone().index_add_(axis, idx, src)

def _segment_sum(src, seg, n):
    out = torch.zeros((n,) + src.shape[1:], dtype=src.dtype)
    return out.index_add_(0, seg, src)

def _pad(x, pw):
    flat = tuple((v for pair in reversed(pw) for v in pair))
    return torch.nn.functional.pad(x, flat)
kernel_name = 'adaLN_cond__spectral_gfnet__glu_gated_bilinear__prompt'

def setup_inputs():

    _w = lambda a: (lambda t: t.to(torch.bfloat16) if t.is_floating_point() else t)(torch.as_tensor(a))

    def _A_setup():
        B, S, D = (1, 2048, 512)
        Df = D // 2 + 1
        return {'x': _w((lambda *s: torch.randn(*s, dtype=torch.bfloat16) * 0.05)(B, S, D)), 'w_r': _w((lambda *s: torch.randn(*s, dtype=torch.bfloat16) * 1.6)(S, Df) * 0.02), 'w_i': _w((lambda *s: torch.randn(*s, dtype=torch.bfloat16) * 1.6)(S, Df) * 0.02)}
    _A_in = _A_setup()

    def _B_setup():
        B, S, D, F = (1, 2048, 512, 1792)
        return {'x': _w((lambda *s: torch.randn(*s, dtype=torch.bfloat16) * 0.05)(B, S, D)), 'w_gate': _w((lambda *s: torch.randn(*s, dtype=torch.bfloat16) * 0.4)(D, F) * D ** (-0.5)), 'w_up': _w((lambda *s: torch.randn(*s, dtype=torch.bfloat16) * 0.4)(D, F) * D ** (-0.5)), 'w_down': _w((lambda *s: torch.randn(*s, dtype=torch.bfloat16) * 0.4)(F, D) * F ** (-0.5))}
    _B_in = _B_setup()
    return {'A_x': _A_in['x'], 'A_w_r': _A_in['w_r'], 'A_w_i': _A_in['w_i'], 'B_x': _B_in['x'], 'B_w_gate': _B_in['w_gate'], 'B_w_up': _B_in['w_up'], 'B_w_down': _B_in['w_down'], 'c': _w((lambda *s: torch.randn(*s, dtype=torch.bfloat16) * 0.2)(1, 512) * 8.0), 'w_mod': _w((lambda *s: torch.randn(*s, dtype=torch.bfloat16) * 0.2)(512, 6 * 512) * 512 ** (-0.5) * 8.0)}

def reference(A_x, A_w_r, A_w_i, B_x, B_w_gate, B_w_up, B_w_down, c, w_mod):

    def _A_ref(x, w_r, w_i):
        B, S, D = x.shape
        X = (lambda x, axes=(-2, -1): torch.fft.rfft2(x.float(), dim=axes))(x, axes=(-2, -1))
        W = w_r + 1j * w_i
        X = X * W
        y = (lambda x, s, axes=(-2, -1): torch.fft.irfft2(x, s=s, dim=axes).to(torch.bfloat16))(X, (S, D), axes=(-2, -1))
        return y

    def _B_ref(x, w_gate, w_up, w_down):
        g = torch.einsum('bsd,df->bsf', x, w_gate)
        u = torch.einsum('bsd,df->bsf', x, w_up)
        h = g * u
        return torch.einsum('bsf,fd->bsd', h, w_down)
    x = A_x
    mod = (_silu(c) @ w_mod).reshape(c.shape[0], 6, 1, -1)
    sa, ca, ga, sb, cb, gb = (mod[:, 0].clone(), mod[:, 1].clone(), mod[:, 2].clone(), mod[:, 3].clone(), mod[:, 4].clone(), mod[:, 5].clone())
    h = _layernorm(x, axis=-1) * (1 + ca) + sa
    x = x + ga * _A_ref(h, A_w_r, A_w_i)
    h = _layernorm(x, axis=-1) * (1 + cb) + sb
    x = x + gb * _B_ref(h, B_w_gate, B_w_up, B_w_down)
    return x
```

```asm
; @launch grid=(256,1,1) block=(512,1,1) lds=163840
.amdgcn_target "amdgcn-amd-amdhsa--gfx950"

.text
.globl adaLN_cond__spectral_gfnet__glu_gated_bilinear__prompt_kernel
.p2align 8
.type adaLN_cond__spectral_gfnet__glu_gated_bilinear__prompt_kernel,@function
adaLN_cond__spectral_gfnet__glu_gated_bilinear__prompt_kernel:
    s_cmp_ge_u32 s2, 256
    s_cbranch_scc1 L_end
    s_load_dwordx2 s[4:5], s[0:1], 0
    s_load_dwordx2 s[6:7], s[0:1], 88
    s_load_dwordx2 s[64:65], s[0:1], 56
    s_load_dwordx2 s[66:67], s[0:1], 64
    s_load_dwordx2 s[8:9], s[0:1], 72
    s_load_dwordx2 s[48:49], s[0:1], 8
    s_load_dwordx2 s[52:53], s[0:1], 16
    s_load_dwordx2 s[44:45], s[0:1], 48
    s_load_dwordx2 s[56:57], s[0:1], 32
    s_load_dwordx2 s[60:61], s[0:1], 40
    v_and_b32 v1, 63, v0
    v_lshrrev_b32 v2, 6, v0
    v_lshlrev_b32 v3, 4, v1
    v_readfirstlane_b32 s10, v2
    s_and_b32 s11, s2, 31
    s_lshr_b32 s12, s2, 5
    s_mov_b32 s96, 60000
    s_and_b32 s13, s2, 7
    s_lshr_b32 s14, s2, 3
    s_lshl_b32 s34, s13, 5
    s_add_u32 s34, s34, s14
    s_lshl_b32 s38, s13, 2
    s_and_b32 s15, s14, 3
    s_add_u32 s38, s38, s15
    s_lshr_b32 s39, s14, 2
    s_sub_u32 s14, s14, 4
    s_lshr_b32 s36, s13, 1
    s_lshl_b32 s36, s36, 2
    s_and_b32 s15, s14, 3
    s_add_u32 s36, s36, s15
    s_and_b32 s37, s13, 1
    s_mul_i32 s37, s37, 7
    s_lshr_b32 s15, s14, 2
    s_add_u32 s37, s37, s15
    s_lshl_b32 s13, s12, 3
    s_add_u32 s13, s13, s10
    s_lshl_b32 s13, s13, 5
    s_add_u32 s13, s13, s11
    s_lshl_b32 s13, s13, 10
    v_add_u32 v4, s13, v3
    v_lshlrev_b32 v6, 4, v0
    s_mul_i32 s16, s2, 4112
    v_min_u32 v7, 256, v0
    v_lshlrev_b32 v7, 4, v7
    v_add_u32 v7, s16, v7
    s_mov_b32 s50, 1052672
    s_mov_b32 s51, 0x20000
    s_mov_b32 s54, 1052672
    s_mov_b32 s55, 0x20000
    v_mov_b32 v108, -1
    v_mov_b32 v109, -1
    v_mov_b32 v110, -1
    v_mov_b32 v111, -1
    s_cmp_ge_u32 s2, 32
    s_cbranch_scc1 L_adaLN_cond__spectral_gfnet__glu_gated_bilinear__prompt_kernel_clsW_1
    s_waitcnt lgkmcnt(0)
    s_load_dword s3, s[6:7], 16384
    global_load_dwordx4 v[8:11], v4, s[4:5]
    buffer_load_dwordx4 v[144:147], v7, s[48:51], 0 offen
    buffer_load_dwordx4 v[148:151], v7, s[52:55], 0 offen
    v_lshrrev_b32 v112, 2, v0
    v_mul_u32_u24 v113, 6144, v112
    v_and_b32 v114, 3, v0
    v_lshlrev_b32 v114, 4, v114
    v_add_u32 v113, v113, v114
    v_lshlrev_b32 v112, 1, v112
    s_mov_b32 s16, s2
    s_lshl_b32 s16, s16, 6
    v_add_u32 v114, s16, v113
    global_load_ushort v92, v112, s[64:65] offset:0
    global_load_ushort v93, v112, s[64:65] offset:256
    global_load_ushort v94, v112, s[64:65] offset:512
    global_load_ushort v95, v112, s[64:65] offset:768
    s_add_u32 s18, s66, 0
    s_addc_u32 s19, s67, 0
    global_load_dwordx4 v[128:131], v114, s[18:19]
    s_add_u32 s18, s66, 786432
    s_addc_u32 s19, s67, 0
    global_load_dwordx4 v[132:135], v114, s[18:19]
    s_add_u32 s18, s66, 1572864
    s_addc_u32 s19, s67, 0
    global_load_dwordx4 v[136:139], v114, s[18:19]
    s_add_u32 s18, s66, 2359296
    s_addc_u32 s19, s67, 0
    global_load_dwordx4 v[140:143], v114, s[18:19]
    v_and_b32 v112, 15, v1
    v_lshrrev_b32 v113, 4, v1
    s_mov_b32 s14, 0x8000
    v_cvt_f32_u32 v115, v1
    v_mul_f32 v115, 0x3c800000, v115
    v_cos_f32 v116, v115
    v_sin_f32 v115, v115
    s_nop 0
    v_cvt_pk_bf16_f32 v114, v116, v115
    v_lshlrev_b32 v116, 3, v112
    v_lshlrev_b32 v117, 2, v113
    v_mul_u32_u24 v117, v117, v116
    v_mad_u32_u24 v120, v116, 0, v117
    v_mad_u32_u24 v121, v116, 1, v117
    v_mad_u32_u24 v122, v116, 2, v117
    v_mad_u32_u24 v123, v116, 3, v117
    v_mad_u32_u24 v124, v116, 16, v117
    v_mad_u32_u24 v125, v116, 17, v117
    v_mad_u32_u24 v126, v116, 18, v117
    v_mad_u32_u24 v127, v116, 19, v117
    ds_bpermute_b32 v56, v120, v114
    ds_bpermute_b32 v57, v121, v114
    ds_bpermute_b32 v58, v122, v114
    ds_bpermute_b32 v59, v123, v114
    ds_bpermute_b32 v64, v124, v114
    ds_bpermute_b32 v65, v125, v114
    ds_bpermute_b32 v66, v126, v114
    ds_bpermute_b32 v67, v127, v114
    v_mad_u32_u24 v96, v116, 0, v117
    v_lshlrev_b32 v96, 1, v96
    v_mad_u32_u24 v97, v116, 1, v117
    v_lshlrev_b32 v97, 1, v97
    v_mad_u32_u24 v98, v116, 2, v117
    v_lshlrev_b32 v98, 1, v98
    v_mad_u32_u24 v99, v116, 3, v117
    v_lshlrev_b32 v99, 1, v99
    ds_bpermute_b32 v100, v96, v114
    ds_bpermute_b32 v101, v97, v114
    ds_bpermute_b32 v102, v98, v114
    ds_bpermute_b32 v103, v99, v114
    v_cvt_f32_u32 v118, v112
    v_mul_f32 v118, 0x3b000000, v118
    v_lshlrev_b32 v119, 2, v113
    v_cvt_f32_u32 v119, v119
    v_mul_f32 v119, v119, v118
    s_mov_b32 s16, 0x0
    v_fma_f32 v44, v118, s16, v119
    s_mov_b32 s16, 0x3f800000
    v_fma_f32 v45, v118, s16, v119
    s_mov_b32 s16, 0x40000000
    v_fma_f32 v46, v118, s16, v119
    s_mov_b32 s16, 0x40400000
    v_fma_f32 v47, v118, s16, v119
    s_mov_b32 s16, 0x41800000
    v_fma_f32 v52, v118, s16, v119
    s_mov_b32 s16, 0x41880000
    v_fma_f32 v53, v118, s16, v119
    s_mov_b32 s16, 0x41900000
    v_fma_f32 v54, v118, s16, v119
    s_mov_b32 s16, 0x41980000
    v_fma_f32 v55, v118, s16, v119
    v_cos_f32 v40, v44
    v_cos_f32 v41, v45
    v_cos_f32 v42, v46
    v_cos_f32 v43, v47
    v_cos_f32 v48, v52
    v_cos_f32 v49, v53
    v_cos_f32 v50, v54
    v_cos_f32 v51, v55
    v_sin_f32 v44, v44
    v_sin_f32 v45, v45
    v_sin_f32 v46, v46
    v_sin_f32 v47, v47
    v_sin_f32 v52, v52
    v_sin_f32 v53, v53
    v_sin_f32 v54, v54
    v_sin_f32 v55, v55
    s_waitcnt lgkmcnt(0)
    v_alignbit_b32 v60, v56, v56, 16
    v_alignbit_b32 v61, v57, v57, 16
    v_alignbit_b32 v62, v58, v58, 16
    v_alignbit_b32 v63, v59, v59, 16
    v_xor_b32 v60, s14, v60
    v_xor_b32 v61, s14, v61
    v_xor_b32 v62, s14, v62
    v_xor_b32 v63, s14, v63
    v_alignbit_b32 v68, v64, v64, 16
    v_alignbit_b32 v69, v65, v65, 16
    v_alignbit_b32 v70, v66, v66, 16
    v_alignbit_b32 v71, v67, v67, 16
    v_xor_b32 v68, s14, v68
    v_xor_b32 v69, s14, v69
    v_xor_b32 v70, s14, v70
    v_xor_b32 v71, s14, v71
    s_mov_b32 s16, 0x05040100
    s_mov_b32 s17, 0x07060302
    s_mov_b32 s18, 0x80008000
    v_perm_b32 v72, v101, v100, s16
    v_perm_b32 v74, v101, v100, s17
    v_perm_b32 v73, v103, v102, s16
    v_perm_b32 v75, v103, v102, s17
    v_xor_b32 v74, s18, v74
    v_xor_b32 v75, s18, v75
    s_waitcnt lgkmcnt(0)
    s_add_u32 s3, s3, 1
    s_waitcnt vmcnt(10)
    v_lshlrev_b32 v12, 16, v8
    v_and_b32 v13, 0xffff0000, v8
    v_lshlrev_b32 v14, 16, v9
    v_and_b32 v15, 0xffff0000, v9
    v_lshlrev_b32 v16, 16, v10
    v_and_b32 v17, 0xffff0000, v10
    v_lshlrev_b32 v18, 16, v11
    v_and_b32 v19, 0xffff0000, v11
    v_readfirstlane_b32 s14, v12
    s_nop 1
    v_pk_add_f32 v[12:13], v[12:13], s[14:15] op_sel_hi:[1,0] neg_lo:[0,1] neg_hi:[0,1]
    v_pk_add_f32 v[14:15], v[14:15], s[14:15] op_sel_hi:[1,0] neg_lo:[0,1] neg_hi:[0,1]
    v_pk_add_f32 v[16:17], v[16:17], s[14:15] op_sel_hi:[1,0] neg_lo:[0,1] neg_hi:[0,1]
    v_pk_add_f32 v[18:19], v[18:19], s[14:15] op_sel_hi:[1,0] neg_lo:[0,1] neg_hi:[0,1]
    v_pk_add_f32 v[20:21], v[12:13], v[14:15]
    v_pk_mul_f32 v[22:23], v[12:13], v[12:13]
    v_pk_add_f32 v[24:25], v[16:17], v[18:19]
    v_pk_fma_f32 v[22:23], v[14:15], v[14:15], v[22:23]
    v_pk_add_f32 v[20:21], v[20:21], v[24:25]
    v_pk_fma_f32 v[22:23], v[16:17], v[16:17], v[22:23]
    v_add_f32 v20, v20, v21
    v_pk_fma_f32 v[22:23], v[18:19], v[18:19], v[22:23]
    v_add_f32 v22, v22, v23
    v_add_f32_dpp v20, v20, v20 row_shr:1 row_mask:0xf bank_mask:0xf bound_ctrl:0
    s_nop 0
    v_add_f32_dpp v22, v22, v22 row_shr:1 row_mask:0xf bank_mask:0xf bound_ctrl:0
    v_add_f32_dpp v20, v20, v20 row_shr:2 row_mask:0xf bank_mask:0xf bound_ctrl:0
    s_nop 0
    v_add_f32_dpp v22, v22, v22 row_shr:2 row_mask:0xf bank_mask:0xf bound_ctrl:0
    v_add_f32_dpp v20, v20, v20 row_shr:4 row_mask:0xf bank_mask:0xf bound_ctrl:0
    s_nop 0
    v_add_f32_dpp v22, v22, v22 row_shr:4 row_mask:0xf bank_mask:0xf bound_ctrl:0
    v_add_f32_dpp v20, v20, v20 row_shr:8 row_mask:0xf bank_mask:0xf bound_ctrl:0
    s_nop 0
    v_add_f32_dpp v22, v22, v22 row_shr:8 row_mask:0xf bank_mask:0xf bound_ctrl:0
    v_add_f32_dpp v20, v20, v20 row_bcast:15 row_mask:0xa bank_mask:0xf
    s_nop 0
    v_add_f32_dpp v22, v22, v22 row_bcast:15 row_mask:0xa bank_mask:0xf
    v_add_f32_dpp v20, v20, v20 row_bcast:31 row_mask:0xc bank_mask:0xf
    s_nop 0
    v_add_f32_dpp v22, v22, v22 row_bcast:31 row_mask:0xc bank_mask:0xf
    v_mul_f32 v20, 0x3b000000, v20
    v_mul_f32 v22, 0x3b000000, v22
    v_fma_f32 v22, -v20, v20, v22
    v_add_f32 v22, 0x3727c5ac, v22
    v_rsq_f32 v22, v22
    v_readlane_b32 s14, v20, 63
    v_readlane_b32 s16, v22, 63
    s_nop 0
    v_pk_add_f32 v[12:13], v[12:13], s[14:15] op_sel_hi:[1,0] neg_lo:[0,1] neg_hi:[0,1]
    v_pk_add_f32 v[14:15], v[14:15], s[14:15] op_sel_hi:[1,0] neg_lo:[0,1] neg_hi:[0,1]
    v_pk_add_f32 v[16:17], v[16:17], s[14:15] op_sel_hi:[1,0] neg_lo:[0,1] neg_hi:[0,1]
    v_pk_add_f32 v[18:19], v[18:19], s[14:15] op_sel_hi:[1,0] neg_lo:[0,1] neg_hi:[0,1]
    v_pk_mul_f32 v[12:13], v[12:13], s[16:17] op_sel_hi:[1,0]
    v_pk_mul_f32 v[14:15], v[14:15], s[16:17] op_sel_hi:[1,0]
    v_pk_mul_f32 v[16:17], v[16:17], s[16:17] op_sel_hi:[1,0]
    v_pk_mul_f32 v[18:19], v[18:19], s[16:17] op_sel_hi:[1,0]
    v_add_u32 v113, 32768, v6
    ds_write_b128 v113, v[8:11]
    s_waitcnt vmcnt(8)
    v_min_u32 v113, 256, v0
    v_lshlrev_b32 v113, 4, v113
    v_add_u32 v113, 140288, v113
    ds_write_b128 v113, v[144:147]
    ds_write_b128 v113, v[148:151] offset:4128
    v_and_b32 v113, 31, v0
    v_lshlrev_b32 v113, 2, v113
    v_add_u32 v113, 163072, v113
    v_mov_b32 v114, 0
    ds_write_b32 v113, v114
    s_cmp_ge_u32 s10, 4
    s_cbranch_scc1 L_adaLN_cond__spectral_gfnet__glu_gated_bilinear__prompt_kernel_wv_3
    s_mul_i32 s16, s2, 8320
    s_add_u32 s16, s16, 1048576
    v_add_u32 v112, s16, v6
    v_add_u32 v113, 4096, v112
    global_store_dwordx4 v112, v[108:111], s[6:7] sc1
    global_store_dwordx4 v113, v[108:111], s[6:7] sc1
    s_cmp_lg_u32 s10, 0
    s_cbranch_scc1 L_adaLN_cond__spectral_gfnet__glu_gated_bilinear__prompt_kernel_cs_4
    s_add_u32 s16, s16, 8192
    v_add_u32 v112, s16, v3
    s_mov_b64 exec, 3
    global_store_dwordx4 v112, v[108:111], s[6:7] sc1
    s_mov_b64 exec, -1
L_adaLN_cond__spectral_gfnet__glu_gated_bilinear__prompt_kernel_cs_4:
L_adaLN_cond__spectral_gfnet__glu_gated_bilinear__prompt_kernel_wv_3:
    s_waitcnt lgkmcnt(0)
    s_barrier
    s_cmp_ge_u32 s10, 4
    s_cbranch_scc1 L_adaLN_cond__spectral_gfnet__glu_gated_bilinear__prompt_kernel_wv_5
    v_add_u32 v126, 256, v0
    v_lshrrev_b32 v114, 1, v0
    v_and_b32 v115, 1, v0
    v_mul_u32_u24 v116, 2056, v115
    v_lshlrev_b32 v117, 1, v114
    v_add_u32 v116, v116, v117
    v_add_u32 v116, 140288, v116
    ds_read_u16 v100, v116 offset:0
    ds_read_u16 v104, v116 offset:4128
    ds_read_u16 v101, v116 offset:514
    ds_read_u16 v105, v116 offset:4642
    ds_read_u16 v102, v116 offset:1028
    ds_read_u16 v106, v116 offset:5156
    ds_read_u16 v103, v116 offset:1542
    ds_read_u16 v107, v116 offset:5670
    s_mul_i32 s18, s2, 8320
    s_add_u32 s18, s18, 7340032
    v_lshlrev_b32 v113, 4, v0
    v_add_u32 v113, s18, v113
    s_waitcnt lgkmcnt(0)
    v_lshl_or_b32 v100, v104, 16, v100
    v_lshl_or_b32 v101, v105, 16, v101
    v_lshl_or_b32 v102, v106, 16, v102
    v_lshl_or_b32 v103, v107, 16, v103
    global_store_dwordx4 v113, v[100:103], s[6:7] sc1
    v_lshrrev_b32 v114, 1, v126
    v_and_b32 v115, 1, v126
    v_mul_u32_u24 v116, 2056, v115
    v_lshlrev_b32 v117, 1, v114
    v_add_u32 v116, v116, v117
    v_add_u32 v116, 140288, v116
    ds_read_u16 v80, v116 offset:0
    ds_read_u16 v84, v116 offset:4128
    ds_read_u16 v81, v116 offset:514
    ds_read_u16 v85, v116 offset:4642
    ds_read_u16 v82, v116 offset:1028
    ds_read_u16 v86, v116 offset:5156
    ds_read_u16 v83, v116 offset:1542
    ds_read_u16 v87, v116 offset:5670
    s_mul_i32 s18, s2, 8320
    s_add_u32 s18, s18, 7340032
    v_lshlrev_b32 v113, 4, v126
    v_add_u32 v113, s18, v113
    s_waitcnt lgkmcnt(0)
    v_lshl_or_b32 v80, v84, 16, v80
    v_lshl_or_b32 v81, v85, 16, v81
    v_lshl_or_b32 v82, v86, 16, v82
    v_lshl_or_b32 v83, v87, 16, v83
    global_store_dwordx4 v113, v[80:83], s[6:7] sc1
    s_cmp_lg_u32 s10, 0
    s_cbranch_scc1 L_adaLN_cond__spectral_gfnet__glu_gated_bilinear__prompt_kernel_ny_6
    v_min_u32 v117, 1, v1
    v_mul_u32_u24 v117, 2056, v117
    v_add_u32 v117, 140288, v117
    ds_read_u16 v120, v117 offset:512
    ds_read_u16 v124, v117 offset:4640
    ds_read_u16 v121, v117 offset:1026
    ds_read_u16 v125, v117 offset:5154
    ds_read_u16 v122, v117 offset:1540
    ds_read_u16 v126, v117 offset:5668
    ds_read_u16 v123, v117 offset:2054
    ds_read_u16 v127, v117 offset:6182
    s_mul_i32 s18, s2, 8320
    s_add_u32 s18, s18, 7348224
    v_add_u32 v113, s18, v3
    s_waitcnt lgkmcnt(0)
    v_lshl_or_b32 v120, v124, 16, v120
    v_lshl_or_b32 v121, v125, 16, v121
    v_lshl_or_b32 v122, v126, 16, v122
    v_lshl_or_b32 v123, v127, 16, v123
    s_mov_b64 exec, 3
    global_store_dwordx4 v113, v[120:123], s[6:7] sc1
    s_mov_b64 exec, -1
L_adaLN_cond__spectral_gfnet__glu_gated_bilinear__prompt_kernel_ny_6:
L_adaLN_cond__spectral_gfnet__glu_gated_bilinear__prompt_kernel_wv_5:
    s_cmp_lt_u32 s10, 4
    s_cbranch_scc1 L_adaLN_cond__spectral_gfnet__glu_gated_bilinear__prompt_kernel_wv_7
    s_lshl_b32 s16, s34, 13
    s_add_u32 s16, s16, 4194304
    v_add_u32 v112, s16, v6
    v_subrev_u32 v113, 4096, v112
    global_store_dwordx4 v113, v[108:111], s[6:7] sc1
    global_store_dwordx4 v112, v[108:111], s[6:7] sc1
    s_cmp_lg_u32 s2, 0
    s_cbranch_scc1 L_adaLN_cond__spectral_gfnet__glu_gated_bilinear__prompt_kernel_cs_8
    v_add_u32 v112, 6291456, v6
    v_subrev_u32 v113, 4096, v112
    global_store_dwordx4 v113, v[108:111], s[6:7] sc1
    global_store_dwordx4 v112, v[108:111], s[6:7] sc1
L_adaLN_cond__spectral_gfnet__glu_gated_bilinear__prompt_kernel_cs_8:
    v_subrev_u32 v115, 256, v0
    s_lshr_b32 s16, s11, 1
    s_lshl_b32 s16, s16, 17
    s_and_b32 s17, s11, 1
    s_lshl_b32 s17, s17, 1
    s_lshr_b32 s18, s12, 2
    s_add_u32 s17, s17, s18
    s_lshl_b32 s17, s17, 15
    s_add_u32 s16, s16, s17
    s_and_b32 s18, s12, 3
    s_lshl_b32 s18, s18, 7
    s_add_u32 s16, s16, s18
    s_add_u32 s16, s16, 12582912
    v_lshrrev_b32 v113, 3, v115
    v_lshlrev_b32 v113, 9, v113
    v_and_b32 v114, 7, v115
    v_lshlrev_b32 v114, 4, v114
    v_add_u32 v113, v113, v114
    v_add_u32 v113, s16, v113
    global_store_dwordx4 v113, v[108:111], s[6:7] sc1
    v_add_u32 v114, 16384, v113
    global_store_dwordx4 v114, v[108:111], s[6:7] sc1
L_adaLN_cond__spectral_gfnet__glu_gated_bilinear__prompt_kernel_wv_7:
    s_cmp_eq_u32 s2, 0
    s_cselect_b32 s16, 8, 4
    s_cmp_ge_u32 s10, s16
    s_cbranch_scc1 L_adaLN_cond__spectral_gfnet__glu_gated_bilinear__prompt_kernel_nofc_9
    v_and_b32 v112, 15, v1
    v_lshrrev_b32 v113, 4, v1
    s_and_b32 s15, s10, 3
    s_lshl_b32 s15, s15, 4
    s_mov_b32 s14, 0x8000
    v_cvt_f32_u32 v115, v1
    v_mul_f32 v115, 0x3c800000, v115
    v_cos_f32 v116, v115
    v_sin_f32 v115, v115
    s_nop 0
    v_cvt_pk_bf16_f32 v114, v116, v115
    v_add_u32 v115, s15, v112
    v_lshlrev_b32 v116, 2, v115
    v_lshlrev_b32 v117, 2, v113
    v_mul_u32_u24 v117, v117, v116
    v_mad_u32_u24 v208, v116, 0, v117
    v_mad_u32_u24 v209, v116, 1, v117
    v_mad_u32_u24 v210, v116, 2, v117
    v_mad_u32_u24 v211, v116, 3, v117
    v_mad_u32_u24 v212, v116, 16, v117
    v_mad_u32_u24 v213, v116, 17, v117
    v_mad_u32_u24 v214, v116, 18, v117
    v_mad_u32_u24 v215, v116, 19, v117
    v_mad_u32_u24 v216, v116, 32, v117
    v_mad_u32_u24 v217, v116, 33, v117
    v_mad_u32_u24 v218, v116, 34, v117
    v_mad_u32_u24 v219, v116, 35, v117
    v_mad_u32_u24 v220, v116, 48, v117
    v_mad_u32_u24 v221, v116, 49, v117
    v_mad_u32_u24 v222, v116, 50, v117
    v_mad_u32_u24 v223, v116, 51, v117
    ds_bpermute_b32 v192, v208, v114
    ds_bpermute_b32 v193, v209, v114
    ds_bpermute_b32 v194, v210, v114
    ds_bpermute_b32 v195, v211, v114
    ds_bpermute_b32 v196, v212, v114
    ds_bpermute_b32 v197, v213, v114
    ds_bpermute_b32 v198, v214, v114
    ds_bpermute_b32 v199, v215, v114
    ds_bpermute_b32 v200, v216, v114
    ds_bpermute_b32 v201, v217, v114
    ds_bpermute_b32 v202, v218, v114
    ds_bpermute_b32 v203, v219, v114
    ds_bpermute_b32 v204, v220, v114
    ds_bpermute_b32 v205, v221, v114
    ds_bpermute_b32 v206, v222, v114
    ds_bpermute_b32 v207, v223, v114
    v_lshlrev_b32 v118, 3, v112
    v_add_u32 v118, 0, v118
    v_lshlrev_b32 v119, 2, v113
    v_mul_u32_u24 v119, v119, v118
    v_mad_u32_u24 v240, v118, 0, v119
    v_mad_u32_u24 v241, v118, 1, v119
    v_mad_u32_u24 v242, v118, 2, v119
    v_mad_u32_u24 v243, v118, 3, v119
    v_mad_u32_u24 v244, v118, 16, v119
    v_mad_u32_u24 v245, v118, 17, v119
    v_mad_u32_u24 v246, v118, 18, v119
    v_mad_u32_u24 v247, v118, 19, v119
    v_lshlrev_b32 v118, 3, v112
    v_add_u32 v118, 128, v118
    v_lshlrev_b32 v119, 2, v113
    v_mul_u32_u24 v119, v119, v118
    v_mad_u32_u24 v248, v118, 0, v119
    v_mad_u32_u24 v249, v118, 1, v119
    v_mad_u32_u24 v250, v118, 2, v119
    v_mad_u32_u24 v251, v118, 3, v119
    v_mad_u32_u24 v252, v118, 16, v119
    v_mad_u32_u24 v253, v118, 17, v119
    v_mad_u32_u24 v254, v118, 18, v119
    v_mad_u32_u24 v255, v118, 19, v119
    ds_bpermute_b32 v224, v240, v114
    ds_bpermute_b32 v225, v241, v114
    ds_bpermute_b32 v226, v242, v114
    ds_bpermute_b32 v227, v243, v114
    ds_bpermute_b32 v228, v244, v114
    ds_bpermute_b32 v229, v245, v114
    ds_bpermute_b32 v230, v246, v114
    ds_bpermute_b32 v231, v247, v114
    ds_bpermute_b32 v232, v248, v114
    ds_bpermute_b32 v233, v249, v114
    ds_bpermute_b32 v234, v250, v114
    ds_bpermute_b32 v235, v251, v114
    ds_bpermute_b32 v236, v252, v114
    ds_bpermute_b32 v237, v253, v114
    ds_bpermute_b32 v238, v254, v114
    ds_bpermute_b32 v239, v255, v114
    s_waitcnt lgkmcnt(0)
    v_alignbit_b32 v208, v192, v192, 16
    v_alignbit_b32 v209, v193, v193, 16
    v_alignbit_b32 v210, v194, v194, 16
    v_alignbit_b32 v211, v195, v195, 16
    v_alignbit_b32 v212, v196, v196, 16
    v_alignbit_b32 v213, v197, v197, 16
    v_alignbit_b32 v214, v198, v198, 16
    v_alignbit_b32 v215, v199, v199, 16
    v_alignbit_b32 v216, v200, v200, 16
    v_alignbit_b32 v217, v201, v201, 16
    v_alignbit_b32 v218, v202, v202, 16
    v_alignbit_b32 v219, v203, v203, 16
    v_alignbit_b32 v220, v204, v204, 16
    v_alignbit_b32 v221, v205, v205, 16
    v_alignbit_b32 v222, v206, v206, 16
    v_alignbit_b32 v223, v207, v207, 16
    v_xor_b32 v208, s14, v208
    v_xor_b32 v209, s14, v209
    v_xor_b32 v210, s14, v210
    v_xor_b32 v211, s14, v211
    v_xor_b32 v212, s14, v212
    v_xor_b32 v213, s14, v213
    v_xor_b32 v214, s14, v214
    v_xor_b32 v215, s14, v215
    v_xor_b32 v216, s14, v216
    v_xor_b32 v217, s14, v217
    v_xor_b32 v218, s14, v218
    v_xor_b32 v219, s14, v219
    v_xor_b32 v220, s14, v220
    v_xor_b32 v221, s14, v221
    v_xor_b32 v222, s14, v222
    v_xor_b32 v223, s14, v223
    v_alignbit_b32 v240, v224, v224, 16
    v_alignbit_b32 v241, v225, v225, 16
    v_alignbit_b32 v242, v226, v226, 16
    v_alignbit_b32 v243, v227, v227, 16
    v_alignbit_b32 v244, v228, v228, 16
    v_alignbit_b32 v245, v229, v229, 16
    v_alignbit_b32 v246, v230, v230, 16
    v_alignbit_b32 v247, v231, v231, 16
    v_alignbit_b32 v248, v232, v232, 16
    v_alignbit_b32 v249, v233, v233, 16
    v_alignbit_b32 v250, v234, v234, 16
    v_alignbit_b32 v251, v235, v235, 16
    v_alignbit_b32 v252, v236, v236, 16
    v_alignbit_b32 v253, v237, v237, 16
    v_alignbit_b32 v254, v238, v238, 16
    v_alignbit_b32 v255, v239, v239, 16
    v_xor_b32 v240, s14, v240
    v_xor_b32 v241, s14, v241
    v_xor_b32 v242, s14, v242
    v_xor_b32 v243, s14, v243
    v_xor_b32 v244, s14, v244
    v_xor_b32 v245, s14, v245
    v_xor_b32 v246, s14, v246
    v_xor_b32 v247, s14, v247
    v_xor_b32 v248, s14, v248
    v_xor_b32 v249, s14, v249
    v_xor_b32 v250, s14, v250
    v_xor_b32 v251, s14, v251
    v_xor_b32 v252, s14, v252
    v_xor_b32 v253, s14, v253
    v_xor_b32 v254, s14, v254
    v_xor_b32 v255, s14, v255
L_adaLN_cond__spectral_gfnet__glu_gated_bilinear__prompt_kernel_nofc_9:
    s_waitcnt vmcnt(8)
    v_lshlrev_b32 v92, 16, v92
    v_mul_f32 v76, 0xbfb8aa3b, v92
    v_lshlrev_b32 v93, 16, v93
    v_mul_f32 v77, 0xbfb8aa3b, v93
    v_lshlrev_b32 v94, 16, v94
    v_mul_f32 v78, 0xbfb8aa3b, v94
    v_lshlrev_b32 v95, 16, v95
    v_mul_f32 v79, 0xbfb8aa3b, v95
    v_exp_f32 v76, v76
    v_exp_f32 v77, v77
    v_exp_f32 v78, v78
    v_exp_f32 v79, v79
    v_add_f32 v76, 1.0, v76
    v_add_f32 v77, 1.0, v77
    v_add_f32 v78, 1.0, v78
    v_add_f32 v79, 1.0, v79
    v_rcp_f32 v76, v76
    v_rcp_f32 v77, v77
    v_rcp_f32 v78, v78
    v_rcp_f32 v79, v79
    v_mul_f32 v76, v92, v76
    v_mul_f32 v77, v93, v77
    v_mul_f32 v78, v94, v78
    v_mul_f32 v79, v95, v79
    v_cvt_pk_bf16_f32 v76, v76, v76
    v_cvt_pk_bf16_f32 v77, v77, v77
    v_cvt_pk_bf16_f32 v78, v78, v78
    v_cvt_pk_bf16_f32 v79, v79, v79
    v_lshlrev_b32 v92, 16, v76
    v_lshlrev_b32 v93, 16, v77
    v_lshlrev_b32 v94, 16, v78
    v_lshlrev_b32 v95, 16, v79
    v_lshrrev_b32 v76, 2, v0
    v_lshlrev_b32 v76, 2, v76
    v_add_u32 v76, 159232, v76
    ds_write_b32 v76, v92 offset:0
    ds_write_b32 v76, v93 offset:512
    ds_write_b32 v76, v94 offset:1024
    ds_write_b32 v76, v95 offset:1536
    s_lshr_b32 s16, s10, 2
    s_cmp_eq_u32 s2, 0
    s_cselect_b32 s16, s16, 0
    s_cmp_eq_u32 s10, 0
    s_cselect_b32 s16, 1, s16
    s_cmp_lg_u32 s16, 0
    s_cbranch_scc1 L_adaLN_cond__spectral_gfnet__glu_gated_bilinear__prompt_kernel_w6_10
    s_waitcnt vmcnt(4)
    s_branch L_adaLN_cond__spectral_gfnet__glu_gated_bilinear__prompt_kernel_w4_11
L_adaLN_cond__spectral_gfnet__glu_gated_bilinear__prompt_kernel_w6_10:
    s_waitcnt vmcnt(6)
L_adaLN_cond__spectral_gfnet__glu_gated_bilinear__prompt_kernel_w4_11:
    v_lshlrev_b32 v84, 16, v128
    v_and_b32 v85, 0xffff0000, v128
    v_lshlrev_b32 v86, 16, v129
    v_and_b32 v87, 0xffff0000, v129
    v_lshlrev_b32 v88, 16, v130
    v_and_b32 v89, 0xffff0000, v130
    v_lshlrev_b32 v90, 16, v131
    v_and_b32 v91, 0xffff0000, v131
    v_mul_f32 v76, v84, v92
    v_mul_f32 v77, v85, v92
    v_mul_f32 v78, v86, v92
    v_mul_f32 v79, v87, v92
    v_mul_f32 v80, v88, v92
    v_mul_f32 v81, v89, v92
    v_mul_f32 v82, v90, v92
    v_mul_f32 v83, v91, v92
    v_lshlrev_b32 v84, 16, v132
    v_and_b32 v85, 0xffff0000, v132
    v_lshlrev_b32 v86, 16, v133
    v_and_b32 v87, 0xffff0000, v133
    v_lshlrev_b32 v88, 16, v134
    v_and_b32 v89, 0xffff0000, v134
    v_lshlrev_b32 v90, 16, v135
    v_and_b32 v91, 0xffff0000, v135
    v_fmac_f32 v76, v84, v93
    v_fmac_f32 v77, v85, v93
    v_fmac_f32 v78, v86, v93
    v_fmac_f32 v79, v87, v93
    v_fmac_f32 v80, v88, v93
    v_fmac_f32 v81, v89, v93
    v_fmac_f32 v82, v90, v93
    v_fmac_f32 v83, v91, v93
    v_lshlrev_b32 v84, 16, v136
    v_and_b32 v85, 0xffff0000, v136
    v_lshlrev_b32 v86, 16, v137
    v_and_b32 v87, 0xffff0000, v137
    v_lshlrev_b32 v88, 16, v138
    v_and_b32 v89, 0xffff0000, v138
    v_lshlrev_b32 v90, 16, v139
    v_and_b32 v91, 0xffff0000, v139
    v_fmac_f32 v76, v84, v94
    v_fmac_f32 v77, v85, v94
    v_fmac_f32 v78, v86, v94
    v_fmac_f32 v79, v87, v94
    v_fmac_f32 v80, v88, v94
    v_fmac_f32 v81, v89, v94
    v_fmac_f32 v82, v90, v94
    v_fmac_f32 v83, v91, v94
    v_lshlrev_b32 v84, 16, v140
    v_and_b32 v85, 0xffff0000, v140
    v_lshlrev_b32 v86, 16, v141
    v_and_b32 v87, 0xffff0000, v141
    v_lshlrev_b32 v88, 16, v142
    v_and_b32 v89, 0xffff0000, v142
    v_lshlrev_b32 v90, 16, v143
    v_and_b32 v91, 0xffff0000, v143
    v_fmac_f32 v76, v84, v95
    v_fmac_f32 v77, v85, v95
    v_fmac_f32 v78, v86, v95
    v_fmac_f32 v79, v87, v95
    v_fmac_f32 v80, v88, v95
    v_fmac_f32 v81, v89, v95
    v_fmac_f32 v82, v90, v95
    v_fmac_f32 v83, v91, v95
    v_add_f32_dpp v76, v76, v76 row_ror:4 row_mask:0xf bank_mask:0xf
    v_add_f32_dpp v77, v77, v77 row_ror:4 row_mask:0xf bank_mask:0xf
    v_add_f32_dpp v78, v78, v78 row_ror:4 row_mask:0xf bank_mask:0xf
    v_add_f32_dpp v79, v79, v79 row_ror:4 row_mask:0xf bank_mask:0xf
    v_add_f32_dpp v80, v80, v80 row_ror:4 row_mask:0xf bank_mask:0xf
    v_add_f32_dpp v81, v81, v81 row_ror:4 row_mask:0xf bank_mask:0xf
    v_add_f32_dpp v82, v82, v82 row_ror:4 row_mask:0xf bank_mask:0xf
    v_add_f32_dpp v83, v83, v83 row_ror:4 row_mask:0xf bank_mask:0xf
    v_add_f32_dpp v76, v76, v76 row_ror:8 row_mask:0xf bank_mask:0xf
    v_add_f32_dpp v77, v77, v77 row_ror:8 row_mask:0xf bank_mask:0xf
    v_add_f32_dpp v78, v78, v78 row_ror:8 row_mask:0xf bank_mask:0xf
    v_add_f32_dpp v79, v79, v79 row_ror:8 row_mask:0xf bank_mask:0xf
    v_add_f32_dpp v80, v80, v80 row_ror:8 row_mask:0xf bank_mask:0xf
    v_add_f32_dpp v81, v81, v81 row_ror:8 row_mask:0xf bank_mask:0xf
    v_add_f32_dpp v82, v82, v82 row_ror:8 row_mask:0xf bank_mask:0xf
    v_add_f32_dpp v83, v83, v83 row_ror:8 row_mask:0xf bank_mask:0xf
    v_mov_b32 v84, v76
    v_mov_b32 v85, v77
    v_mov_b32 v86, v78
    v_mov_b32 v87, v79
    v_mov_b32 v88, v80
    v_mov_b32 v89, v81
    v_mov_b32 v90, v82
    v_mov_b32 v91, v83
    v_permlane16_swap_b32 v76, v84
    v_permlane16_swap_b32 v77, v85
    v_permlane16_swap_b32 v78, v86
    v_permlane16_swap_b32 v79, v87
    v_permlane16_swap_b32 v80, v88
    v_permlane16_swap_b32 v81, v89
    v_permlane16_swap_b32 v82, v90
    v_permlane16_swap_b32 v83, v91
    v_add_f32 v76, v76, v84
    v_add_f32 v77, v77, v85
    v_add_f32 v78, v78, v86
    v_add_f32 v79, v79, v87
    v_add_f32 v80, v80, v88
    v_add_f32 v81, v81, v89
    v_add_f32 v82, v82, v90
    v_add_f32 v83, v83, v91
    v_mov_b32 v84, v76
    v_mov_b32 v85, v77
    v_mov_b32 v86, v78
    v_mov_b32 v87, v79
    v_mov_b32 v88, v80
    v_mov_b32 v89, v81
    v_mov_b32 v90, v82
    v_mov_b32 v91, v83
    v_permlane32_swap_b32 v76, v84
    v_permlane32_swap_b32 v77, v85
    v_permlane32_swap_b32 v78, v86
    v_permlane32_swap_b32 v79, v87
    v_permlane32_swap_b32 v80, v88
    v_permlane32_swap_b32 v81, v89
    v_permlane32_swap_b32 v82, v90
    v_permlane32_swap_b32 v83, v91
    v_add_f32 v76, v76, v84
    v_add_f32 v77, v77, v85
    v_add_f32 v78, v78, v86
    v_add_f32 v79, v79, v87
    v_add_f32 v80, v80, v88
    v_add_f32 v81, v81, v89
    v_add_f32 v82, v82, v90
    v_add_f32 v83, v83, v91
    v_lshrrev_b32 v84, 6, v0
    v_lshlrev_b32 v84, 7, v84
    v_and_b32 v85, 3, v0
    v_lshlrev_b32 v85, 5, v85
    v_add_u32 v84, v84, v85
    v_add_u32 v84, 148992, v84
    s_mov_b64 exec, 15
    ds_write_b128 v84, v[76:79]
    ds_write_b128 v84, v[80:83] offset:16
    s_mov_b64 exec, -1
    s_waitcnt lgkmcnt(0)
    s_barrier
    s_cmp_lg_u32 s10, 4
    s_cbranch_scc1 L_adaLN_cond__spectral_gfnet__glu_gated_bilinear__prompt_kernel_modw0_12
    v_and_b32 v85, 31, v1
    v_lshlrev_b32 v84, 2, v85
    v_add_u32 v86, 148992, v84
    ds_read_b32 v76, v86 offset:0
    ds_read_b32 v77, v86 offset:128
    ds_read_b32 v78, v86 offset:256
    ds_read_b32 v79, v86 offset:384
    ds_read_b32 v80, v86 offset:512
    ds_read_b32 v81, v86 offset:640
    ds_read_b32 v82, v86 offset:768
    ds_read_b32 v83, v86 offset:896
    s_waitcnt lgkmcnt(0)
    v_add_f32 v76, v76, v77
    v_add_f32 v78, v78, v79
    v_add_f32 v80, v80, v81
    v_add_f32 v82, v82, v83
    v_add_f32 v76, v76, v78
    v_add_f32 v80, v80, v82
    v_add_f32 v76, v76, v80
    v_cvt_pk_bf16_f32 v76, v76, v76
    v_lshlrev_b32 v76, 16, v76
    v_add_f32 v77, 1.0, v76
    v_cvt_pk_bf16_f32 v77, v77, v77
    v_lshlrev_b32 v77, 16, v77
    s_mov_b32 s16, s2
    s_lshr_b32 s16, s16, 4
    s_cmp_eq_u32 s16, 1
    s_cselect_b32 s17, 1, 0
    s_cmp_eq_u32 s16, 4
    s_cselect_b32 s17, 1, s17
    s_cmp_eq_u32 s17, 1
    s_cselect_b64 vcc, -1, 0
    v_cndmask_b32 v76, v76, v77, vcc
    s_nop 1
    v_mov_b32_dpp v77, v76 quad_perm:[1,0,3,2] row_mask:0xf bank_mask:0xf
    v_lshrrev_b32 v78, 16, v76
    v_or_b32 v78, v78, v77
    v_mov_b32 v79, s3
    v_lshlrev_b32 v84, 2, v85
    s_mov_b32 s16, s2
    s_lshl_b32 s16, s16, 7
    s_add_u32 s16, s16, 20480
    v_add_u32 v84, s16, v84
    s_mov_b32 s16, 0x55555555
    s_mov_b32 s17, 0
    s_mov_b64 exec, s[16:17]
    global_store_dwordx2 v84, v[78:79], s[6:7] sc1
    s_mov_b64 exec, -1
L_adaLN_cond__spectral_gfnet__glu_gated_bilinear__prompt_kernel_modw0_12:
    s_cmp_eq_u32 s2, 0
    s_cbranch_scc1 L_adaLN_cond__spectral_gfnet__glu_gated_bilinear__prompt_kernel_nmm_13
    s_cmp_lt_u32 s10, 4
    s_cbranch_scc1 L_adaLN_cond__spectral_gfnet__glu_gated_bilinear__prompt_kernel_wv_14
    s_sub_u32 s35, s2, 1
    s_cmp_eq_u32 s2, 0
    s_cselect_b32 s35, 31, s35
    v_subrev_u32 v112, 256, v0
    v_lshrrev_b32 v113, 3, v112
    v_mul_u32_u24 v113, 98304, v113
    v_and_b32 v114, 7, v112
    v_lshlrev_b32 v114, 4, v114
    v_add_u32 v113, v113, v114
    s_lshl_b32 s16, s35, 7
    s_add_u32 s16, s16, 2048
    v_add_u32 v113, s16, v113
    s_add_u32 s18, s66, 0
    s_addc_u32 s19, s67, 0
    global_load_dwordx4 v[128:131], v113, s[18:19]
    s_add_u32 s18, s66, 6144
    s_addc_u32 s19, s67, 0
    global_load_dwordx4 v[132:135], v113, s[18:19]
    s_add_u32 s18, s66, 12288
    s_addc_u32 s19, s67, 0
    global_load_dwordx4 v[136:139], v113, s[18:19]
    s_add_u32 s18, s66, 18432
    s_addc_u32 s19, s67, 0
    global_load_dwordx4 v[140:143], v113, s[18:19]
    s_add_u32 s18, s66, 24576
    s_addc_u32 s19, s67, 0
    global_load_dwordx4 v[144:147], v113, s[18:19]
    s_add_u32 s18, s66, 30720
    s_addc_u32 s19, s67, 0
    global_load_dwordx4 v[148:151], v113, s[18:19]
    s_add_u32 s18, s66, 36864
    s_addc_u32 s19, s67, 0
    global_load_dwordx4 v[152:155], v113, s[18:19]
    s_add_u32 s18, s66, 43008
    s_addc_u32 s19, s67, 0
    global_load_dwordx4 v[156:159], v113, s[18:19]
    s_add_u32 s18, s66, 49152
    s_addc_u32 s19, s67, 0
    global_load_dwordx4 v[160:163], v113, s[18:19]
    s_add_u32 s18, s66, 55296
    s_addc_u32 s19, s67, 0
    global_load_dwordx4 v[164:167], v113, s[18:19]
    s_add_u32 s18, s66, 61440
    s_addc_u32 s19, s67, 0
    global_load_dwordx4 v[168:171], v113, s[18:19]
    s_add_u32 s18, s66, 67584
    s_addc_u32 s19, s67, 0
    global_load_dwordx4 v[172:175], v113, s[18:19]
    s_add_u32 s18, s66, 73728
    s_addc_u32 s19, s67, 0
    global_load_dwordx4 v[176:179], v113, s[18:19]
    s_add_u32 s18, s66, 79872
    s_addc_u32 s19, s67, 0
    global_load_dwordx4 v[180:183], v113, s[18:19]
    s_add_u32 s18, s66, 86016
    s_addc_u32 s19, s67, 0
    global_load_dwordx4 v[184:187], v113, s[18:19]
    s_add_u32 s18, s66, 92160
    s_addc_u32 s19, s67, 0
    global_load_dwordx4 v[188:191], v113, s[18:19]
L_adaLN_cond__spectral_gfnet__glu_gated_bilinear__prompt_kernel_wv_14:
L_adaLN_cond__spectral_gfnet__glu_gated_bilinear__prompt_kernel_nmm_13:
    s_cmp_ge_u32 s10, 4
    s_cbranch_scc1 L_adaLN_cond__spectral_gfnet__glu_gated_bilinear__prompt_kernel_wv_15
    s_waitcnt vmcnt(0)
    v_mov_b32 v120, 163120
    v_mov_b32 v121, 1
    s_mov_b64 exec, 1
    ds_add_rtn_u32 v122, v120, v121
    s_lshl_b32 s16, s2, 7
    s_add_u32 s16, s16, 65536
    v_mov_b32 v120, s16
    v_mov_b32 v121, s3
    s_waitcnt lgkmcnt(0)
    v_cmp_eq_u32 vcc, 3, v122
    s_cbranch_vccz L_adaLN_cond__spectral_gfnet__glu_gated_bilinear__prompt_kernel_sf_16
    global_store_dword v120, v121, s[6:7] sc1
L_adaLN_cond__spectral_gfnet__glu_gated_bilinear__prompt_kernel_sf_16:
    s_mov_b64 exec, -1
L_adaLN_cond__spectral_gfnet__glu_gated_bilinear__prompt_kernel_wv_15:
    s_branch L_adaLN_cond__spectral_gfnet__glu_gated_bilinear__prompt_kernel_join0_2
L_adaLN_cond__spectral_gfnet__glu_gated_bilinear__prompt_kernel_clsW_1:
    v_and_b32 v112, 15, v1
    v_lshrrev_b32 v113, 4, v1
    s_mov_b32 s14, 0x8000
    v_cvt_f32_u32 v115, v1
    v_mul_f32 v115, 0x3c800000, v115
    v_cos_f32 v116, v115
    v_sin_f32 v115, v115
    s_nop 0
    v_cvt_pk_bf16_f32 v114, v116, v115
    v_lshlrev_b32 v116, 3, v112
    v_lshlrev_b32 v117, 2, v113
    v_mul_u32_u24 v117, v117, v116
    v_mad_u32_u24 v120, v116, 0, v117
    v_mad_u32_u24 v121, v116, 1, v117
    v_mad_u32_u24 v122, v116, 2, v117
    v_mad_u32_u24 v123, v116, 3, v117
    v_mad_u32_u24 v124, v116, 16, v117
    v_mad_u32_u24 v125, v116, 17, v117
    v_mad_u32_u24 v126, v116, 18, v117
    v_mad_u32_u24 v127, v116, 19, v117
    ds_bpermute_b32 v56, v120, v114
    ds_bpermute_b32 v57, v121, v114
    ds_bpermute_b32 v58, v122, v114
    ds_bpermute_b32 v59, v123, v114
    ds_bpermute_b32 v64, v124, v114
    ds_bpermute_b32 v65, v125, v114
    ds_bpermute_b32 v66, v126, v114
    ds_bpermute_b32 v67, v127, v114
    v_mad_u32_u24 v96, v116, 0, v117
    v_lshlrev_b32 v96, 1, v96
    v_mad_u32_u24 v97, v116, 1, v117
    v_lshlrev_b32 v97, 1, v97
    v_mad_u32_u24 v98, v116, 2, v117
    v_lshlrev_b32 v98, 1, v98
    v_mad_u32_u24 v99, v116, 3, v117
    v_lshlrev_b32 v99, 1, v99
    ds_bpermute_b32 v100, v96, v114
    ds_bpermute_b32 v101, v97, v114
    ds_bpermute_b32 v102, v98, v114
    ds_bpermute_b32 v103, v99, v114
    v_cvt_f32_u32 v118, v112
    v_mul_f32 v118, 0x3b000000, v118
    v_lshlrev_b32 v119, 2, v113
    v_cvt_f32_u32 v119, v119
    v_mul_f32 v119, v119, v118
    s_mov_b32 s16, 0x0
    v_fma_f32 v44, v118, s16, v119
    s_mov_b32 s16, 0x3f800000
    v_fma_f32 v45, v118, s16, v119
    s_mov_b32 s16, 0x40000000
    v_fma_f32 v46, v118, s16, v119
    s_mov_b32 s16, 0x40400000
    v_fma_f32 v47, v118, s16, v119
    s_mov_b32 s16, 0x41800000
    v_fma_f32 v52, v118, s16, v119
    s_mov_b32 s16, 0x41880000
    v_fma_f32 v53, v118, s16, v119
    s_mov_b32 s16, 0x41900000
    v_fma_f32 v54, v118, s16, v119
    s_mov_b32 s16, 0x41980000
    v_fma_f32 v55, v118, s16, v119
    v_cos_f32 v40, v44
    v_cos_f32 v41, v45
    v_cos_f32 v42, v46
    v_cos_f32 v43, v47
    v_cos_f32 v48, v52
    v_cos_f32 v49, v53
    v_cos_f32 v50, v54
    v_cos_f32 v51, v55
    v_sin_f32 v44, v44
    v_sin_f32 v45, v45
    v_sin_f32 v46, v46
    v_sin_f32 v47, v47
    v_sin_f32 v52, v52
    v_sin_f32 v53, v53
    v_sin_f32 v54, v54
    v_sin_f32 v55, v55
    s_waitcnt lgkmcnt(0)
    v_alignbit_b32 v60, v56, v56, 16
    v_alignbit_b32 v61, v57, v57, 16
    v_alignbit_b32 v62, v58, v58, 16
    v_alignbit_b32 v63, v59, v59, 16
    v_xor_b32 v60, s14, v60
    v_xor_b32 v61, s14, v61
    v_xor_b32 v62, s14, v62
    v_xor_b32 v63, s14, v63
    v_alignbit_b32 v68, v64, v64, 16
    v_alignbit_b32 v69, v65, v65, 16
    v_alignbit_b32 v70, v66, v66, 16
    v_alignbit_b32 v71, v67, v67, 16
    v_xor_b32 v68, s14, v68
    v_xor_b32 v69, s14, v69
    v_xor_b32 v70, s14, v70
    v_xor_b32 v71, s14, v71
    s_mov_b32 s16, 0x05040100
    s_mov_b32 s17, 0x07060302
    s_mov_b32 s18, 0x80008000
    v_perm_b32 v72, v101, v100, s16
    v_perm_b32 v74, v101, v100, s17
    v_perm_b32 v73, v103, v102, s16
    v_perm_b32 v75, v103, v102, s17
    v_xor_b32 v74, s18, v74
    v_xor_b32 v75, s18, v75
    s_waitcnt lgkmcnt(0)
    s_load_dword s3, s[6:7], 16384
    global_load_dwordx4 v[8:11], v4, s[4:5]
    buffer_load_dwordx4 v[96:99], v7, s[48:51], 0 offen
    buffer_load_dwordx4 v[100:103], v7, s[52:55], 0 offen
    s_cmp_eq_u32 s2, 0
    s_cselect_b32 s16, 8, 4
    s_cmp_ge_u32 s10, s16
    s_cbranch_scc1 L_adaLN_cond__spectral_gfnet__glu_gated_bilinear__prompt_kernel_nofc_17
    v_and_b32 v112, 15, v1
    v_lshrrev_b32 v113, 4, v1
    s_and_b32 s15, s10, 3
    s_lshl_b32 s15, s15, 4
    s_mov_b32 s14, 0x8000
    v_cvt_f32_u32 v115, v1
    v_mul_f32 v115, 0x3c800000, v115
    v_cos_f32 v116, v115
    v_sin_f32 v115, v115
    s_nop 0
    v_cvt_pk_bf16_f32 v114, v116, v115
    v_add_u32 v115, s15, v112
    v_lshlrev_b32 v116, 2, v115
    v_lshlrev_b32 v117, 2, v113
    v_mul_u32_u24 v117, v117, v116
    v_mad_u32_u24 v208, v116, 0, v117
    v_mad_u32_u24 v209, v116, 1, v117
    v_mad_u32_u24 v210, v116, 2, v117
    v_mad_u32_u24 v211, v116, 3, v117
    v_mad_u32_u24 v212, v116, 16, v117
    v_mad_u32_u24 v213, v116, 17, v117
    v_mad_u32_u24 v214, v116, 18, v117
    v_mad_u32_u24 v215, v116, 19, v117
    v_mad_u32_u24 v216, v116, 32, v117
    v_mad_u32_u24 v217, v116, 33, v117
    v_mad_u32_u24 v218, v116, 34, v117
    v_mad_u32_u24 v219, v116, 35, v117
    v_mad_u32_u24 v220, v116, 48, v117
    v_mad_u32_u24 v221, v116, 49, v117
    v_mad_u32_u24 v222, v116, 50, v117
    v_mad_u32_u24 v223, v116, 51, v117
    ds_bpermute_b32 v192, v208, v114
    ds_bpermute_b32 v193, v209, v114
    ds_bpermute_b32 v194, v210, v114
    ds_bpermute_b32 v195, v211, v114
    ds_bpermute_b32 v196, v212, v114
    ds_bpermute_b32 v197, v213, v114
    ds_bpermute_b32 v198, v214, v114
    ds_bpermute_b32 v199, v215, v114
    ds_bpermute_b32 v200, v216, v114
    ds_bpermute_b32 v201, v217, v114
    ds_bpermute_b32 v202, v218, v114
    ds_bpermute_b32 v203, v219, v114
    ds_bpermute_b32 v204, v220, v114
    ds_bpermute_b32 v205, v221, v114
    ds_bpermute_b32 v206, v222, v114
    ds_bpermute_b32 v207, v223, v114
    v_lshlrev_b32 v118, 3, v112
    v_add_u32 v118, 0, v118
    v_lshlrev_b32 v119, 2, v113
    v_mul_u32_u24 v119, v119, v118
    v_mad_u32_u24 v240, v118, 0, v119
    v_mad_u32_u24 v241, v118, 1, v119
    v_mad_u32_u24 v242, v118, 2, v119
    v_mad_u32_u24 v243, v118, 3, v119
    v_mad_u32_u24 v244, v118, 16, v119
    v_mad_u32_u24 v245, v118, 17, v119
    v_mad_u32_u24 v246, v118, 18, v119
    v_mad_u32_u24 v247, v118, 19, v119
    v_lshlrev_b32 v118, 3, v112
    v_add_u32 v118, 128, v118
    v_lshlrev_b32 v119, 2, v113
    v_mul_u32_u24 v119, v119, v118
    v_mad_u32_u24 v248, v118, 0, v119
    v_mad_u32_u24 v249, v118, 1, v119
    v_mad_u32_u24 v250, v118, 2, v119
    v_mad_u32_u24 v251, v118, 3, v119
    v_mad_u32_u24 v252, v118, 16, v119
    v_mad_u32_u24 v253, v118, 17, v119
    v_mad_u32_u24 v254, v118, 18, v119
    v_mad_u32_u24 v255, v118, 19, v119
    ds_bpermute_b32 v224, v240, v114
    ds_bpermute_b32 v225, v241, v114
    ds_bpermute_b32 v226, v242, v114
    ds_bpermute_b32 v227, v243, v114
    ds_bpermute_b32 v228, v244, v114
    ds_bpermute_b32 v229, v245, v114
    ds_bpermute_b32 v230, v246, v114
    ds_bpermute_b32 v231, v247, v114
    ds_bpermute_b32 v232, v248, v114
    ds_bpermute_b32 v233, v249, v114
    ds_bpermute_b32 v234, v250, v114
    ds_bpermute_b32 v235, v251, v114
    ds_bpermute_b32 v236, v252, v114
    ds_bpermute_b32 v237, v253, v114
    ds_bpermute_b32 v238, v254, v114
    ds_bpermute_b32 v239, v255, v114
    s_waitcnt lgkmcnt(0)
    v_alignbit_b32 v208, v192, v192, 16
    v_alignbit_b32 v209, v193, v193, 16
    v_alignbit_b32 v210, v194, v194, 16
    v_alignbit_b32 v211, v195, v195, 16
    v_alignbit_b32 v212, v196, v196, 16
    v_alignbit_b32 v213, v197, v197, 16
    v_alignbit_b32 v214, v198, v198, 16
    v_alignbit_b32 v215, v199, v199, 16
    v_alignbit_b32 v216, v200, v200, 16
    v_alignbit_b32 v217, v201, v201, 16
    v_alignbit_b32 v218, v202, v202, 16
    v_alignbit_b32 v219, v203, v203, 16
    v_alignbit_b32 v220, v204, v204, 16
    v_alignbit_b32 v221, v205, v205, 16
    v_alignbit_b32 v222, v206, v206, 16
    v_alignbit_b32 v223, v207, v207, 16
    v_xor_b32 v208, s14, v208
    v_xor_b32 v209, s14, v209
    v_xor_b32 v210, s14, v210
    v_xor_b32 v211, s14, v211
    v_xor_b32 v212, s14, v212
    v_xor_b32 v213, s14, v213
    v_xor_b32 v214, s14, v214
    v_xor_b32 v215, s14, v215
    v_xor_b32 v216, s14, v216
    v_xor_b32 v217, s14, v217
    v_xor_b32 v218, s14, v218
    v_xor_b32 v219, s14, v219
    v_xor_b32 v220, s14, v220
    v_xor_b32 v221, s14, v221
    v_xor_b32 v222, s14, v222
    v_xor_b32 v223, s14, v223
    v_alignbit_b32 v240, v224, v224, 16
    v_alignbit_b32 v241, v225, v225, 16
    v_alignbit_b32 v242, v226, v226, 16
    v_alignbit_b32 v243, v227, v227, 16
    v_alignbit_b32 v244, v228, v228, 16
    v_alignbit_b32 v245, v229, v229, 16
    v_alignbit_b32 v246, v230, v230, 16
    v_alignbit_b32 v247, v231, v231, 16
    v_alignbit_b32 v248, v232, v232, 16
    v_alignbit_b32 v249, v233, v233, 16
    v_alignbit_b32 v250, v234, v234, 16
    v_alignbit_b32 v251, v235, v235, 16
    v_alignbit_b32 v252, v236, v236, 16
    v_alignbit_b32 v253, v237, v237, 16
    v_alignbit_b32 v254, v238, v238, 16
    v_alignbit_b32 v255, v239, v239, 16
    v_xor_b32 v240, s14, v240
    v_xor_b32 v241, s14, v241
    v_xor_b32 v242, s14, v242
    v_xor_b32 v243, s14, v243
    v_xor_b32 v244, s14, v244
    v_xor_b32 v245, s14, v245
    v_xor_b32 v246, s14, v246
    v_xor_b32 v247, s14, v247
    v_xor_b32 v248, s14, v248
    v_xor_b32 v249, s14, v249
    v_xor_b32 v250, s14, v250
    v_xor_b32 v251, s14, v251
    v_xor_b32 v252, s14, v252
    v_xor_b32 v253, s14, v253
    v_xor_b32 v254, s14, v254
    v_xor_b32 v255, s14, v255
L_adaLN_cond__spectral_gfnet__glu_gated_bilinear__prompt_kernel_nofc_17:
    s_waitcnt lgkmcnt(0)
    s_add_u32 s3, s3, 1
    s_waitcnt vmcnt(2)
    v_lshlrev_b32 v12, 16, v8
    v_and_b32 v13, 0xffff0000, v8
    v_lshlrev_b32 v14, 16, v9
    v_and_b32 v15, 0xffff0000, v9
    v_lshlrev_b32 v16, 16, v10
    v_and_b32 v17, 0xffff0000, v10
    v_lshlrev_b32 v18, 16, v11
    v_and_b32 v19, 0xffff0000, v11
    v_readfirstlane_b32 s14, v12
    s_nop 1
    v_pk_add_f32 v[12:13], v[12:13], s[14:15] op_sel_hi:[1,0] neg_lo:[0,1] neg_hi:[0,1]
    v_pk_add_f32 v[14:15], v[14:15], s[14:15] op_sel_hi:[1,0] neg_lo:[0,1] neg_hi:[0,1]
    v_pk_add_f32 v[16:17], v[16:17], s[14:15] op_sel_hi:[1,0] neg_lo:[0,1] neg_hi:[0,1]
    v_pk_add_f32 v[18:19], v[18:19], s[14:15] op_sel_hi:[1,0] neg_lo:[0,1] neg_hi:[0,1]
    v_pk_add_f32 v[20:21], v[12:13], v[14:15]
    v_pk_mul_f32 v[22:23], v[12:13], v[12:13]
    v_pk_add_f32 v[24:25], v[16:17], v[18:19]
    v_pk_fma_f32 v[22:23], v[14:15], v[14:15], v[22:23]
    v_pk_add_f32 v[20:21], v[20:21], v[24:25]
    v_pk_fma_f32 v[22:23], v[16:17], v[16:17], v[22:23]
    v_add_f32 v20, v20, v21
    v_pk_fma_f32 v[22:23], v[18:19], v[18:19], v[22:23]
    v_add_f32 v22, v22, v23
    v_add_f32_dpp v20, v20, v20 row_shr:1 row_mask:0xf bank_mask:0xf bound_ctrl:0
    s_nop 0
    v_add_f32_dpp v22, v22, v22 row_shr:1 row_mask:0xf bank_mask:0xf bound_ctrl:0
    v_add_f32_dpp v20, v20, v20 row_shr:2 row_mask:0xf bank_mask:0xf bound_ctrl:0
    s_nop 0
    v_add_f32_dpp v22, v22, v22 row_shr:2 row_mask:0xf bank_mask:0xf bound_ctrl:0
    v_add_f32_dpp v20, v20, v20 row_shr:4 row_mask:0xf bank_mask:0xf bound_ctrl:0
    s_nop 0
    v_add_f32_dpp v22, v22, v22 row_shr:4 row_mask:0xf bank_mask:0xf bound_ctrl:0
    v_add_f32_dpp v20, v20, v20 row_shr:8 row_mask:0xf bank_mask:0xf bound_ctrl:0
    s_nop 0
    v_add_f32_dpp v22, v22, v22 row_shr:8 row_mask:0xf bank_mask:0xf bound_ctrl:0
    v_add_f32_dpp v20, v20, v20 row_bcast:15 row_mask:0xa bank_mask:0xf
    s_nop 0
    v_add_f32_dpp v22, v22, v22 row_bcast:15 row_mask:0xa bank_mask:0xf
    v_add_f32_dpp v20, v20, v20 row_bcast:31 row_mask:0xc bank_mask:0xf
    s_nop 0
    v_add_f32_dpp v22, v22, v22 row_bcast:31 row_mask:0xc bank_mask:0xf
    v_mul_f32 v20, 0x3b000000, v20
    v_mul_f32 v22, 0x3b000000, v22
    v_fma_f32 v22, -v20, v20, v22
    v_add_f32 v22, 0x3727c5ac, v22
    v_rsq_f32 v22, v22
    v_readlane_b32 s14, v20, 63
    v_readlane_b32 s16, v22, 63
    s_nop 0
    v_pk_add_f32 v[12:13], v[12:13], s[14:15] op_sel_hi:[1,0] neg_lo:[0,1] neg_hi:[0,1]
    v_pk_add_f32 v[14:15], v[14:15], s[14:15] op_sel_hi:[1,0] neg_lo:[0,1] neg_hi:[0,1]
    v_pk_add_f32 v[16:17], v[16:17], s[14:15] op_sel_hi:[1,0] neg_lo:[0,1] neg_hi:[0,1]
    v_pk_add_f32 v[18:19], v[18:19], s[14:15] op_sel_hi:[1,0] neg_lo:[0,1] neg_hi:[0,1]
    v_pk_mul_f32 v[12:13], v[12:13], s[16:17] op_sel_hi:[1,0]
    v_pk_mul_f32 v[14:15], v[14:15], s[16:17] op_sel_hi:[1,0]
    v_pk_mul_f32 v[16:17], v[16:17], s[16:17] op_sel_hi:[1,0]
    v_pk_mul_f32 v[18:19], v[18:19], s[16:17] op_sel_hi:[1,0]
    v_add_u32 v113, 32768, v6
    ds_write_b128 v113, v[8:11]
    s_cmp_lt_u32 s10, 4
    s_cbranch_scc1 L_adaLN_cond__spectral_gfnet__glu_gated_bilinear__prompt_kernel_t0_18
    s_sub_u32 s16, s2, 32
    s_sub_u32 s19, s10, 4
    s_lshr_b32 s17, s16, 4
    s_and_b32 s18, s16, 15
    s_mul_i32 s18, s18, 114688
    s_lshl_b32 s17, s17, 8
    s_add_u32 s18, s18, s17
    s_lshl_b32 s17, s19, 6
    s_add_u32 s18, s18, s17
    v_lshrrev_b32 v113, 2, v1
    v_mul_u32_u24 v113, 3584, v113
    v_and_b32 v114, 3, v1
    v_lshlrev_b32 v114, 4, v114
    v_add_u32 v113, v113, v114
    v_add_u32 v113, s18, v113
    v_add_u32 v114, 57344, v113
    global_load_dwordx4 v[144:147], v113, s[56:57]
    global_load_dwordx4 v[148:151], v114, s[56:57]
    global_load_dwordx4 v[152:155], v113, s[60:61]
    global_load_dwordx4 v[156:159], v114, s[60:61]
    s_lshr_b32 s17, s16, 1
    s_lshl_b32 s17, s17, 14
    s_and_b32 s18, s16, 1
    s_lshl_b32 s18, s18, 9
    s_add_u32 s17, s17, s18
    s_lshl_b32 s18, s19, 7
    s_add_u32 s17, s17, s18
    v_lshrrev_b32 v112, 3, v1
    v_lshlrev_b32 v112, 10, v112
    v_and_b32 v113, 7, v1
    v_lshlrev_b32 v113, 4, v113
    v_add_u32 v112, v112, v113
    v_add_u32 v112, s17, v112
    v_add_u32 v113, 8192, v112
    global_load_dwordx4 v[160:163], v112, s[44:45]
    global_load_dwordx4 v[164:167], v113, s[44:45]
    s_waitcnt vmcnt(6)
    s_branch L_adaLN_cond__spectral_gfnet__glu_gated_bilinear__prompt_kernel_t1_19
L_adaLN_cond__spectral_gfnet__glu_gated_bilinear__prompt_kernel_t0_18:
    s_waitcnt vmcnt(0)
L_adaLN_cond__spectral_gfnet__glu_gated_bilinear__prompt_kernel_t1_19:
    v_min_u32 v113, 256, v0
    v_lshlrev_b32 v113, 4, v113
    v_add_u32 v113, 140288, v113
    ds_write_b128 v113, v[96:99]
    ds_write_b128 v113, v[100:103] offset:4128
    v_and_b32 v113, 31, v0
    v_lshlrev_b32 v113, 2, v113
    v_add_u32 v113, 163072, v113
    v_mov_b32 v114, 0
    ds_write_b32 v113, v114
    s_cmp_ge_u32 s10, 4
    s_cbranch_scc1 L_adaLN_cond__spectral_gfnet__glu_gated_bilinear__prompt_kernel_wv_20
    s_mul_i32 s16, s2, 8320
    s_add_u32 s16, s16, 1048576
    v_add_u32 v112, s16, v6
    v_add_u32 v113, 4096, v112
    global_store_dwordx4 v112, v[108:111], s[6:7] sc1
    global_store_dwordx4 v113, v[108:111], s[6:7] sc1
    s_cmp_lg_u32 s10, 0
    s_cbranch_scc1 L_adaLN_cond__spectral_gfnet__glu_gated_bilinear__prompt_kernel_cs_21
    s_add_u32 s16, s16, 8192
    v_add_u32 v112, s16, v3
    s_mov_b64 exec, 3
    global_store_dwordx4 v112, v[108:111], s[6:7] sc1
    s_mov_b64 exec, -1
L_adaLN_cond__spectral_gfnet__glu_gated_bilinear__prompt_kernel_cs_21:
L_adaLN_cond__spectral_gfnet__glu_gated_bilinear__prompt_kernel_wv_20:
    s_waitcnt lgkmcnt(0)
    s_barrier
    s_cmp_ge_u32 s10, 4
    s_cbranch_scc1 L_adaLN_cond__spectral_gfnet__glu_gated_bilinear__prompt_kernel_wv_22
    v_add_u32 v126, 256, v0
    v_lshrrev_b32 v114, 1, v0
    v_and_b32 v115, 1, v0
    v_mul_u32_u24 v116, 2056, v115
    v_lshlrev_b32 v117, 1, v114
    v_add_u32 v116, v116, v117
    v_add_u32 v116, 140288, v116
    ds_read_u16 v100, v116 offset:0
    ds_read_u16 v104, v116 offset:4128
    ds_read_u16 v101, v116 offset:514
    ds_read_u16 v105, v116 offset:4642
    ds_read_u16 v102, v116 offset:1028
    ds_read_u16 v106, v116 offset:5156
    ds_read_u16 v103, v116 offset:1542
    ds_read_u16 v107, v116 offset:5670
    s_mul_i32 s18, s2, 8320
    s_add_u32 s18, s18, 7340032
    v_lshlrev_b32 v113, 4, v0
    v_add_u32 v113, s18, v113
    s_waitcnt lgkmcnt(0)
    v_lshl_or_b32 v100, v104, 16, v100
    v_lshl_or_b32 v101, v105, 16, v101
    v_lshl_or_b32 v102, v106, 16, v102
    v_lshl_or_b32 v103, v107, 16, v103
    global_store_dwordx4 v113, v[100:103], s[6:7] sc1
    v_lshrrev_b32 v114, 1, v126
    v_and_b32 v115, 1, v126
    v_mul_u32_u24 v116, 2056, v115
    v_lshlrev_b32 v117, 1, v114
    v_add_u32 v116, v116, v117
    v_add_u32 v116, 140288, v116
    ds_read_u16 v80, v116 offset:0
    ds_read_u16 v84, v116 offset:4128
    ds_read_u16 v81, v116 offset:514
    ds_read_u16 v85, v116 offset:4642
    ds_read_u16 v82, v116 offset:1028
    ds_read_u16 v86, v116 offset:5156
    ds_read_u16 v83, v116 offset:1542
    ds_read_u16 v87, v116 offset:5670
    s_mul_i32 s18, s2, 8320
    s_add_u32 s18, s18, 7340032
    v_lshlrev_b32 v113, 4, v126
    v_add_u32 v113, s18, v113
    s_waitcnt lgkmcnt(0)
    v_lshl_or_b32 v80, v84, 16, v80
    v_lshl_or_b32 v81, v85, 16, v81
    v_lshl_or_b32 v82, v86, 16, v82
    v_lshl_or_b32 v83, v87, 16, v83
    global_store_dwordx4 v113, v[80:83], s[6:7] sc1
    s_cmp_lg_u32 s10, 0
    s_cbranch_scc1 L_adaLN_cond__spectral_gfnet__glu_gated_bilinear__prompt_kernel_ny_23
    v_min_u32 v117, 1, v1
    v_mul_u32_u24 v117, 2056, v117
    v_add_u32 v117, 140288, v117
    ds_read_u16 v120, v117 offset:512
    ds_read_u16 v124, v117 offset:4640
    ds_read_u16 v121, v117 offset:1026
    ds_read_u16 v125, v117 offset:5154
    ds_read_u16 v122, v117 offset:1540
    ds_read_u16 v126, v117 offset:5668
    ds_read_u16 v123, v117 offset:2054
    ds_read_u16 v127, v117 offset:6182
    s_mul_i32 s18, s2, 8320
    s_add_u32 s18, s18, 7348224
    v_add_u32 v113, s18, v3
    s_waitcnt lgkmcnt(0)
    v_lshl_or_b32 v120, v124, 16, v120
    v_lshl_or_b32 v121, v125, 16, v121
    v_lshl_or_b32 v122, v126, 16, v122
    v_lshl_or_b32 v123, v127, 16, v123
    s_mov_b64 exec, 3
    global_store_dwordx4 v113, v[120:123], s[6:7] sc1
    s_mov_b64 exec, -1
L_adaLN_cond__spectral_gfnet__glu_gated_bilinear__prompt_kernel_ny_23:
L_adaLN_cond__spectral_gfnet__glu_gated_bilinear__prompt_kernel_wv_22:
    s_cmp_lt_u32 s10, 4
    s_cbranch_scc1 L_adaLN_cond__spectral_gfnet__glu_gated_bilinear__prompt_kernel_wv_24
    s_sub_u32 s41, s10, 4
    s_lshl_b32 s41, s41, 1
    s_add_u32 s43, s41, 1
    s_waitcnt vmcnt(0)
    s_sub_u32 s19, s10, 4
    s_lshl_b32 s17, s19, 6
    v_lshrrev_b32 v112, 2, v1
    v_mul_u32_u24 v112, 288, v112
    v_and_b32 v113, 3, v1
    v_lshlrev_b32 v113, 4, v113
    v_add_u32 v112, v112, v113
    v_add_u32 v112, s17, v112
    ds_write_b128 v112, v[144:147] offset:0
    ds_write_b128 v112, v[148:151] offset:4608
    ds_write_b128 v112, v[152:155] offset:9344
    ds_write_b128 v112, v[156:159] offset:13952
    s_lshl_b32 s17, s19, 7
    v_lshrrev_b32 v112, 3, v1
    v_mul_u32_u24 v112, 576, v112
    v_and_b32 v113, 7, v1
    v_lshlrev_b32 v113, 4, v113
    v_add_u32 v112, v112, v113
    v_add_u32 v112, s17, v112
    ds_write_b128 v112, v[160:163] offset:20480
    ds_write_b128 v112, v[164:167] offset:25088
    v_lshrrev_b32 v112, 5, v1
    v_lshlrev_b32 v112, 2, v112
    v_bfe_u32 v113, v1, 2, 2
    v_add_u32 v112, v112, v113
    v_mul_u32_u24 v118, 288, v112
    v_mul_u32_u24 v112, 576, v112
    v_and_b32 v113, 3, v1
    v_lshlrev_b32 v113, 3, v113
    v_add_u32 v112, v112, v113
    v_add_u32 v118, v118, v113
    v_bfe_u32 v113, v1, 4, 1
    v_mul_u32_u24 v114, 9344, v113
    v_add_u32 v118, v118, v114
    v_lshlrev_b32 v113, 5, v113
    v_add_u32 v112, v112, v113
    s_lshl_b32 s16, s41, 6
    s_add_u32 s16, s16, 20480
    v_add_u32 v112, s16, v112
    s_lshl_b32 s16, s41, 5
    v_add_u32 v118, s16, v118
    ds_read_b64_tr_b16 v[96:97], v112 offset:0
    ds_read_b64_tr_b16 v[98:99], v112 offset:4608
    ds_read_b64_tr_b16 v[144:145], v118 offset:0
    ds_read_b64_tr_b16 v[146:147], v118 offset:4608
    ds_read_b64_tr_b16 v[148:149], v118 offset:2304
    ds_read_b64_tr_b16 v[150:151], v118 offset:6912
    s_sub_u32 s17, s2, 32
    s_and_b32 s18, s17, 1
    s_lshl_b32 s18, s18, 2
    s_lshr_b32 s19, s41, 1
    s_add_u32 s18, s18, s19
    s_mul_i32 s18, s18, 112
    s_lshr_b32 s19, s17, 1
    s_add_u32 s18, s18, s19
    s_lshl_b32 s18, s18, 1
    s_and_b32 s19, s41, 1
    s_add_u32 s18, s18, s19
    s_lshl_b32 s18, s18, 10
    s_add_u32 s18, s18, 20971520
    v_add_u32 v112, s18, v3
    s_lshr_b32 s18, s17, 4
    s_lshl_b32 s18, s18, 3
    s_add_u32 s18, s18, s41
    s_lshl_b32 s18, s18, 5
    s_and_b32 s19, s17, 15
    s_lshl_b32 s19, s19, 1
    s_add_u32 s18, s18, s19
    s_lshl_b32 s18, s18, 10
    s_add_u32 s18, s18, 16777216
    v_add_u32 v118, s18, v3
    s_waitcnt lgkmcnt(0)
    global_store_dwordx4 v118, v[144:147], s[6:7] sc1
    global_store_dwordx4 v118, v[148:151], s[6:7] offset:1024 sc1
    global_store_dwordx4 v112, v[96:99], s[6:7] sc1
    v_lshrrev_b32 v112, 5, v1
    v_lshlrev_b32 v112, 2, v112
    v_bfe_u32 v113, v1, 2, 2
    v_add_u32 v112, v112, v113
    v_mul_u32_u24 v118, 288, v112
    v_mul_u32_u24 v112, 576, v112
    v_and_b32 v113, 3, v1
    v_lshlrev_b32 v113, 3, v113
    v_add_u32 v112, v112, v113
    v_add_u32 v118, v118, v113
    v_bfe_u32 v113, v1, 4, 1
    v_mul_u32_u24 v114, 9344, v113
    v_add_u32 v118, v118, v114
    v_lshlrev_b32 v113, 5, v113
    v_add_u32 v112, v112, v113
    s_lshl_b32 s16, s43, 6
    s_add_u32 s16, s16, 20480
    v_add_u32 v112, s16, v112
    s_lshl_b32 s16, s43, 5
    v_add_u32 v118, s16, v118
    ds_read_b64_tr_b16 v[100:101], v112 offset:0
    ds_read_b64_tr_b16 v[102:103], v112 offset:4608
    ds_read_b64_tr_b16 v[152:153], v118 offset:0
    ds_read_b64_tr_b16 v[154:155], v118 offset:4608
    ds_read_b64_tr_b16 v[156:157], v118 offset:2304
    ds_read_b64_tr_b16 v[158:159], v118 offset:6912
    s_sub_u32 s17, s2, 32
    s_and_b32 s18, s17, 1
    s_lshl_b32 s18, s18, 2
    s_lshr_b32 s19, s43, 1
    s_add_u32 s18, s18, s19
    s_mul_i32 s18, s18, 112
    s_lshr_b32 s19, s17, 1
    s_add_u32 s18, s18, s19
    s_lshl_b32 s18, s18, 1
    s_and_b32 s19, s43, 1
    s_add_u32 s18, s18, s19
    s_lshl_b32 s18, s18, 10
    s_add_u32 s18, s18, 20971520
    v_add_u32 v112, s18, v3
    s_lshr_b32 s18, s17, 4
    s_lshl_b32 s18, s18, 3
    s_add_u32 s18, s18, s43
    s_lshl_b32 s18, s18, 5
    s_and_b32 s19, s17, 15
    s_lshl_b32 s19, s19, 1
    s_add_u32 s18, s18, s19
    s_lshl_b32 s18, s18, 10
    s_add_u32 s18, s18, 16777216
    v_add_u32 v118, s18, v3
    s_waitcnt lgkmcnt(0)
    global_store_dwordx4 v118, v[152:155], s[6:7] sc1
    global_store_dwordx4 v118, v[156:159], s[6:7] offset:1024 sc1
    global_store_dwordx4 v112, v[100:103], s[6:7] sc1
    s_lshl_b32 s16, s34, 13
    s_add_u32 s16, s16, 4194304
    v_add_u32 v112, s16, v6
    v_subrev_u32 v113, 4096, v112
    global_store_dwordx4 v113, v[108:111], s[6:7] sc1
    global_store_dwordx4 v112, v[108:111], s[6:7] sc1
    s_cmp_lg_u32 s2, 0
    s_cbranch_scc1 L_adaLN_cond__spectral_gfnet__glu_gated_bilinear__prompt_kernel_cs_25
    v_add_u32 v112, 6291456, v6
    v_subrev_u32 v113, 4096, v112
    global_store_dwordx4 v113, v[108:111], s[6:7] sc1
    global_store_dwordx4 v112, v[108:111], s[6:7] sc1
L_adaLN_cond__spectral_gfnet__glu_gated_bilinear__prompt_kernel_cs_25:
    v_subrev_u32 v115, 256, v0
    s_lshr_b32 s16, s11, 1
    s_lshl_b32 s16, s16, 17
    s_and_b32 s17, s11, 1
    s_lshl_b32 s17, s17, 1
    s_lshr_b32 s18, s12, 2
    s_add_u32 s17, s17, s18
    s_lshl_b32 s17, s17, 15
    s_add_u32 s16, s16, s17
    s_and_b32 s18, s12, 3
    s_lshl_b32 s18, s18, 7
    s_add_u32 s16, s16, s18
    s_add_u32 s16, s16, 12582912
    v_lshrrev_b32 v113, 3, v115
    v_lshlrev_b32 v113, 9, v113
    v_and_b32 v114, 7, v115
    v_lshlrev_b32 v114, 4, v114
    v_add_u32 v113, v113, v114
    v_add_u32 v113, s16, v113
    global_store_dwordx4 v113, v[108:111], s[6:7] sc1
    v_add_u32 v114, 16384, v113
    global_store_dwordx4 v114, v[108:111], s[6:7] sc1
L_adaLN_cond__spectral_gfnet__glu_gated_bilinear__prompt_kernel_wv_24:
L_adaLN_cond__spectral_gfnet__glu_gated_bilinear__prompt_kernel_join0_2:
    s_cmp_ge_u32 s10, 4
    s_cbranch_scc1 L_adaLN_cond__spectral_gfnet__glu_gated_bilinear__prompt_kernel_wv_26
    v_add_u32 v112, 20480, v6
    global_load_dwordx4 v[116:119], v112, s[6:7] sc1
    s_waitcnt vmcnt(0)
    v_mov_b32 v120, 163120
    v_mov_b32 v121, 1
    s_mov_b64 exec, 1
    ds_add_rtn_u32 v122, v120, v121
    s_lshl_b32 s16, s2, 7
    s_add_u32 s16, s16, 65536
    v_mov_b32 v120, s16
    v_mov_b32 v121, s3
    s_waitcnt lgkmcnt(0)
    v_cmp_eq_u32 vcc, 3, v122
    s_cbranch_vccz L_adaLN_cond__spectral_gfnet__glu_gated_bilinear__prompt_kernel_sf_28
    global_store_dword v120, v121, s[6:7] sc1
L_adaLN_cond__spectral_gfnet__glu_gated_bilinear__prompt_kernel_sf_28:
    s_mov_b64 exec, -1
    v_xor_b32 v113, s3, v117
    v_xor_b32 v114, s3, v119
    v_or_b32 v113, v113, v114
    v_cmp_ne_u32 vcc, 0, v113
    s_cbranch_vccz L_adaLN_cond__spectral_gfnet__glu_gated_bilinear__prompt_kernel_mok_27
    s_mov_b32 s97, 0
L_adaLN_cond__spectral_gfnet__glu_gated_bilinear__prompt_kernel_modp_29:
    global_load_dwordx4 v[116:119], v112, s[6:7] sc1
    s_waitcnt vmcnt(0)
    v_xor_b32 v113, s3, v117
    v_xor_b32 v114, s3, v119
    v_or_b32 v113, v113, v114
    v_cmp_ne_u32 vcc, 0, v113
    s_cbranch_vccz L_adaLN_cond__spectral_gfnet__glu_gated_bilinear__prompt_kernel_modp_29_x
    s_add_u32 s97, s97, 1
    s_cmp_lt_u32 s97, s96
    s_cbranch_scc1 L_adaLN_cond__spectral_gfnet__glu_gated_bilinear__prompt_kernel_modp_29
    s_mov_b32 s96, 0
L_adaLN_cond__spectral_gfnet__glu_gated_bilinear__prompt_kernel_modp_29_x:
L_adaLN_cond__spectral_gfnet__glu_gated_bilinear__prompt_kernel_mok_27:
    v_lshlrev_b32 v112, 3, v0
    v_add_u32 v112, 152576, v112
    v_mov_b32 v117, v118
    ds_write_b64 v112, v[116:117]
L_adaLN_cond__spectral_gfnet__glu_gated_bilinear__prompt_kernel_wv_26:
    s_waitcnt lgkmcnt(0)
    s_barrier
    v_and_b32 v93, 255, v0
    v_lshlrev_b32 v93, 7, v93
    v_add_u32 v93, 65536, v93
    v_mov_b32 v92, 0
    s_cmp_eq_u32 s2, 0
    s_cselect_b32 s16, 8, 4
    s_cmp_ge_u32 s10, s16
    s_cbranch_scc1 L_adaLN_cond__spectral_gfnet__glu_gated_bilinear__prompt_kernel_fae_30
    global_load_dword v92, v93, s[6:7] sc1
L_adaLN_cond__spectral_gfnet__glu_gated_bilinear__prompt_kernel_fae_30:
    v_add_u32 v2, 152576, v3
    ds_read_b128 v[20:23], v2
    ds_read_b128 v[24:27], v2 offset:1024
    s_mul_i32 s18, s10, 1280
    s_add_u32 s18, s18, 131072
    v_lshrrev_b32 v7, 4, v1
    v_lshlrev_b32 v28, 5, v7
    v_add_u32 v28, v28, v3
    v_add_u32 v28, s18, v28
    v_mul_u32_u24 v29, 288, v7
    v_bfe_u32 v30, v1, 2, 2
    v_lshlrev_b32 v30, 6, v30
    v_add_u32 v29, v29, v30
    v_and_b32 v30, 3, v1
    v_lshlrev_b32 v30, 3, v30
    v_add_u32 v29, v29, v30
    v_add_u32 v29, s18, v29
    s_waitcnt lgkmcnt(0)
    v_lshlrev_b32 v76, 16, v20
    v_and_b32 v77, 0xffff0000, v20
    v_lshlrev_b32 v84, 16, v24
    v_and_b32 v85, 0xffff0000, v24
    v_lshlrev_b32 v78, 16, v21
    v_and_b32 v79, 0xffff0000, v21
    v_lshlrev_b32 v86, 16, v25
    v_and_b32 v87, 0xffff0000, v25
    v_lshlrev_b32 v80, 16, v22
    v_and_b32 v81, 0xffff0000, v22
    v_lshlrev_b32 v88, 16, v26
    v_and_b32 v89, 0xffff0000, v26
    v_lshlrev_b32 v82, 16, v23
    v_and_b32 v83, 0xffff0000, v23
    v_lshlrev_b32 v90, 16, v27
    v_and_b32 v91, 0xffff0000, v27
    v_pk_fma_f32 v[12:13], v[12:13], v[84:85], v[76:77]
    v_pk_fma_f32 v[14:15], v[14:15], v[86:87], v[78:79]
    v_pk_fma_f32 v[16:17], v[16:17], v[88:89], v[80:81]
    v_pk_fma_f32 v[18:19], v[18:19], v[90:91], v[82:83]
    v_cvt_pk_bf16_f32 v8, v12, v13
    v_cvt_pk_bf16_f32 v9, v14, v15
    v_cvt_pk_bf16_f32 v10, v16, v17
    v_cvt_pk_bf16_f32 v11, v18, v19
    ds_write_b128 v28, v[8:11]
    s_waitcnt lgkmcnt(0)
    ds_read_b64_tr_b16 v[12:13], v29
    ds_read_b64_tr_b16 v[14:15], v29 offset:32
    v_and_b32 v32, 15, v1
    v_cmp_eq_u32 vcc, 0, v32
    v_mov_b32 v33, 0x3f80
    v_mov_b32 v34, 0xbf80
    v_cndmask_b32 v28, 0, v33, vcc
    v_cndmask_b32 v29, 0, v34, vcc
    v_mov_b32 v30, v28
    v_mov_b32 v31, v29
    s_waitcnt lgkmcnt(0)
    v_mfma_f32_16x16x16_bf16 v[96:99], v[12:13], v[72:73], 0
    v_mfma_f32_16x16x16_bf16 v[100:103], v[12:13], v[74:75], 0
    v_mfma_f32_16x16x16_bf16 v[104:107], v[14:15], v[72:73], 0
    v_mfma_f32_16x16x16_bf16 v[108:111], v[14:15], v[74:75], 0
    s_nop 4
    v_pk_mul_f32 v[112:113], v[96:97], v[40:41]
    v_pk_mul_f32 v[120:121], v[100:101], v[40:41]
    v_pk_fma_f32 v[112:113], v[100:101], v[44:45], v[112:113]
    v_pk_fma_f32 v[120:121], v[96:97], v[44:45], v[120:121] neg_lo:[1,0,0] neg_hi:[1,0,0]
    v_pk_mul_f32 v[114:115], v[98:99], v[42:43]
    v_pk_mul_f32 v[122:123], v[102:103], v[42:43]
    v_pk_fma_f32 v[114:115], v[102:103], v[46:47], v[114:115]
    v_pk_fma_f32 v[122:123], v[98:99], v[46:47], v[122:123] neg_lo:[1,0,0] neg_hi:[1,0,0]
    v_pk_mul_f32 v[116:117], v[104:105], v[48:49]
    v_pk_mul_f32 v[124:125], v[108:109], v[48:49]
    v_pk_fma_f32 v[116:117], v[108:109], v[52:53], v[116:117]
    v_pk_fma_f32 v[124:125], v[104:105], v[52:53], v[124:125] neg_lo:[1,0,0] neg_hi:[1,0,0]
    v_pk_mul_f32 v[118:119], v[106:107], v[50:51]
    v_pk_mul_f32 v[126:127], v[110:111], v[50:51]
    v_pk_fma_f32 v[118:119], v[110:111], v[54:55], v[118:119]
    v_pk_fma_f32 v[126:127], v[106:107], v[54:55], v[126:127] neg_lo:[1,0,0] neg_hi:[1,0,0]
    v_cvt_pk_bf16_f32 v12, v112, v120
    v_cvt_pk_bf16_f32 v13, v113, v121
    v_cvt_pk_bf16_f32 v14, v114, v122
    v_cvt_pk_bf16_f32 v15, v115, v123
    v_cvt_pk_bf16_f32 v16, v116, v124
    v_cvt_pk_bf16_f32 v17, v117, v125
    v_cvt_pk_bf16_f32 v18, v118, v126
    v_cvt_pk_bf16_f32 v19, v119, v127
    v_mfma_f32_16x16x32_bf16 v[96:99], v[56:59], v[12:15], 0
    v_mfma_f32_16x16x32_bf16 v[100:103], v[60:63], v[12:15], 0
    v_mfma_f32_16x16x32_bf16 v[104:107], v[28:31], v[12:15], 0
    v_mfma_f32_16x16x32_bf16 v[96:99], v[64:67], v[16:19], v[96:99]
    v_mfma_f32_16x16x32_bf16 v[100:103], v[68:71], v[16:19], v[100:103]
    v_mfma_f32_16x16x32_bf16 v[104:107], v[28:31], v[16:19], v[104:107]
    s_mul_i32 s18, s10, 1312
    s_add_u32 s18, s18, 141312
    v_and_b32 v32, 15, v1
    v_mul_u32_u24 v33, 80, v7
    v_add_u32 v32, v32, v33
    v_lshlrev_b32 v32, 2, v32
    v_add_u32 v32, s18, v32
    v_cvt_pk_bf16_f32 v8, v96, v100
    v_cvt_pk_bf16_f32 v9, v97, v101
    v_cvt_pk_bf16_f32 v10, v98, v102
    v_cvt_pk_bf16_f32 v11, v99, v103
    v_cvt_pk_bf16_f32 v33, v104, 0
    ds_write_b32 v32, v8 offset:0
    ds_write_b32 v32, v9 offset:64
    ds_write_b32 v32, v10 offset:128
    ds_write_b32 v32, v11 offset:192
    v_mov_b32 v34, s18
    s_mov_b64 exec, 1
    ds_write_b32 v34, v33 offset:1280
    s_mov_b64 exec, -1
    s_waitcnt lgkmcnt(0)
    s_barrier
    v_lshrrev_b32 v8, 1, v0
    v_lshrrev_b32 v9, 6, v8
    v_lshlrev_b32 v9, 4, v9
    v_add_u32 v9, v9, v8
    v_lshlrev_b32 v9, 2, v9
    v_and_b32 v10, 1, v0
    v_mul_u32_u24 v11, 5248, v10
    v_add_u32 v9, v9, v11
    v_add_u32 v9, 141312, v9
    ds_read_b32 v12, v9 offset:0
    ds_read_b32 v13, v9 offset:1312
    ds_read_b32 v14, v9 offset:2624
    ds_read_b32 v15, v9 offset:3936
    v_min_u32 v11, 1, v0
    v_mul_u32_u24 v11, 5248, v11
    v_add_u32 v11, 142592, v11
    ds_read_b32 v16, v11 offset:0
    ds_read_b32 v17, v11 offset:1312
    ds_read_b32 v18, v11 offset:2624
    ds_read_b32 v19, v11 offset:3936
    s_mul_i32 s18, s2, 8320
    s_add_u32 s18, s18, 1048576
    v_add_u32 v8, s18, v6
    v_add_u32 v20, 8192, v8
    s_waitcnt lgkmcnt(0)
    global_store_dwordx4 v8, v[12:15], s[6:7] sc1
    s_cmp_lg_u32 s10, 0
    s_cbranch_scc1 L_adaLN_cond__spectral_gfnet__glu_gated_bilinear__prompt_kernel_ny_31
    s_mov_b64 exec, 3
    global_store_dwordx4 v20, v[16:19], s[6:7] sc1
    s_mov_b64 exec, -1
L_adaLN_cond__spectral_gfnet__glu_gated_bilinear__prompt_kernel_ny_31:
    s_cmp_lt_u32 s10, 4
    s_cbranch_scc1 L_adaLN_cond__spectral_gfnet__glu_gated_bilinear__prompt_kernel_p2act_32
    s_waitcnt vmcnt(1)
    v_mov_b32 v112, 163136
    v_mov_b32 v113, 1
    s_mov_b64 exec, 1
    ds_add_rtn_u32 v114, v112, v113
    s_lshl_b32 s16, s2, 7
    s_add_u32 s16, s16, 196608
    v_mov_b32 v112, s16
    v_mov_b32 v113, s3
    s_waitcnt lgkmcnt(0)
    v_cmp_eq_u32 vcc, 3, v114
    s_cbranch_vccz L_adaLN_cond__spectral_gfnet__glu_gated_bilinear__prompt_kernel_sf_37
    global_store_dword v112, v113, s[6:7] sc1
L_adaLN_cond__spectral_gfnet__glu_gated_bilinear__prompt_kernel_sf_37:
    s_mov_b64 exec, -1
    s_cmp_eq_u32 s2, 0
    s_cbranch_scc1 L_adaLN_cond__spectral_gfnet__glu_gated_bilinear__prompt_kernel_p2act0_34
    v_and_b32 v2, 15, v1
    v_lshrrev_b32 v3, 4, v1
    s_cmp_lt_u32 s2, 32
    s_cbranch_scc1 L_adaLN_cond__spectral_gfnet__glu_gated_bilinear__prompt_kernel_svcm_35
    s_lshl_b32 s16, s37, 4
    s_add_u32 s16, s16, 32
    s_lshl_b32 s16, s16, 7
    s_add_u32 s16, s16, 196608
    v_and_b32 v109, 15, v1
    v_lshlrev_b32 v109, 7, v109
    v_add_u32 v109, s16, v109
    global_load_dword v108, v109, s[6:7] sc1
    s_lshl_b32 s25, s37, 3
    s_add_u32 s25, s25, s10
    s_lshl_b32 s25, s25, 15
    s_add_u32 s25, s25, 16777216
    s_add_u32 s40, s6, s25
    s_addc_u32 s41, s7, 0
    s_mov_b32 s42, 32768
    s_mov_b32 s43, 0x20000
    v_lshrrev_b32 v6, 3, v2
    v_lshlrev_b32 v6, 13, v6
    v_lshlrev_b32 v7, 19, v3
    v_add_u32 v6, v6, v7
    v_and_b32 v7, 7, v2
    v_lshlrev_b32 v7, 2, v7
    v_add_u32 v6, v6, v7
    s_lshl_b32 s13, s10, 14
    s_lshr_b32 s14, s12, 1
    s_lshl_b32 s14, s14, 11
    s_and_b32 s15, s11, 7
    s_lshl_b32 s15, s15, 8
    s_add_u32 s14, s14, s15
    s_lshr_b32 s15, s11, 3
    s_lshl_b32 s15, s15, 6
    s_add_u32 s14, s14, s15
    s_and_b32 s15, s12, 1
    s_lshl_b32 s15, s15, 5
    s_add_u32 s14, s14, s15
    s_add_u32 s14, s14, 4194304
    s_add_u32 s13, s13, s14
    v_add_u32 v6, s13, v6
    s_lshl_b32 s15, s10, 2
    s_add_u32 s15, s15, s14
    s_add_u32 s15, s15, 2097152
    v_mov_b32 v7, s15
    s_lshl_b32 s17, s10, 10
    s_add_u32 s17, s17, 32768
    v_lshlrev_b32 v8, 6, v2
    v_lshlrev_b32 v9, 3, v3
    v_add_u32 v8, v8, v9
    v_lshlrev_b32 v10, 1, v8
    v_add_u32 v9, s17, v8
    v_add_u32 v10, 40960, v10
    ds_read_b64 v[22:23], v9
    ds_read_b64 v[24:25], v9 offset:32
    s_add_u32 s20, s6, 0
    s_addc_u32 s21, s7, 0
    s_add_u32 s22, s6, 131072
    s_addc_u32 s23, s7, 0
    s_add_u32 s24, s6, 262144
    s_addc_u32 s25, s7, 0
    s_add_u32 s26, s6, 393216
    s_addc_u32 s27, s7, 0
    v_cvt_f32_u32 v12, v1
    v_mul_f32 v12, 0x3c800000, v12
    v_cos_f32 v13, v12
    v_sin_f32 v12, v12
    s_nop 0
    v_cvt_pk_bf16_f32 v4, v13, v12
    s_mov_b32 s18, 0x8000
    v_lshlrev_b32 v12, 3, v2
    v_add_u32 v12, 0, v12
    v_lshlrev_b32 v13, 2, v3
    v_mul_u32_u24 v13, v13, v12
    v_mad_u32_u24 v64, v12, 0, v13
    v_mad_u32_u24 v65, v12, 1, v13
    v_mad_u32_u24 v66, v12, 2, v13
    v_mad_u32_u24 v67, v12, 3, v13
    v_lshlrev_b32 v12, 3, v2
    v_add_u32 v12, 128, v12
    v_lshlrev_b32 v13, 2, v3
    v_mul_u32_u24 v13, v13, v12
    v_mad_u32_u24 v68, v12, 0, v13
    v_mad_u32_u24 v69, v12, 1, v13
    v_mad_u32_u24 v70, v12, 2, v13
    v_mad_u32_u24 v71, v12, 3, v13
    v_lshlrev_b32 v12, 4, v2
    v_lshlrev_b32 v13, 2, v3
    v_mul_u32_u24 v13, v13, v12
    v_mad_u32_u24 v76, v12, 0, v13
    v_mad_u32_u24 v77, v12, 1, v13
    v_mad_u32_u24 v78, v12, 2, v13
    v_mad_u32_u24 v79, v12, 3, v13
    ds_bpermute_b32 v56, v64, v4
    ds_bpermute_b32 v57, v65, v4
    ds_bpermute_b32 v58, v66, v4
    ds_bpermute_b32 v59, v67, v4
    ds_bpermute_b32 v60, v68, v4
    ds_bpermute_b32 v61, v69, v4
    ds_bpermute_b32 v62, v70, v4
    ds_bpermute_b32 v63, v71, v4
    ds_bpermute_b32 v72, v76, v4
    ds_bpermute_b32 v73, v77, v4
    ds_bpermute_b32 v74, v78, v4
    ds_bpermute_b32 v75, v79, v4
    v_lshrrev_b32 v12, 3, v2
    s_lshl_b32 s19, s10, 1
    v_add_u32 v12, s19, v12
    v_cvt_f32_u32 v14, v12
    v_mul_f32 v14, 0x3b000000, v14
    v_lshlrev_b32 v13, 2, v3
    v_cvt_f32_u32 v13, v13
    v_mul_f32 v13, v13, v14
    s_waitcnt lgkmcnt(0)
    s_mov_b32 s19, 0x0
    v_fma_f32 v84, v14, s19, v13
    s_mov_b32 s19, 0x3f800000
    v_fma_f32 v85, v14, s19, v13
    s_mov_b32 s19, 0x40000000
    v_fma_f32 v86, v14, s19, v13
    s_mov_b32 s19, 0x40400000
    v_fma_f32 v87, v14, s19, v13
    s_mov_b32 s19, 0x41800000
    v_fma_f32 v88, v14, s19, v13
    s_mov_b32 s19, 0x41880000
    v_fma_f32 v89, v14, s19, v13
    s_mov_b32 s19, 0x41900000
    v_fma_f32 v90, v14, s19, v13
    s_mov_b32 s19, 0x41980000
    v_fma_f32 v91, v14, s19, v13
    v_cos_f32 v76, v84
    v_cos_f32 v77, v85
    v_cos_f32 v78, v86
    v_cos_f32 v79, v87
    v_cos_f32 v80, v88
    v_cos_f32 v81, v89
    v_cos_f32 v82, v90
    v_cos_f32 v83, v91
    v_sin_f32 v84, v84
    v_sin_f32 v85, v85
    v_sin_f32 v86, v86
    v_sin_f32 v87, v87
    v_sin_f32 v88, v88
    v_sin_f32 v89, v89
    v_sin_f32 v90, v90
    v_sin_f32 v91, v91
    v_alignbit_b32 v64, v56, v56, 16
    v_alignbit_b32 v65, v57, v57, 16
    v_alignbit_b32 v66, v58, v58, 16
    v_alignbit_b32 v67, v59, v59, 16
    v_alignbit_b32 v68, v60, v60, 16
    v_alignbit_b32 v69, v61, v61, 16
    v_alignbit_b32 v70, v62, v62, 16
    v_alignbit_b32 v71, v63, v63, 16
    v_xor_b32 v64, s18, v64
    v_xor_b32 v65, s18, v65
    v_xor_b32 v66, s18, v66
    v_xor_b32 v67, s18, v67
    v_xor_b32 v68, s18, v68
    v_xor_b32 v69, s18, v69
    v_xor_b32 v70, s18, v70
    v_xor_b32 v71, s18, v71
    v_and_b32 v15, 7, v2
    v_mul_u32_u24 v15, 2336, v15
    v_mul_u32_u24 v12, 144, v12
    v_add_u32 v15, v15, v12
    v_lshlrev_b32 v12, 4, v3
    v_add_u32 v15, v15, v12
    v_add_u32 v15, 131072, v15
    s_mul_i32 s19, s10, 2336
    s_add_u32 s19, s19, 131072
    v_mul_u32_u24 v21, 576, v3
    v_lshlrev_b32 v12, 2, v2
    v_add_u32 v21, v21, v12
    v_add_u32 v21, s19, v21
    v_mul_u32_u24 v26, 80, v2
    v_lshlrev_b32 v12, 3, v3
    v_add_u32 v26, v26, v12
    v_add_u32 v26, s19, v26
    v_lshrrev_b32 v27, 2, v1
    v_mul_u32_u24 v27, 80, v27
    v_and_b32 v12, 3, v1
    v_lshlrev_b32 v12, 4, v12
    v_add_u32 v27, v27, v12
    v_add_u32 v27, s19, v27
    s_lshl_b32 s16, s11, 6
    s_lshl_b32 s17, s12, 3
    s_add_u32 s16, s16, s17
    s_lshl_b32 s16, s16, 10
    s_add_u32 s16, s16, 10485760
    v_lshlrev_b32 v52, 4, v0
    v_add_u32 v52, s16, v52
    s_lshr_b32 s16, s11, 1
    s_lshl_b32 s16, s16, 17
    s_and_b32 s17, s11, 1
    s_lshl_b32 s17, s17, 1
    s_lshr_b32 s18, s12, 2
    s_add_u32 s17, s17, s18
    s_lshl_b32 s17, s17, 15
    s_add_u32 s16, s16, s17
    s_and_b32 s18, s12, 3
    s_lshl_b32 s18, s18, 7
    s_add_u32 s16, s16, s18
    s_add_u32 s16, s16, 12582912
    v_lshrrev_b32 v53, 3, v0
    v_lshlrev_b32 v53, 9, v53
    v_and_b32 v12, 7, v0
    v_lshlrev_b32 v12, 4, v12
    v_add_u32 v53, v53, v12
    v_add_u32 v53, s16, v53
    v_lshlrev_b32 v12, 2, v2
    v_add_u32 v12, v12, v3
    v_add_u32 v13, s10, v12
    v_and_b32 v13, 7, v13
    v_lshlrev_b32 v13, 4, v13
    v_lshlrev_b32 v12, 7, v12
    v_add_u32 v12, v12, v13
    v_add_u32 v54, 149760, v12
    v_lshrrev_b32 v12, 3, v0
    v_add_u32 v13, v12, v0
    v_and_b32 v13, 7, v13
    v_lshlrev_b32 v13, 4, v13
    v_lshlrev_b32 v14, 7, v12
    v_add_u32 v13, v13, v14
    v_add_u32 v55, 149760, v13
    v_lshlrev_b32 v110, 4, v1
    v_and_b32 v110, 0x300, v110
    v_lshl_add_u32 v110, v1, 4, v110
    s_waitcnt vmcnt(0)
    v_cmp_ne_u32 vcc, s3, v108
    s_cbranch_vccz L_adaLN_cond__spectral_gfnet__glu_gated_bilinear__prompt_kernel_fok_39
    s_mov_b32 s97, 0
L_adaLN_cond__spectral_gfnet__glu_gated_bilinear__prompt_kernel_c16s_40:
    global_load_dword v108, v109, s[6:7] sc1
    s_waitcnt vmcnt(0)
    v_cmp_ne_u32 vcc, s3, v108
    s_cbranch_vccz L_adaLN_cond__spectral_gfnet__glu_gated_bilinear__prompt_kernel_c16s_40_x
    s_add_u32 s97, s97, 1
    s_cmp_lt_u32 s97, s96
    s_cbranch_scc1 L_adaLN_cond__spectral_gfnet__glu_gated_bilinear__prompt_kernel_c16s_40
    s_mov_b32 s96, 0
L_adaLN_cond__spectral_gfnet__glu_gated_bilinear__prompt_kernel_c16s_40_x:
L_adaLN_cond__spectral_gfnet__glu_gated_bilinear__prompt_kernel_fok_39:
    s_mov_b32 s28, 0
    buffer_load_dwordx4 v[128:131], v110, s[40:43], s28 offen offset:0 sc1
    s_mov_b32 s28, 0
    buffer_load_dwordx4 v[132:135], v110, s[40:43], s28 offen offset:256 sc1
    s_mov_b32 s28, 0
    buffer_load_dwordx4 v[136:139], v110, s[40:43], s28 offen offset:2048 sc1
    s_mov_b32 s28, 0
    buffer_load_dwordx4 v[140:143], v110, s[40:43], s28 offen offset:2304 sc1
    s_mov_b32 s28, 4096
    buffer_load_dwordx4 v[144:147], v110, s[40:43], s28 offen offset:0 sc1
    s_mov_b32 s28, 4096
    buffer_load_dwordx4 v[148:151], v110, s[40:43], s28 offen offset:256 sc1
    s_mov_b32 s28, 4096
    buffer_load_dwordx4 v[152:155], v110, s[40:43], s28 offen offset:2048 sc1
    s_mov_b32 s28, 4096
    buffer_load_dwordx4 v[156:159], v110, s[40:43], s28 offen offset:2304 sc1
    s_mov_b32 s28, 8192
    buffer_load_dwordx4 v[160:163], v110, s[40:43], s28 offen offset:0 sc1
    s_mov_b32 s28, 8192
    buffer_load_dwordx4 v[164:167], v110, s[40:43], s28 offen offset:256 sc1
    s_mov_b32 s28, 8192
    buffer_load_dwordx4 v[168:171], v110, s[40:43], s28 offen offset:2048 sc1
    s_mov_b32 s28, 8192
    buffer_load_dwordx4 v[172:175], v110, s[40:43], s28 offen offset:2304 sc1
    s_mov_b32 s28, 12288
    buffer_load_dwordx4 v[176:179], v110, s[40:43], s28 offen offset:0 sc1
    s_mov_b32 s28, 12288
    buffer_load_dwordx4 v[180:183], v110, s[40:43], s28 offen offset:256 sc1
    s_mov_b32 s28, 12288
    buffer_load_dwordx4 v[184:187], v110, s[40:43], s28 offen offset:2048 sc1
    s_mov_b32 s28, 12288
    buffer_load_dwordx4 v[188:191], v110, s[40:43], s28 offen offset:2304 sc1
    s_mov_b32 s28, 16384
    buffer_load_dwordx4 v[192:195], v110, s[40:43], s28 offen offset:0 sc1
    s_mov_b32 s28, 16384
    buffer_load_dwordx4 v[196:199], v110, s[40:43], s28 offen offset:256 sc1
    s_mov_b32 s28, 16384
    buffer_load_dwordx4 v[200:203], v110, s[40:43], s28 offen offset:2048 sc1
    s_mov_b32 s28, 16384
    buffer_load_dwordx4 v[204:207], v110, s[40:43], s28 offen offset:2304 sc1
    s_mov_b32 s28, 20480
    buffer_load_dwordx4 v[208:211], v110, s[40:43], s28 offen offset:0 sc1
    s_mov_b32 s28, 20480
    buffer_load_dwordx4 v[212:215], v110, s[40:43], s28 offen offset:256 sc1
    s_mov_b32 s28, 20480
    buffer_load_dwordx4 v[216:219], v110, s[40:43], s28 offen offset:2048 sc1
    s_mov_b32 s28, 20480
    buffer_load_dwordx4 v[220:223], v110, s[40:43], s28 offen offset:2304 sc1
    s_mov_b32 s28, 24576
    buffer_load_dwordx4 v[224:227], v110, s[40:43], s28 offen offset:0 sc1
    s_mov_b32 s28, 24576
    buffer_load_dwordx4 v[228:231], v110, s[40:43], s28 offen offset:256 sc1
    s_mov_b32 s28, 24576
    buffer_load_dwordx4 v[232:235], v110, s[40:43], s28 offen offset:2048 sc1
    s_mov_b32 s28, 24576
    buffer_load_dwordx4 v[236:239], v110, s[40:43], s28 offen offset:2304 sc1
    s_mov_b32 s28, 28672
    buffer_load_dwordx4 v[240:243], v110, s[40:43], s28 offen offset:0 sc1
    s_mov_b32 s28, 28672
    buffer_load_dwordx4 v[244:247], v110, s[40:43], s28 offen offset:256 sc1
    s_mov_b32 s28, 28672
    buffer_load_dwordx4 v[248:251], v110, s[40:43], s28 offen offset:2048 sc1
    s_mov_b32 s28, 28672
    buffer_load_dwordx4 v[252:255], v110, s[40:43], s28 offen offset:2304 sc1
    v_and_b32 v97, 255, v0
    v_lshlrev_b32 v97, 7, v97
    v_add_u32 v97, 196608, v97
    v_and_b32 v104, 255, v0
    v_lshlrev_b32 v104, 3, v104
    v_add_u32 v104, 24576, v104
    global_load_dword v96, v97, s[6:7] sc1
    global_load_dwordx2 v[98:99], v104, s[6:7] offset:0 sc1
    global_load_dwordx2 v[100:101], v104, s[6:7] offset:2048 sc1
    v_add_u32 v105, 4096, v104
    global_load_dwordx2 v[102:103], v105, s[6:7] sc1
    s_waitcnt vmcnt(0)
    v_xor_b32 v105, s3, v96
    v_xor_b32 v106, s3, v99
    v_or_b32 v105, v105, v106
    v_xor_b32 v106, s3, v101
    v_xor_b32 v107, s3, v103
    v_or3_b32 v105, v105, v106, v107
    v_cmp_ne_u32 vcc, 0, v105
    s_cbranch_vccz L_adaLN_cond__spectral_gfnet__glu_gated_bilinear__prompt_kernel_s2ok_41
    s_mov_b32 s97, 0
L_adaLN_cond__spectral_gfnet__glu_gated_bilinear__prompt_kernel_s2r_42:
    global_load_dword v96, v97, s[6:7] sc1
    global_load_dwordx2 v[98:99], v104, s[6:7] offset:0 sc1
    global_load_dwordx2 v[100:101], v104, s[6:7] offset:2048 sc1
    v_add_u32 v105, 4096, v104
    global_load_dwordx2 v[102:103], v105, s[6:7] sc1
    s_waitcnt vmcnt(0)
    v_xor_b32 v105, s3, v96
    v_xor_b32 v106, s3, v99
    v_or_b32 v105, v105, v106
    v_xor_b32 v106, s3, v101
    v_xor_b32 v107, s3, v103
    v_or3_b32 v105, v105, v106, v107
    v_cmp_ne_u32 vcc, 0, v105
    s_cbranch_vccz L_adaLN_cond__spectral_gfnet__glu_gated_bilinear__prompt_kernel_s2r_42_x
    s_add_u32 s97, s97, 1
    s_cmp_lt_u32 s97, s96
    s_cbranch_scc1 L_adaLN_cond__spectral_gfnet__glu_gated_bilinear__prompt_kernel_s2r_42
    s_mov_b32 s96, 0
L_adaLN_cond__spectral_gfnet__glu_gated_bilinear__prompt_kernel_s2r_42_x:
L_adaLN_cond__spectral_gfnet__glu_gated_bilinear__prompt_kernel_s2ok_41:
    v_subrev_u32 v105, 24576, v104
    v_add_u32 v105, 40960, v105
    v_and_b32 v99, 0xffff0000, v98
    v_lshlrev_b32 v98, 16, v98
    ds_write_b64 v105, v[98:99] offset:0
    v_and_b32 v101, 0xffff0000, v100
    v_lshlrev_b32 v100, 16, v100
    ds_write_b64 v105, v[100:101] offset:2048
    v_and_b32 v103, 0xffff0000, v102
    v_lshlrev_b32 v102, 16, v102
    ds_write_b64 v105, v[102:103] offset:4096
    s_branch L_adaLN_cond__spectral_gfnet__glu_gated_bilinear__prompt_kernel_p2e2_38
L_adaLN_cond__spectral_gfnet__glu_gated_bilinear__prompt_kernel_svcm_35:
    s_sub_u32 s35, s2, 1
    s_cmp_eq_u32 s2, 0
    s_cselect_b32 s35, 31, s35
    v_subrev_u32 v40, 256, v0
    v_lshrrev_b32 v41, 3, v40
    v_lshlrev_b32 v41, 6, v41
    v_add_u32 v41, 159232, v41
    ds_read_b128 v[16:19], v41 offset:0
    ds_read_b128 v[20:23], v41 offset:16
    ds_read_b128 v[24:27], v41 offset:32
    ds_read_b128 v[28:31], v41 offset:48
    s_waitcnt lgkmcnt(0)
    v_lshlrev_b32 v96, 16, v128
    v_and_b32 v97, 0xffff0000, v128
    v_lshlrev_b32 v98, 16, v129
    v_and_b32 v99, 0xffff0000, v129
    v_lshlrev_b32 v100, 16, v130
    v_and_b32 v101, 0xffff0000, v130
    v_lshlrev_b32 v102, 16, v131
    v_and_b32 v103, 0xffff0000, v131
    v_pk_mul_f32 v[8:9], v[96:97], v[16:17] op_sel:[0,0] op_sel_hi:[1,0]
    v_pk_mul_f32 v[10:11], v[98:99], v[16:17] op_sel:[0,0] op_sel_hi:[1,0]
    v_pk_mul_f32 v[12:13], v[100:101], v[16:17] op_sel:[0,0] op_sel_hi:[1,0]
    v_pk_mul_f32 v[14:15], v[102:103], v[16:17] op_sel:[0,0] op_sel_hi:[1,0]
    v_lshlrev_b32 v104, 16, v132
    v_and_b32 v105, 0xffff0000, v132
    v_lshlrev_b32 v106, 16, v133
    v_and_b32 v107, 0xffff0000, v133
    v_lshlrev_b32 v108, 16, v134
    v_and_b32 v109, 0xffff0000, v134
    v_lshlrev_b32 v110, 16, v135
    v_and_b32 v111, 0xffff0000, v135
    v_pk_fma_f32 v[8:9], v[104:105], v[16:17], v[8:9] op_sel:[0,1,0] op_sel_hi:[1,1,1]
    v_pk_fma_f32 v[10:11], v[106:107], v[16:17], v[10:11] op_sel:[0,1,0] op_sel_hi:[1,1,1]
    v_pk_fma_f32 v[12:13], v[108:109], v[16:17], v[12:13] op_sel:[0,1,0] op_sel_hi:[1,1,1]
    v_pk_fma_f32 v[14:15], v[110:111], v[16:17], v[14:15] op_sel:[0,1,0] op_sel_hi:[1,1,1]
    v_lshlrev_b32 v112, 16, v136
    v_and_b32 v113, 0xffff0000, v136
    v_lshlrev_b32 v114, 16, v137
    v_and_b32 v115, 0xffff0000, v137
    v_lshlrev_b32 v116, 16, v138
    v_and_b32 v117, 0xffff0000, v138
    v_lshlrev_b32 v118, 16, v139
    v_and_b32 v119, 0xffff0000, v139
    v_pk_fma_f32 v[8:9], v[112:113], v[18:19], v[8:9] op_sel:[0,0,0] op_sel_hi:[1,0,1]
    v_pk_fma_f32 v[10:11], v[114:115], v[18:19], v[10:11] op_sel:[0,0,0] op_sel_hi:[1,0,1]
    v_pk_fma_f32 v[12:13], v[116:117], v[18:19], v[12:13] op_sel:[0,0,0] op_sel_hi:[1,0,1]
    v_pk_fma_f32 v[14:15], v[118:119], v[18:19], v[14:15] op_sel:[0,0,0] op_sel_hi:[1,0,1]
    v_lshlrev_b32 v120, 16, v140
    v_and_b32 v121, 0xffff0000, v140
    v_lshlrev_b32 v122, 16, v141
    v_and_b32 v123, 0xffff0000, v141
    v_lshlrev_b32 v124, 16, v142
    v_and_b32 v125, 0xffff0000, v142
    v_lshlrev_b32 v126, 16, v143
    v_and_b32 v127, 0xffff0000, v143
    v_pk_fma_f32 v[8:9], v[120:121], v[18:19], v[8:9] op_sel:[0,1,0] op_sel_hi:[1,1,1]
    v_pk_fma_f32 v[10:11], v[122:123], v[18:19], v[10:11] op_sel:[0,1,0] op_sel_hi:[1,1,1]
    v_pk_fma_f32 v[12:13], v[124:125], v[18:19], v[12:13] op_sel:[0,1,0] op_sel_hi:[1,1,1]
    v_pk_fma_f32 v[14:15], v[126:127], v[18:19], v[14:15] op_sel:[0,1,0] op_sel_hi:[1,1,1]
    v_lshlrev_b32 v96, 16, v144
    v_and_b32 v97, 0xffff0000, v144
    v_lshlrev_b32 v98, 16, v145
    v_and_b32 v99, 0xffff0000, v145
    v_lshlrev_b32 v100, 16, v146
    v_and_b32 v101, 0xffff0000, v146
    v_lshlrev_b32 v102, 16, v147
    v_and_b32 v103, 0xffff0000, v147
    v_pk_fma_f32 v[8:9], v[96:97], v[20:21], v[8:9] op_sel:[0,0,0] op_sel_hi:[1,0,1]
    v_pk_fma_f32 v[10:11], v[98:99], v[20:21], v[10:11] op_sel:[0,0,0] op_sel_hi:[1,0,1]
    v_pk_fma_f32 v[12:13], v[100:101], v[20:21], v[12:13] op_sel:[0,0,0] op_sel_hi:[1,0,1]
    v_pk_fma_f32 v[14:15], v[102:103], v[20:21], v[14:15] op_sel:[0,0,0] op_sel_hi:[1,0,1]
    v_lshlrev_b32 v104, 16, v148
    v_and_b32 v105, 0xffff0000, v148
    v_lshlrev_b32 v106, 16, v149
    v_and_b32 v107, 0xffff0000, v149
    v_lshlrev_b32 v108, 16, v150
    v_and_b32 v109, 0xffff0000, v150
    v_lshlrev_b32 v110, 16, v151
    v_and_b32 v111, 0xffff0000, v151
    v_pk_fma_f32 v[8:9], v[104:105], v[20:21], v[8:9] op_sel:[0,1,0] op_sel_hi:[1,1,1]
    v_pk_fma_f32 v[10:11], v[106:107], v[20:21], v[10:11] op_sel:[0,1,0] op_sel_hi:[1,1,1]
    v_pk_fma_f32 v[12:13], v[108:109], v[20:21], v[12:13] op_sel:[0,1,0] op_sel_hi:[1,1,1]
    v_pk_fma_f32 v[14:15], v[110:111], v[20:21], v[14:15] op_sel:[0,1,0] op_sel_hi:[1,1,1]
    v_lshlrev_b32 v112, 16, v152
    v_and_b32 v113, 0xffff0000, v152
    v_lshlrev_b32 v114, 16, v153
    v_and_b32 v115, 0xffff0000, v153
    v_lshlrev_b32 v116, 16, v154
    v_and_b32 v117, 0xffff0000, v154
    v_lshlrev_b32 v118, 16, v155
    v_and_b32 v119, 0xffff0000, v155
    v_pk_fma_f32 v[8:9], v[112:113], v[22:23], v[8:9] op_sel:[0,0,0] op_sel_hi:[1,0,1]
    v_pk_fma_f32 v[10:11], v[114:115], v[22:23], v[10:11] op_sel:[0,0,0] op_sel_hi:[1,0,1]
    v_pk_fma_f32 v[12:13], v[116:117], v[22:23], v[12:13] op_sel:[0,0,0] op_sel_hi:[1,0,1]
    v_pk_fma_f32 v[14:15], v[118:119], v[22:23], v[14:15] op_sel:[0,0,0] op_sel_hi:[1,0,1]
    v_lshlrev_b32 v120, 16, v156
    v_and_b32 v121, 0xffff0000, v156
    v_lshlrev_b32 v122, 16, v157
    v_and_b32 v123, 0xffff0000, v157
    v_lshlrev_b32 v124, 16, v158
    v_and_b32 v125, 0xffff0000, v158
    v_lshlrev_b32 v126, 16, v159
    v_and_b32 v127, 0xffff0000, v159
    v_pk_fma_f32 v[8:9], v[120:121], v[22:23], v[8:9] op_sel:[0,1,0] op_sel_hi:[1,1,1]
    v_pk_fma_f32 v[10:11], v[122:123], v[22:23], v[10:11] op_sel:[0,1,0] op_sel_hi:[1,1,1]
    v_pk_fma_f32 v[12:13], v[124:125], v[22:23], v[12:13] op_sel:[0,1,0] op_sel_hi:[1,1,1]
    v_pk_fma_f32 v[14:15], v[126:127], v[22:23], v[14:15] op_sel:[0,1,0] op_sel_hi:[1,1,1]
    v_lshlrev_b32 v96, 16, v160
    v_and_b32 v97, 0xffff0000, v160
    v_lshlrev_b32 v98, 16, v161
    v_and_b32 v99, 0xffff0000, v161
    v_lshlrev_b32 v100, 16, v162
    v_and_b32 v101, 0xffff0000, v162
    v_lshlrev_b32 v102, 16, v163
    v_and_b32 v103, 0xffff0000, v163
    v_pk_fma_f32 v[8:9], v[96:97], v[24:25], v[8:9] op_sel:[0,0,0] op_sel_hi:[1,0,1]
    v_pk_fma_f32 v[10:11], v[98:99], v[24:25], v[10:11] op_sel:[0,0,0] op_sel_hi:[1,0,1]
    v_pk_fma_f32 v[12:13], v[100:101], v[24:25], v[12:13] op_sel:[0,0,0] op_sel_hi:[1,0,1]
    v_pk_fma_f32 v[14:15], v[102:103], v[24:25], v[14:15] op_sel:[0,0,0] op_sel_hi:[1,0,1]
    v_lshlrev_b32 v104, 16, v164
    v_and_b32 v105, 0xffff0000, v164
    v_lshlrev_b32 v106, 16, v165
    v_and_b32 v107, 0xffff0000, v165
    v_lshlrev_b32 v108, 16, v166
    v_and_b32 v109, 0xffff0000, v166
    v_lshlrev_b32 v110, 16, v167
    v_and_b32 v111, 0xffff0000, v167
    v_pk_fma_f32 v[8:9], v[104:105], v[24:25], v[8:9] op_sel:[0,1,0] op_sel_hi:[1,1,1]
    v_pk_fma_f32 v[10:11], v[106:107], v[24:25], v[10:11] op_sel:[0,1,0] op_sel_hi:[1,1,1]
    v_pk_fma_f32 v[12:13], v[108:109], v[24:25], v[12:13] op_sel:[0,1,0] op_sel_hi:[1,1,1]
    v_pk_fma_f32 v[14:15], v[110:111], v[24:25], v[14:15] op_sel:[0,1,0] op_sel_hi:[1,1,1]
    v_lshlrev_b32 v112, 16, v168
    v_and_b32 v113, 0xffff0000, v168
    v_lshlrev_b32 v114, 16, v169
    v_and_b32 v115, 0xffff0000, v169
    v_lshlrev_b32 v116, 16, v170
    v_and_b32 v117, 0xffff0000, v170
    v_lshlrev_b32 v118, 16, v171
    v_and_b32 v119, 0xffff0000, v171
    v_pk_fma_f32 v[8:9], v[112:113], v[26:27], v[8:9] op_sel:[0,0,0] op_sel_hi:[1,0,1]
    v_pk_fma_f32 v[10:11], v[114:115], v[26:27], v[10:11] op_sel:[0,0,0] op_sel_hi:[1,0,1]
    v_pk_fma_f32 v[12:13], v[116:117], v[26:27], v[12:13] op_sel:[0,0,0] op_sel_hi:[1,0,1]
    v_pk_fma_f32 v[14:15], v[118:119], v[26:27], v[14:15] op_sel:[0,0,0] op_sel_hi:[1,0,1]
    v_lshlrev_b32 v120, 16, v172
    v_and_b32 v121, 0xffff0000, v172
    v_lshlrev_b32 v122, 16, v173
    v_and_b32 v123, 0xffff0000, v173
    v_lshlrev_b32 v124, 16, v174
    v_and_b32 v125, 0xffff0000, v174
    v_lshlrev_b32 v126, 16, v175
    v_and_b32 v127, 0xffff0000, v175
    v_pk_fma_f32 v[8:9], v[120:121], v[26:27], v[8:9] op_sel:[0,1,0] op_sel_hi:[1,1,1]
    v_pk_fma_f32 v[10:11], v[122:123], v[26:27], v[10:11] op_sel:[0,1,0] op_sel_hi:[1,1,1]
    v_pk_fma_f32 v[12:13], v[124:125], v[26:27], v[12:13] op_sel:[0,1,0] op_sel_hi:[1,1,1]
    v_pk_fma_f32 v[14:15], v[126:127], v[26:27], v[14:15] op_sel:[0,1,0] op_sel_hi:[1,1,1]
    v_lshlrev_b32 v96, 16, v176
    v_and_b32 v97, 0xffff0000, v176
    v_lshlrev_b32 v98, 16, v177
    v_and_b32 v99, 0xffff0000, v177
    v_lshlrev_b32 v100, 16, v178
    v_and_b32 v101, 0xffff0000, v178
    v_lshlrev_b32 v102, 16, v179
    v_and_b32 v103, 0xffff0000, v179
    v_pk_fma_f32 v[8:9], v[96:97], v[28:29], v[8:9] op_sel:[0,0,0] op_sel_hi:[1,0,1]
    v_pk_fma_f32 v[10:11], v[98:99], v[28:29], v[10:11] op_sel:[0,0,0] op_sel_hi:[1,0,1]
    v_pk_fma_f32 v[12:13], v[100:101], v[28:29], v[12:13] op_sel:[0,0,0] op_sel_hi:[1,0,1]
    v_pk_fma_f32 v[14:15], v[102:103], v[28:29], v[14:15] op_sel:[0,0,0] op_sel_hi:[1,0,1]
    v_lshlrev_b32 v104, 16, v180
    v_and_b32 v105, 0xffff0000, v180
    v_lshlrev_b32 v106, 16, v181
    v_and_b32 v107, 0xffff0000, v181
    v_lshlrev_b32 v108, 16, v182
    v_and_b32 v109, 0xffff0000, v182
    v_lshlrev_b32 v110, 16, v183
    v_and_b32 v111, 0xffff0000, v183
    v_pk_fma_f32 v[8:9], v[104:105], v[28:29], v[8:9] op_sel:[0,1,0] op_sel_hi:[1,1,1]
    v_pk_fma_f32 v[10:11], v[106:107], v[28:29], v[10:11] op_sel:[0,1,0] op_sel_hi:[1,1,1]
    v_pk_fma_f32 v[12:13], v[108:109], v[28:29], v[12:13] op_sel:[0,1,0] op_sel_hi:[1,1,1]
    v_pk_fma_f32 v[14:15], v[110:111], v[28:29], v[14:15] op_sel:[0,1,0] op_sel_hi:[1,1,1]
    v_lshlrev_b32 v112, 16, v184
    v_and_b32 v113, 0xffff0000, v184
    v_lshlrev_b32 v114, 16, v185
    v_and_b32 v115, 0xffff0000, v185
    v_lshlrev_b32 v116, 16, v186
    v_and_b32 v117, 0xffff0000, v186
    v_lshlrev_b32 v118, 16, v187
    v_and_b32 v119, 0xffff0000, v187
    v_pk_fma_f32 v[8:9], v[112:113], v[30:31], v[8:9] op_sel:[0,0,0] op_sel_hi:[1,0,1]
    v_pk_fma_f32 v[10:11], v[114:115], v[30:31], v[10:11] op_sel:[0,0,0] op_sel_hi:[1,0,1]
    v_pk_fma_f32 v[12:13], v[116:117], v[30:31], v[12:13] op_sel:[0,0,0] op_sel_hi:[1,0,1]
    v_pk_fma_f32 v[14:15], v[118:119], v[30:31], v[14:15] op_sel:[0,0,0] op_sel_hi:[1,0,1]
    v_lshlrev_b32 v120, 16, v188
    v_and_b32 v121, 0xffff0000, v188
    v_lshlrev_b32 v122, 16, v189
    v_and_b32 v123, 0xffff0000, v189
    v_lshlrev_b32 v124, 16, v190
    v_and_b32 v125, 0xffff0000, v190
    v_lshlrev_b32 v126, 16, v191
    v_and_b32 v127, 0xffff0000, v191
    v_pk_fma_f32 v[8:9], v[120:121], v[30:31], v[8:9] op_sel:[0,1,0] op_sel_hi:[1,1,1]
    v_pk_fma_f32 v[10:11], v[122:123], v[30:31], v[10:11] op_sel:[0,1,0] op_sel_hi:[1,1,1]
    v_pk_fma_f32 v[12:13], v[124:125], v[30:31], v[12:13] op_sel:[0,1,0] op_sel_hi:[1,1,1]
    v_pk_fma_f32 v[14:15], v[126:127], v[30:31], v[14:15] op_sel:[0,1,0] op_sel_hi:[1,1,1]
    v_add_f32_dpp v8, v8, v8 row_ror:8 row_mask:0xf bank_mask:0xf
    v_add_f32_dpp v9, v9, v9 row_ror:8 row_mask:0xf bank_mask:0xf
    v_add_f32_dpp v10, v10, v10 row_ror:8 row_mask:0xf bank_mask:0xf
    v_add_f32_dpp v11, v11, v11 row_ror:8 row_mask:0xf bank_mask:0xf
    v_add_f32_dpp v12, v12, v12 row_ror:8 row_mask:0xf bank_mask:0xf
    v_add_f32_dpp v13, v13, v13 row_ror:8 row_mask:0xf bank_mask:0xf
    v_add_f32_dpp v14, v14, v14 row_ror:8 row_mask:0xf bank_mask:0xf
    v_add_f32_dpp v15, v15, v15 row_ror:8 row_mask:0xf bank_mask:0xf
    v_mov_b32 v96, v8
    v_mov_b32 v97, v9
    v_mov_b32 v98, v10
    v_mov_b32 v99, v11
    v_mov_b32 v100, v12
    v_mov_b32 v101, v13
    v_mov_b32 v102, v14
    v_mov_b32 v103, v15
    v_permlane16_swap_b32 v8, v96
    v_permlane16_swap_b32 v9, v97
    v_permlane16_swap_b32 v10, v98
    v_permlane16_swap_b32 v11, v99
    v_permlane16_swap_b32 v12, v100
    v_permlane16_swap_b32 v13, v101
    v_permlane16_swap_b32 v14, v102
    v_permlane16_swap_b32 v15, v103
    v_add_f32 v8, v8, v96
    v_add_f32 v9, v9, v97
    v_add_f32 v10, v10, v98
    v_add_f32 v11, v11, v99
    v_add_f32 v12, v12, v100
    v_add_f32 v13, v13, v101
    v_add_f32 v14, v14, v102
    v_add_f32 v15, v15, v103
    v_mov_b32 v96, v8
    v_mov_b32 v97, v9
    v_mov_b32 v98, v10
    v_mov_b32 v99, v11
    v_mov_b32 v100, v12
    v_mov_b32 v101, v13
    v_mov_b32 v102, v14
    v_mov_b32 v103, v15
    v_permlane32_swap_b32 v8, v96
    v_permlane32_swap_b32 v9, v97
    v_permlane32_swap_b32 v10, v98
    v_permlane32_swap_b32 v11, v99
    v_permlane32_swap_b32 v12, v100
    v_permlane32_swap_b32 v13, v101
    v_permlane32_swap_b32 v14, v102
    v_permlane32_swap_b32 v15, v103
    v_add_f32 v8, v8, v96
    v_add_f32 v9, v9, v97
    v_add_f32 v10, v10, v98
    v_add_f32 v11, v11, v99
    v_add_f32 v12, v12, v100
    v_add_f32 v13, v13, v101
    v_add_f32 v14, v14, v102
    v_add_f32 v15, v15, v103
    s_sub_u32 s16, s10, 4
    s_lshl_b32 s16, s16, 8
    s_add_u32 s16, s16, 158208
    v_and_b32 v42, 7, v1
    v_lshlrev_b32 v42, 5, v42
    v_add_u32 v42, s16, v42
    s_mov_b64 exec, 0xff
    ds_write_b128 v42, v[8:11]
    ds_write_b128 v42, v[12:15] offset:16
    s_mov_b64 exec, -1
    v_mov_b32 v43, 163152
    v_mov_b32 v44, 1
    s_mov_b64 exec, 1
    ds_add_rtn_u32 v45, v43, v44
    s_waitcnt lgkmcnt(0)
    v_cmp_gt_u32 vcc, 3, v45
    s_cbranch_vccz L_adaLN_cond__spectral_gfnet__glu_gated_bilinear__prompt_kernel_gsd_43
    s_mov_b32 s97, 0
L_adaLN_cond__spectral_gfnet__glu_gated_bilinear__prompt_kernel_gs_44:
    ds_read_b32 v45, v43
    s_waitcnt lgkmcnt(0)
    v_cmp_gt_u32 vcc, 4, v45
    s_cbranch_vccz L_adaLN_cond__spectral_gfnet__glu_gated_bilinear__prompt_kernel_gs_44_x
    s_add_u32 s97, s97, 1
    s_cmp_lt_u32 s97, s96
    s_cbranch_scc1 L_adaLN_cond__spectral_gfnet__glu_gated_bilinear__prompt_kernel_gs_44
    s_mov_b32 s96, 0
L_adaLN_cond__spectral_gfnet__glu_gated_bilinear__prompt_kernel_gs_44_x:
L_adaLN_cond__spectral_gfnet__glu_gated_bilinear__prompt_kernel_gsd_43:
    s_mov_b64 exec, -1
    s_cmp_lg_u32 s10, 4
    s_cbranch_scc1 L_adaLN_cond__spectral_gfnet__glu_gated_bilinear__prompt_kernel_nmw_45
    v_lshlrev_b32 v42, 2, v1
    v_add_u32 v42, 158208, v42
    ds_read_b32 v8, v42 offset:0
    ds_read_b32 v9, v42 offset:256
    ds_read_b32 v10, v42 offset:512
    ds_read_b32 v11, v42 offset:768
    s_waitcnt lgkmcnt(0)
    v_add_f32 v8, v8, v9
    v_add_f32 v10, v10, v11
    v_add_f32 v8, v8, v10
    v_cvt_pk_bf16_f32 v8, v8, v8
    v_lshlrev_b32 v8, 16, v8
    v_add_f32 v9, 1.0, v8
    v_cvt_pk_bf16_f32 v9, v9, v9
    v_lshlrev_b32 v9, 16, v9
    s_lshr_b32 s16, s35, 3
    s_cmp_eq_u32 s16, 2
    s_cselect_b64 vcc, -1, 0
    v_cndmask_b32 v8, v8, v9, vcc
    s_nop 1
    v_mov_b32_dpp v9, v8 quad_perm:[1,0,3,2] row_mask:0xf bank_mask:0xf
    v_lshrrev_b32 v10, 16, v8
    v_or_b32 v10, v10, v9
    v_mov_b32 v11, s3
    v_lshlrev_b32 v16, 2, v1
    s_lshl_b32 s16, s35, 8
    s_add_u32 s16, s16, 24576
    v_add_u32 v16, s16, v16
    s_mov_b32 s16, 0x55555555
    s_mov_b32 s17, 0x55555555
    s_mov_b64 exec, s[16:17]
    global_store_dwordx2 v16, v[10:11], s[6:7] sc1
    s_mov_b64 exec, -1
L_adaLN_cond__spectral_gfnet__glu_gated_bilinear__prompt_kernel_nmw_45:
    s_cmp_lg_u32 s2, 31
    s_cbranch_scc1 L_adaLN_cond__spectral_gfnet__glu_gated_bilinear__prompt_kernel_p2end_36
    v_mov_b32 v43, 163152
    v_mov_b32 v44, 1
    s_mov_b64 exec, 1
    ds_add_rtn_u32 v45, v43, v44
    s_waitcnt lgkmcnt(0)
    v_cmp_gt_u32 vcc, 7, v45
    s_cbranch_vccz L_adaLN_cond__spectral_gfnet__glu_gated_bilinear__prompt_kernel_gsd_47
    s_mov_b32 s97, 0
L_adaLN_cond__spectral_gfnet__glu_gated_bilinear__prompt_kernel_gs_48:
    ds_read_b32 v45, v43
    s_waitcnt lgkmcnt(0)
    v_cmp_gt_u32 vcc, 8, v45
    s_cbranch_vccz L_adaLN_cond__spectral_gfnet__glu_gated_bilinear__prompt_kernel_gs_48_x
    s_add_u32 s97, s97, 1
    s_cmp_lt_u32 s97, s96
    s_cbranch_scc1 L_adaLN_cond__spectral_gfnet__glu_gated_bilinear__prompt_kernel_gs_48
    s_mov_b32 s96, 0
L_adaLN_cond__spectral_gfnet__glu_gated_bilinear__prompt_kernel_gs_48_x:
L_adaLN_cond__spectral_gfnet__glu_gated_bilinear__prompt_kernel_gsd_47:
    s_mov_b64 exec, -1
    s_mov_b32 s35, 31
    v_subrev_u32 v112, 256, v0
    v_lshrrev_b32 v113, 3, v112
    v_mul_u32_u24 v113, 98304, v113
    v_and_b32 v114, 7, v112
    v_lshlrev_b32 v114, 4, v114
    v_add_u32 v113, v113, v114
    s_lshl_b32 s16, s35, 7
    s_add_u32 s16, s16, 2048
    v_add_u32 v113, s16, v113
    s_add_u32 s18, s66, 0
    s_addc_u32 s19, s67, 0
    global_load_dwordx4 v[128:131], v113, s[18:19]
    s_add_u32 s18, s66, 6144
    s_addc_u32 s19, s67, 0
    global_load_dwordx4 v[132:135], v113, s[18:19]
    s_add_u32 s18, s66, 12288
    s_addc_u32 s19, s67, 0
    global_load_dwordx4 v[136:139], v113, s[18:19]
    s_add_u32 s18, s66, 18432
    s_addc_u32 s19, s67, 0
    global_load_dwordx4 v[140:143], v113, s[18:19]
    s_add_u32 s18, s66, 24576
    s_addc_u32 s19, s67, 0
    global_load_dwordx4 v[144:147], v113, s[18:19]
    s_add_u32 s18, s66, 30720
    s_addc_u32 s19, s67, 0
    global_load_dwordx4 v[148:151], v113, s[18:19]
    s_add_u32 s18, s66, 36864
    s_addc_u32 s19, s67, 0
    global_load_dwordx4 v[152:155], v113, s[18:19]
    s_add_u32 s18, s66, 43008
    s_addc_u32 s19, s67, 0
    global_load_dwordx4 v[156:159], v113, s[18:19]
    s_add_u32 s18, s66, 49152
    s_addc_u32 s19, s67, 0
    global_load_dwordx4 v[160:163], v113, s[18:19]
    s_add_u32 s18, s66, 55296
    s_addc_u32 s19, s67, 0
    global_load_dwordx4 v[164:167], v113, s[18:19]
    s_add_u32 s18, s66, 61440
    s_addc_u32 s19, s67, 0
    global_load_dwordx4 v[168:171], v113, s[18:19]
    s_add_u32 s18, s66, 67584
    s_addc_u32 s19, s67, 0
    global_load_dwordx4 v[172:175], v113, s[18:19]
    s_add_u32 s18, s66, 73728
    s_addc_u32 s19, s67, 0
    global_load_dwordx4 v[176:179], v113, s[18:19]
    s_add_u32 s18, s66, 79872
    s_addc_u32 s19, s67, 0
    global_load_dwordx4 v[180:183], v113, s[18:19]
    s_add_u32 s18, s66, 86016
    s_addc_u32 s19, s67, 0
    global_load_dwordx4 v[184:187], v113, s[18:19]
    s_add_u32 s18, s66, 92160
    s_addc_u32 s19, s67, 0
    global_load_dwordx4 v[188:191], v113, s[18:19]
    s_waitcnt vmcnt(0)
    s_mov_b32 s35, 31
    v_subrev_u32 v40, 256, v0
    v_lshrrev_b32 v41, 3, v40
    v_lshlrev_b32 v41, 6, v41
    v_add_u32 v41, 159232, v41
    ds_read_b128 v[16:19], v41 offset:0
    ds_read_b128 v[20:23], v41 offset:16
    ds_read_b128 v[24:27], v41 offset:32
    ds_read_b128 v[28:31], v41 offset:48
    s_waitcnt lgkmcnt(0)
    v_lshlrev_b32 v96, 16, v128
    v_and_b32 v97, 0xffff0000, v128
    v_lshlrev_b32 v98, 16, v129
    v_and_b32 v99, 0xffff0000, v129
    v_lshlrev_b32 v100, 16, v130
    v_and_b32 v101, 0xffff0000, v130
    v_lshlrev_b32 v102, 16, v131
    v_and_b32 v103, 0xffff0000, v131
    v_pk_mul_f32 v[8:9], v[96:97], v[16:17] op_sel:[0,0] op_sel_hi:[1,0]
    v_pk_mul_f32 v[10:11], v[98:99], v[16:17] op_sel:[0,0] op_sel_hi:[1,0]
    v_pk_mul_f32 v[12:13], v[100:101], v[16:17] op_sel:[0,0] op_sel_hi:[1,0]
    v_pk_mul_f32 v[14:15], v[102:103], v[16:17] op_sel:[0,0] op_sel_hi:[1,0]
    v_lshlrev_b32 v104, 16, v132
    v_and_b32 v105, 0xffff0000, v132
    v_lshlrev_b32 v106, 16, v133
    v_and_b32 v107, 0xffff0000, v133
    v_lshlrev_b32 v108, 16, v134
    v_and_b32 v109, 0xffff0000, v134
    v_lshlrev_b32 v110, 16, v135
    v_and_b32 v111, 0xffff0000, v135
    v_pk_fma_f32 v[8:9], v[104:105], v[16:17], v[8:9] op_sel:[0,1,0] op_sel_hi:[1,1,1]
    v_pk_fma_f32 v[10:11], v[106:107], v[16:17], v[10:11] op_sel:[0,1,0] op_sel_hi:[1,1,1]
    v_pk_fma_f32 v[12:13], v[108:109], v[16:17], v[12:13] op_sel:[0,1,0] op_sel_hi:[1,1,1]
    v_pk_fma_f32 v[14:15], v[110:111], v[16:17], v[14:15] op_sel:[0,1,0] op_sel_hi:[1,1,1]
    v_lshlrev_b32 v112, 16, v136
    v_and_b32 v113, 0xffff0000, v136
    v_lshlrev_b32 v114, 16, v137
    v_and_b32 v115, 0xffff0000, v137
    v_lshlrev_b32 v116, 16, v138
    v_and_b32 v117, 0xffff0000, v138
    v_lshlrev_b32 v118, 16, v139
    v_and_b32 v119, 0xffff0000, v139
    v_pk_fma_f32 v[8:9], v[112:113], v[18:19], v[8:9] op_sel:[0,0,0] op_sel_hi:[1,0,1]
    v_pk_fma_f32 v[10:11], v[114:115], v[18:19], v[10:11] op_sel:[0,0,0] op_sel_hi:[1,0,1]
    v_pk_fma_f32 v[12:13], v[116:117], v[18:19], v[12:13] op_sel:[0,0,0] op_sel_hi:[1,0,1]
    v_pk_fma_f32 v[14:15], v[118:119], v[18:19], v[14:15] op_sel:[0,0,0] op_sel_hi:[1,0,1]
    v_lshlrev_b32 v120, 16, v140
    v_and_b32 v121, 0xffff0000, v140
    v_lshlrev_b32 v122, 16, v141
    v_and_b32 v123, 0xffff0000, v141
    v_lshlrev_b32 v124, 16, v142
    v_and_b32 v125, 0xffff0000, v142
    v_lshlrev_b32 v126, 16, v143
    v_and_b32 v127, 0xffff0000, v143
    v_pk_fma_f32 v[8:9], v[120:121], v[18:19], v[8:9] op_sel:[0,1,0] op_sel_hi:[1,1,1]
    v_pk_fma_f32 v[10:11], v[122:123], v[18:19], v[10:11] op_sel:[0,1,0] op_sel_hi:[1,1,1]
    v_pk_fma_f32 v[12:13], v[124:125], v[18:19], v[12:13] op_sel:[0,1,0] op_sel_hi:[1,1,1]
    v_pk_fma_f32 v[14:15], v[126:127], v[18:19], v[14:15] op_sel:[0,1,0] op_sel_hi:[1,1,1]
    v_lshlrev_b32 v96, 16, v144
    v_and_b32 v97, 0xffff0000, v144
    v_lshlrev_b32 v98, 16, v145
    v_and_b32 v99, 0xffff0000, v145
    v_lshlrev_b32 v100, 16, v146
    v_and_b32 v101, 0xffff0000, v146
    v_lshlrev_b32 v102, 16, v147
    v_and_b32 v103, 0xffff0000, v147
    v_pk_fma_f32 v[8:9], v[96:97], v[20:21], v[8:9] op_sel:[0,0,0] op_sel_hi:[1,0,1]
    v_pk_fma_f32 v[10:11], v[98:99], v[20:21], v[10:11] op_sel:[0,0,0] op_sel_hi:[1,0,1]
    v_pk_fma_f32 v[12:13], v[100:101], v[20:21], v[12:13] op_sel:[0,0,0] op_sel_hi:[1,0,1]
    v_pk_fma_f32 v[14:15], v[102:103], v[20:21], v[14:15] op_sel:[0,0,0] op_sel_hi:[1,0,1]
    v_lshlrev_b32 v104, 16, v148
    v_and_b32 v105, 0xffff0000, v148
    v_lshlrev_b32 v106, 16, v149
    v_and_b32 v107, 0xffff0000, v149
    v_lshlrev_b32 v108, 16, v150
    v_and_b32 v109, 0xffff0000, v150
    v_lshlrev_b32 v110, 16, v151
    v_and_b32 v111, 0xffff0000, v151
    v_pk_fma_f32 v[8:9], v[104:105], v[20:21], v[8:9] op_sel:[0,1,0] op_sel_hi:[1,1,1]
    v_pk_fma_f32 v[10:11], v[106:107], v[20:21], v[10:11] op_sel:[0,1,0] op_sel_hi:[1,1,1]
    v_pk_fma_f32 v[12:13], v[108:109], v[20:21], v[12:13] op_sel:[0,1,0] op_sel_hi:[1,1,1]
    v_pk_fma_f32 v[14:15], v[110:111], v[20:21], v[14:15] op_sel:[0,1,0] op_sel_hi:[1,1,1]
    v_lshlrev_b32 v112, 16, v152
    v_and_b32 v113, 0xffff0000, v152
    v_lshlrev_b32 v114, 16, v153
    v_and_b32 v115, 0xffff0000, v153
    v_lshlrev_b32 v116, 16, v154
    v_and_b32 v117, 0xffff0000, v154
    v_lshlrev_b32 v118, 16, v155
    v_and_b32 v119, 0xffff0000, v155
    v_pk_fma_f32 v[8:9], v[112:113], v[22:23], v[8:9] op_sel:[0,0,0] op_sel_hi:[1,0,1]
    v_pk_fma_f32 v[10:11], v[114:115], v[22:23], v[10:11] op_sel:[0,0,0] op_sel_hi:[1,0,1]
    v_pk_fma_f32 v[12:13], v[116:117], v[22:23], v[12:13] op_sel:[0,0,0] op_sel_hi:[1,0,1]
    v_pk_fma_f32 v[14:15], v[118:119], v[22:23], v[14:15] op_sel:[0,0,0] op_sel_hi:[1,0,1]
    v_lshlrev_b32 v120, 16, v156
    v_and_b32 v121, 0xffff0000, v156
    v_lshlrev_b32 v122, 16, v157
    v_and_b32 v123, 0xffff0000, v157
    v_lshlrev_b32 v124, 16, v158
    v_and_b32 v125, 0xffff0000, v158
    v_lshlrev_b32 v126, 16, v159
    v_and_b32 v127, 0xffff0000, v159
    v_pk_fma_f32 v[8:9], v[120:121], v[22:23], v[8:9] op_sel:[0,1,0] op_sel_hi:[1,1,1]
    v_pk_fma_f32 v[10:11], v[122:123], v[22:23], v[10:11] op_sel:[0,1,0] op_sel_hi:[1,1,1]
    v_pk_fma_f32 v[12:13], v[124:125], v[22:23], v[12:13] op_sel:[0,1,0] op_sel_hi:[1,1,1]
    v_pk_fma_f32 v[14:15], v[126:127], v[22:23], v[14:15] op_sel:[0,1,0] op_sel_hi:[1,1,1]
    v_lshlrev_b32 v96, 16, v160
    v_and_b32 v97, 0xffff0000, v160
    v_lshlrev_b32 v98, 16, v161
    v_and_b32 v99, 0xffff0000, v161
    v_lshlrev_b32 v100, 16, v162
    v_and_b32 v101, 0xffff0000, v162
    v_lshlrev_b32 v102, 16, v163
    v_and_b32 v103, 0xffff0000, v163
    v_pk_fma_f32 v[8:9], v[96:97], v[24:25], v[8:9] op_sel:[0,0,0] op_sel_hi:[1,0,1]
    v_pk_fma_f32 v[10:11], v[98:99], v[24:25], v[10:11] op_sel:[0,0,0] op_sel_hi:[1,0,1]
    v_pk_fma_f32 v[12:13], v[100:101], v[24:25], v[12:13] op_sel:[0,0,0] op_sel_hi:[1,0,1]
    v_pk_fma_f32 v[14:15], v[102:103], v[24:25], v[14:15] op_sel:[0,0,0] op_sel_hi:[1,0,1]
    v_lshlrev_b32 v104, 16, v164
    v_and_b32 v105, 0xffff0000, v164
    v_lshlrev_b32 v106, 16, v165
    v_and_b32 v107, 0xffff0000, v165
    v_lshlrev_b32 v108, 16, v166
    v_and_b32 v109, 0xffff0000, v166
    v_lshlrev_b32 v110, 16, v167
    v_and_b32 v111, 0xffff0000, v167
    v_pk_fma_f32 v[8:9], v[104:105], v[24:25], v[8:9] op_sel:[0,1,0] op_sel_hi:[1,1,1]
    v_pk_fma_f32 v[10:11], v[106:107], v[24:25], v[10:11] op_sel:[0,1,0] op_sel_hi:[1,1,1]
    v_pk_fma_f32 v[12:13], v[108:109], v[24:25], v[12:13] op_sel:[0,1,0] op_sel_hi:[1,1,1]
    v_pk_fma_f32 v[14:15], v[110:111], v[24:25], v[14:15] op_sel:[0,1,0] op_sel_hi:[1,1,1]
    v_lshlrev_b32 v112, 16, v168
    v_and_b32 v113, 0xffff0000, v168
    v_lshlrev_b32 v114, 16, v169
    v_and_b32 v115, 0xffff0000, v169
    v_lshlrev_b32 v116, 16, v170
    v_and_b32 v117, 0xffff0000, v170
    v_lshlrev_b32 v118, 16, v171
    v_and_b32 v119, 0xffff0000, v171
    v_pk_fma_f32 v[8:9], v[112:113], v[26:27], v[8:9] op_sel:[0,0,0] op_sel_hi:[1,0,1]
    v_pk_fma_f32 v[10:11], v[114:115], v[26:27], v[10:11] op_sel:[0,0,0] op_sel_hi:[1,0,1]
    v_pk_fma_f32 v[12:13], v[116:117], v[26:27], v[12:13] op_sel:[0,0,0] op_sel_hi:[1,0,1]
    v_pk_fma_f32 v[14:15], v[118:119], v[26:27], v[14:15] op_sel:[0,0,0] op_sel_hi:[1,0,1]
    v_lshlrev_b32 v120, 16, v172
    v_and_b32 v121, 0xffff0000, v172
    v_lshlrev_b32 v122, 16, v173
    v_and_b32 v123, 0xffff0000, v173
    v_lshlrev_b32 v124, 16, v174
    v_and_b32 v125, 0xffff0000, v174
    v_lshlrev_b32 v126, 16, v175
    v_and_b32 v127, 0xffff0000, v175
    v_pk_fma_f32 v[8:9], v[120:121], v[26:27], v[8:9] op_sel:[0,1,0] op_sel_hi:[1,1,1]
    v_pk_fma_f32 v[10:11], v[122:123], v[26:27], v[10:11] op_sel:[0,1,0] op_sel_hi:[1,1,1]
    v_pk_fma_f32 v[12:13], v[124:125], v[26:27], v[12:13] op_sel:[0,1,0] op_sel_hi:[1,1,1]
    v_pk_fma_f32 v[14:15], v[126:127], v[26:27], v[14:15] op_sel:[0,1,0] op_sel_hi:[1,1,1]
    v_lshlrev_b32 v96, 16, v176
    v_and_b32 v97, 0xffff0000, v176
    v_lshlrev_b32 v98, 16, v177
    v_and_b32 v99, 0xffff0000, v177
    v_lshlrev_b32 v100, 16, v178
    v_and_b32 v101, 0xffff0000, v178
    v_lshlrev_b32 v102, 16, v179
    v_and_b32 v103, 0xffff0000, v179
    v_pk_fma_f32 v[8:9], v[96:97], v[28:29], v[8:9] op_sel:[0,0,0] op_sel_hi:[1,0,1]
    v_pk_fma_f32 v[10:11], v[98:99], v[28:29], v[10:11] op_sel:[0,0,0] op_sel_hi:[1,0,1]
    v_pk_fma_f32 v[12:13], v[100:101], v[28:29], v[12:13] op_sel:[0,0,0] op_sel_hi:[1,0,1]
    v_pk_fma_f32 v[14:15], v[102:103], v[28:29], v[14:15] op_sel:[0,0,0] op_sel_hi:[1,0,1]
    v_lshlrev_b32 v104, 16, v180
    v_and_b32 v105, 0xffff0000, v180
    v_lshlrev_b32 v106, 16, v181
    v_and_b32 v107, 0xffff0000, v181
    v_lshlrev_b32 v108, 16, v182
    v_and_b32 v109, 0xffff0000, v182
    v_lshlrev_b32 v110, 16, v183
    v_and_b32 v111, 0xffff0000, v183
    v_pk_fma_f32 v[8:9], v[104:105], v[28:29], v[8:9] op_sel:[0,1,0] op_sel_hi:[1,1,1]
    v_pk_fma_f32 v[10:11], v[106:107], v[28:29], v[10:11] op_sel:[0,1,0] op_sel_hi:[1,1,1]
    v_pk_fma_f32 v[12:13], v[108:109], v[28:29], v[12:13] op_sel:[0,1,0] op_sel_hi:[1,1,1]
    v_pk_fma_f32 v[14:15], v[110:111], v[28:29], v[14:15] op_sel:[0,1,0] op_sel_hi:[1,1,1]
    v_lshlrev_b32 v112, 16, v184
    v_and_b32 v113, 0xffff0000, v184
    v_lshlrev_b32 v114, 16, v185
    v_and_b32 v115, 0xffff0000, v185
    v_lshlrev_b32 v116, 16, v186
    v_and_b32 v117, 0xffff0000, v186
    v_lshlrev_b32 v118, 16, v187
    v_and_b32 v119, 0xffff0000, v187
    v_pk_fma_f32 v[8:9], v[112:113], v[30:31], v[8:9] op_sel:[0,0,0] op_sel_hi:[1,0,1]
    v_pk_fma_f32 v[10:11], v[114:115], v[30:31], v[10:11] op_sel:[0,0,0] op_sel_hi:[1,0,1]
    v_pk_fma_f32 v[12:13], v[116:117], v[30:31], v[12:13] op_sel:[0,0,0] op_sel_hi:[1,0,1]
    v_pk_fma_f32 v[14:15], v[118:119], v[30:31], v[14:15] op_sel:[0,0,0] op_sel_hi:[1,0,1]
    v_lshlrev_b32 v120, 16, v188
    v_and_b32 v121, 0xffff0000, v188
    v_lshlrev_b32 v122, 16, v189
    v_and_b32 v123, 0xffff0000, v189
    v_lshlrev_b32 v124, 16, v190
    v_and_b32 v125, 0xffff0000, v190
    v_lshlrev_b32 v126, 16, v191
    v_and_b32 v127, 0xffff0000, v191
    v_pk_fma_f32 v[8:9], v[120:121], v[30:31], v[8:9] op_sel:[0,1,0] op_sel_hi:[1,1,1]
    v_pk_fma_f32 v[10:11], v[122:123], v[30:31], v[10:11] op_sel:[0,1,0] op_sel_hi:[1,1,1]
    v_pk_fma_f32 v[12:13], v[124:125], v[30:31], v[12:13] op_sel:[0,1,0] op_sel_hi:[1,1,1]
    v_pk_fma_f32 v[14:15], v[126:127], v[30:31], v[14:15] op_sel:[0,1,0] op_sel_hi:[1,1,1]
    v_add_f32_dpp v8, v8, v8 row_ror:8 row_mask:0xf bank_mask:0xf
    v_add_f32_dpp v9, v9, v9 row_ror:8 row_mask:0xf bank_mask:0xf
    v_add_f32_dpp v10, v10, v10 row_ror:8 row_mask:0xf bank_mask:0xf
    v_add_f32_dpp v11, v11, v11 row_ror:8 row_mask:0xf bank_mask:0xf
    v_add_f32_dpp v12, v12, v12 row_ror:8 row_mask:0xf bank_mask:0xf
    v_add_f32_dpp v13, v13, v13 row_ror:8 row_mask:0xf bank_mask:0xf
    v_add_f32_dpp v14, v14, v14 row_ror:8 row_mask:0xf bank_mask:0xf
    v_add_f32_dpp v15, v15, v15 row_ror:8 row_mask:0xf bank_mask:0xf
    v_mov_b32 v96, v8
    v_mov_b32 v97, v9
    v_mov_b32 v98, v10
    v_mov_b32 v99, v11
    v_mov_b32 v100, v12
    v_mov_b32 v101, v13
    v_mov_b32 v102, v14
    v_mov_b32 v103, v15
    v_permlane16_swap_b32 v8, v96
    v_permlane16_swap_b32 v9, v97
    v_permlane16_swap_b32 v10, v98
    v_permlane16_swap_b32 v11, v99
    v_permlane16_swap_b32 v12, v100
    v_permlane16_swap_b32 v13, v101
    v_permlane16_swap_b32 v14, v102
    v_permlane16_swap_b32 v15, v103
    v_add_f32 v8, v8, v96
    v_add_f32 v9, v9, v97
    v_add_f32 v10, v10, v98
    v_add_f32 v11, v11, v99
    v_add_f32 v12, v12, v100
    v_add_f32 v13, v13, v101
    v_add_f32 v14, v14, v102
    v_add_f32 v15, v15, v103
    v_mov_b32 v96, v8
    v_mov_b32 v97, v9
    v_mov_b32 v98, v10
    v_mov_b32 v99, v11
    v_mov_b32 v100, v12
    v_mov_b32 v101, v13
    v_mov_b32 v102, v14
    v_mov_b32 v103, v15
    v_permlane32_swap_b32 v8, v96
    v_permlane32_swap_b32 v9, v97
    v_permlane32_swap_b32 v10, v98
    v_permlane32_swap_b32 v11, v99
    v_permlane32_swap_b32 v12, v100
    v_permlane32_swap_b32 v13, v101
    v_permlane32_swap_b32 v14, v102
    v_permlane32_swap_b32 v15, v103
    v_add_f32 v8, v8, v96
    v_add_f32 v9, v9, v97
    v_add_f32 v10, v10, v98
    v_add_f32 v11, v11, v99
    v_add_f32 v12, v12, v100
    v_add_f32 v13, v13, v101
    v_add_f32 v14, v14, v102
    v_add_f32 v15, v15, v103
    s_sub_u32 s16, s10, 4
    s_lshl_b32 s16, s16, 8
    s_add_u32 s16, s16, 158208
    v_and_b32 v42, 7, v1
    v_lshlrev_b32 v42, 5, v42
    v_add_u32 v42, s16, v42
    s_mov_b64 exec, 0xff
    ds_write_b128 v42, v[8:11]
    ds_write_b128 v42, v[12:15] offset:16
    s_mov_b64 exec, -1
    v_mov_b32 v43, 163152
    v_mov_b32 v44, 1
    s_mov_b64 exec, 1
    ds_add_rtn_u32 v45, v43, v44
    s_waitcnt lgkmcnt(0)
    v_cmp_gt_u32 vcc, 11, v45
    s_cbranch_vccz L_adaLN_cond__spectral_gfnet__glu_gated_bilinear__prompt_kernel_gsd_49
    s_mov_b32 s97, 0
L_adaLN_cond__spectral_gfnet__glu_gated_bilinear__prompt_kernel_gs_50:
    ds_read_b32 v45, v43
    s_waitcnt lgkmcnt(0)
    v_cmp_gt_u32 vcc, 12, v45
    s_cbranch_vccz L_adaLN_cond__spectral_gfnet__glu_gated_bilinear__prompt_kernel_gs_50_x
    s_add_u32 s97, s97, 1
    s_cmp_lt_u32 s97, s96
    s_cbranch_scc1 L_adaLN_cond__spectral_gfnet__glu_gated_bilinear__prompt_kernel_gs_50
    s_mov_b32 s96, 0
L_adaLN_cond__spectral_gfnet__glu_gated_bilinear__prompt_kernel_gs_50_x:
L_adaLN_cond__spectral_gfnet__glu_gated_bilinear__prompt_kernel_gsd_49:
    s_mov_b64 exec, -1
    s_cmp_lg_u32 s10, 4
    s_cbranch_scc1 L_adaLN_cond__spectral_gfnet__glu_gated_bilinear__prompt_kernel_nmw_51
    v_lshlrev_b32 v42, 2, v1
    v_add_u32 v42, 158208, v42
    ds_read_b32 v8, v42 offset:0
    ds_read_b32 v9, v42 offset:256
    ds_read_b32 v10, v42 offset:512
    ds_read_b32 v11, v42 offset:768
    s_waitcnt lgkmcnt(0)
    v_add_f32 v8, v8, v9
    v_add_f32 v10, v10, v11
    v_add_f32 v8, v8, v10
    v_cvt_pk_bf16_f32 v8, v8, v8
    v_lshlrev_b32 v8, 16, v8
    v_add_f32 v9, 1.0, v8
    v_cvt_pk_bf16_f32 v9, v9, v9
    v_lshlrev_b32 v9, 16, v9
    s_lshr_b32 s16, s35, 3
    s_cmp_eq_u32 s16, 2
    s_cselect_b64 vcc, -1, 0
    v_cndmask_b32 v8, v8, v9, vcc
    s_nop 1
    v_mov_b32_dpp v9, v8 quad_perm:[1,0,3,2] row_mask:0xf bank_mask:0xf
    v_lshrrev_b32 v10, 16, v8
    v_or_b32 v10, v10, v9
    v_mov_b32 v11, s3
    v_lshlrev_b32 v16, 2, v1
    s_lshl_b32 s16, s35, 8
    s_add_u32 s16, s16, 24576
    v_add_u32 v16, s16, v16
    s_mov_b32 s16, 0x55555555
    s_mov_b32 s17, 0x55555555
    s_mov_b64 exec, s[16:17]
    global_store_dwordx2 v16, v[10:11], s[6:7] sc1
    s_mov_b64 exec, -1
L_adaLN_cond__spectral_gfnet__glu_gated_bilinear__prompt_kernel_nmw_51:
    s_branch L_adaLN_cond__spectral_gfnet__glu_gated_bilinear__prompt_kernel_p2end_36
L_adaLN_cond__spectral_gfnet__glu_gated_bilinear__prompt_kernel_p2act0_34:
    s_setprio 3
    s_mov_b32 s34, 256
    v_and_b32 v2, 15, v1
    v_lshrrev_b32 v3, 4, v1
    s_and_b32 s15, s10, 3
    s_lshl_b32 s15, s15, 4
    v_add_u32 v12, s15, v2
    v_cvt_f32_u32 v58, v12
    v_mul_f32 v58, 0x3a000000, v58
    v_lshlrev_b32 v59, 2, v3
    v_cvt_f32_u32 v59, v59
    v_mul_f32 v59, v59, v58
    s_mov_b32 s16, 0x0
    v_fma_f32 v72, v58, s16, v59
    s_mov_b32 s16, 0x3f800000
    v_fma_f32 v73, v58, s16, v59
    s_mov_b32 s16, 0x40000000
    v_fma_f32 v74, v58, s16, v59
    s_mov_b32 s16, 0x40400000
    v_fma_f32 v75, v58, s16, v59
    s_mov_b32 s16, 0x41800000
    v_fma_f32 v76, v58, s16, v59
    s_mov_b32 s16, 0x41880000
    v_fma_f32 v77, v58, s16, v59
    s_mov_b32 s16, 0x41900000
    v_fma_f32 v78, v58, s16, v59
    s_mov_b32 s16, 0x41980000
    v_fma_f32 v79, v58, s16, v59
    v_cos_f32 v64, v72
    v_cos_f32 v65, v73
    v_cos_f32 v66, v74
    v_cos_f32 v67, v75
    v_cos_f32 v68, v76
    v_cos_f32 v69, v77
    v_cos_f32 v70, v78
    v_cos_f32 v71, v79
    v_sin_f32 v72, v72
    v_sin_f32 v73, v73
    v_sin_f32 v74, v74
    v_sin_f32 v75, v75
    v_sin_f32 v76, v76
    v_sin_f32 v77, v77
    v_sin_f32 v78, v78
    v_sin_f32 v79, v79
    s_mov_b32 s16, 0x3ab504f3
    s_and_b32 s17, s34, 255
    s_cmp_eq_u32 s17, 0
    s_cselect_b32 s16, 0x3a800000, s16
    v_pk_mul_f32 v[64:65], v[64:65], s[16:17] op_sel_hi:[1,0]
    v_pk_mul_f32 v[72:73], v[72:73], s[16:17] op_sel_hi:[1,0]
    v_pk_mul_f32 v[66:67], v[66:67], s[16:17] op_sel_hi:[1,0]
    v_pk_mul_f32 v[74:75], v[74:75], s[16:17] op_sel_hi:[1,0]
    v_pk_mul_f32 v[68:69], v[68:69], s[16:17] op_sel_hi:[1,0]
    v_pk_mul_f32 v[76:77], v[76:77], s[16:17] op_sel_hi:[1,0]
    v_pk_mul_f32 v[70:71], v[70:71], s[16:17] op_sel_hi:[1,0]
    v_pk_mul_f32 v[78:79], v[78:79], s[16:17] op_sel_hi:[1,0]
    s_mov_b32 s33, 49152
    s_cmp_lt_u32 s10, 4
    s_cselect_b32 s33, 131072, s33
    s_lshr_b32 s32, s10, 2
    s_mul_i32 s32, s32, 8704
    s_add_u32 s32, s32, 0
    v_mul_u32_u24 v60, 1088, v3
    v_lshlrev_b32 v61, 2, v12
    v_add_u32 v60, v60, v61
    v_add_u32 v60, s32, v60
    v_mul_u32_u24 v61, 272, v2
    v_lshlrev_b32 v62, 4, v3
    v_add_u32 v61, v61, v62
    v_add_u32 v62, s32, v61
    v_add_u32 v61, s33, v61
    s_lshr_b32 s16, s10, 2
    s_lshl_b32 s16, s16, 4
    s_add_u32 s16, s16, 163088
    v_mov_b32 v57, s16
    v_mov_b32 v58, 1
    v_and_b32 v4, 255, v0
    v_lshrrev_b32 v5, 1, v4
    v_mul_u32_u24 v8, 8320, v5
    v_and_b32 v6, 1, v4
    v_lshlrev_b32 v6, 4, v6
    v_add_u32 v8, v8, v6
    s_lshl_b32 s16, s34, 5
    s_add_u32 s17, s16, 1048576
    v_add_u32 v8, s17, v8
    v_add_u32 v9, 1064960, v8
    v_and_b32 v10, 31, v5
    v_mul_u32_u24 v10, 272, v10
    v_lshrrev_b32 v11, 5, v5
    v_lshlrev_b32 v11, 5, v11
    v_add_u32 v10, v10, v11
    v_add_u32 v10, v10, v6
    v_add_u32 v10, s33, v10
    v_lshlrev_b32 v13, 5, v3
    v_lshrrev_b32 v14, 3, v2
    v_add_u32 v13, v13, v14
    s_and_b32 s17, s10, 3
    s_lshl_b32 s17, s17, 1
    v_add_u32 v13, s17, v13
    v_mul_u32_u24 v13, 8320, v13
    v_and_b32 v14, 7, v2
    v_lshlrev_b32 v14, 2, v14
    v_add_u32 v13, v13, v14
    s_add_u32 s17, s16, 7340032
    v_add_u32 v13, s17, v13
    v_cmp_ne_u32 vcc, s3, v92
    s_cbranch_vccz L_adaLN_cond__spectral_gfnet__glu_gated_bilinear__prompt_kernel_fok_52
    s_mov_b32 s97, 0
L_adaLN_cond__spectral_gfnet__glu_gated_bilinear__prompt_kernel_fla0_53:
    global_load_dword v92, v93, s[6:7] sc1
    s_waitcnt vmcnt(0)
    v_cmp_ne_u32 vcc, s3, v92
    s_cbranch_vccz L_adaLN_cond__spectral_gfnet__glu_gated_bilinear__prompt_kernel_fla0_53_x
    s_add_u32 s97, s97, 1
    s_cmp_lt_u32 s97, s96
    s_cbranch_scc1 L_adaLN_cond__spectral_gfnet__glu_gated_bilinear__prompt_kernel_fla0_53
    s_mov_b32 s96, 0
L_adaLN_cond__spectral_gfnet__glu_gated_bilinear__prompt_kernel_fla0_53_x:
L_adaLN_cond__spectral_gfnet__glu_gated_bilinear__prompt_kernel_fok_52:
    s_mov_b64 exec, 1
    ds_add_rtn_u32 v56, v57, v58
    s_waitcnt lgkmcnt(0)
    v_cmp_gt_u32 vcc, 3, v56
    s_cbranch_vccz L_adaLN_cond__spectral_gfnet__glu_gated_bilinear__prompt_kernel_gsd_54
    s_mov_b32 s97, 0
L_adaLN_cond__spectral_gfnet__glu_gated_bilinear__prompt_kernel_gs_55:
    ds_read_b32 v56, v57
    s_waitcnt lgkmcnt(0)
    v_cmp_gt_u32 vcc, 4, v56
    s_cbranch_vccz L_adaLN_cond__spectral_gfnet__glu_gated_bilinear__prompt_kernel_gs_55_x
    s_add_u32 s97, s97, 1
    s_cmp_lt_u32 s97, s96
    s_cbranch_scc1 L_adaLN_cond__spectral_gfnet__glu_gated_bilinear__prompt_kernel_gs_55
    s_mov_b32 s96, 0
L_adaLN_cond__spectral_gfnet__glu_gated_bilinear__prompt_kernel_gs_55_x:
L_adaLN_cond__spectral_gfnet__glu_gated_bilinear__prompt_kernel_gsd_54:
    s_mov_b64 exec, -1
    s_add_u32 s18, s6, 0
    s_addc_u32 s19, s7, 0
    global_load_dword v48, v13, s[18:19] sc1
    s_add_u32 s18, s6, 66560
    s_addc_u32 s19, s7, 0
    global_load_dword v49, v13, s[18:19] sc1
    s_add_u32 s18, s6, 133120
    s_addc_u32 s19, s7, 0
    global_load_dword v50, v13, s[18:19] sc1
    s_add_u32 s18, s6, 199680
    s_addc_u32 s19, s7, 0
    global_load_dword v51, v13, s[18:19] sc1
    s_add_u32 s18, s6, 1064960
    s_addc_u32 s19, s7, 0
    global_load_dword v52, v13, s[18:19] sc1
    s_add_u32 s18, s6, 1131520
    s_addc_u32 s19, s7, 0
    global_load_dword v53, v13, s[18:19] sc1
    s_add_u32 s18, s6, 1198080
    s_addc_u32 s19, s7, 0
    global_load_dword v54, v13, s[18:19] sc1
    s_add_u32 s18, s6, 1264640
    s_addc_u32 s19, s7, 0
    global_load_dword v55, v13, s[18:19] sc1
    s_mov_b32 s97, 0
L_adaLN_cond__spectral_gfnet__glu_gated_bilinear__prompt_kernel_z1p_56:
    global_load_dwordx4 v[16:19], v8, s[6:7] sc1
    global_load_dwordx4 v[20:23], v9, s[6:7] sc1
    s_waitcnt vmcnt(0)
    v_max3_u32 v24, v16, v17, v18
    v_max3_u32 v24, v24, v19, v20
    v_max3_u32 v24, v24, v21, v22
    v_max_u32 v24, v24, v23
    v_cmp_eq_u32 vcc, -1, v24
    s_cbranch_vccz L_adaLN_cond__spectral_gfnet__glu_gated_bilinear__prompt_kernel_z1p_56_x
    s_mov_b64 exec, vcc
    s_add_u32 s97, s97, 1
    s_cmp_lt_u32 s97, s96
    s_cbranch_scc1 L_adaLN_cond__spectral_gfnet__glu_gated_bilinear__prompt_kernel_z1p_56
    s_mov_b32 s96, 0
L_adaLN_cond__spectral_gfnet__glu_gated_bilinear__prompt_kernel_z1p_56_x:
    s_mov_b64 exec, -1
    ds_write_b128 v10, v[16:19]
    ds_write_b128 v10, v[20:23] offset:128
    v_lshlrev_b32 v80, 16, v48
    v_and_b32 v88, 0xffff0000, v48
    v_lshlrev_b32 v81, 16, v49
    v_and_b32 v89, 0xffff0000, v49
    v_lshlrev_b32 v82, 16, v50
    v_and_b32 v90, 0xffff0000, v50
    v_lshlrev_b32 v83, 16, v51
    v_and_b32 v91, 0xffff0000, v51
    v_lshlrev_b32 v84, 16, v52
    v_and_b32 v92, 0xffff0000, v52
    v_lshlrev_b32 v85, 16, v53
    v_and_b32 v93, 0xffff0000, v53
    v_lshlrev_b32 v86, 16, v54
    v_and_b32 v94, 0xffff0000, v54
    v_lshlrev_b32 v87, 16, v55
    v_and_b32 v95, 0xffff0000, v55
    s_mov_b64 exec, 1
    ds_add_rtn_u32 v56, v57, v58
    s_waitcnt lgkmcnt(0)
    v_cmp_gt_u32 vcc, 7, v56
    s_cbranch_vccz L_adaLN_cond__spectral_gfnet__glu_gated_bilinear__prompt_kernel_gsd_57
    s_mov_b32 s97, 0
L_adaLN_cond__spectral_gfnet__glu_gated_bilinear__prompt_kernel_gs_58:
    ds_read_b32 v56, v57
    s_waitcnt lgkmcnt(0)
    v_cmp_gt_u32 vcc, 8, v56
    s_cbranch_vccz L_adaLN_cond__spectral_gfnet__glu_gated_bilinear__prompt_kernel_gs_58_x
    s_add_u32 s97, s97, 1
    s_cmp_lt_u32 s97, s96
    s_cbranch_scc1 L_adaLN_cond__spectral_gfnet__glu_gated_bilinear__prompt_kernel_gs_58
    s_mov_b32 s96, 0
L_adaLN_cond__spectral_gfnet__glu_gated_bilinear__prompt_kernel_gs_58_x:
L_adaLN_cond__spectral_gfnet__glu_gated_bilinear__prompt_kernel_gsd_57:
    s_mov_b64 exec, -1
    ds_read_b128 v[16:19], v61 offset:0
    ds_read_b128 v[20:23], v61 offset:64
    ds_read_b128 v[24:27], v61 offset:128
    ds_read_b128 v[28:31], v61 offset:192
    ds_read_b128 v[32:35], v61 offset:4352
    ds_read_b128 v[36:39], v61 offset:4416
    ds_read_b128 v[40:43], v61 offset:4480
    ds_read_b128 v[44:47], v61 offset:4544
    s_waitcnt lgkmcnt(0)
    v_mfma_f32_16x16x32_bf16 v[96:99], v[16:19], v[192:195], 0
    v_mfma_f32_16x16x32_bf16 v[104:107], v[16:19], v[208:211], 0
    v_mfma_f32_16x16x32_bf16 v[100:103], v[32:35], v[192:195], 0
    v_mfma_f32_16x16x32_bf16 v[108:111], v[32:35], v[208:211], 0
    v_mfma_f32_16x16x32_bf16 v[96:99], v[20:23], v[196:199], v[96:99]
    v_mfma_f32_16x16x32_bf16 v[104:107], v[20:23], v[212:215], v[104:107]
    v_mfma_f32_16x16x32_bf16 v[100:103], v[36:39], v[196:199], v[100:103]
    v_mfma_f32_16x16x32_bf16 v[108:111], v[36:39], v[212:215], v[108:111]
    v_mfma_f32_16x16x32_bf16 v[96:99], v[24:27], v[200:203], v[96:99]
    v_mfma_f32_16x16x32_bf16 v[104:107], v[24:27], v[216:219], v[104:107]
    v_mfma_f32_16x16x32_bf16 v[100:103], v[40:43], v[200:203], v[100:103]
    v_mfma_f32_16x16x32_bf16 v[108:111], v[40:43], v[216:219], v[108:111]
    v_mfma_f32_16x16x32_bf16 v[96:99], v[28:31], v[204:207], v[96:99]
    v_mfma_f32_16x16x32_bf16 v[104:107], v[28:31], v[220:223], v[104:107]
    v_mfma_f32_16x16x32_bf16 v[100:103], v[44:47], v[204:207], v[100:103]
    v_mfma_f32_16x16x32_bf16 v[108:111], v[44:47], v[220:223], v[108:111]
    s_nop 4
    v_pk_mul_f32 v[112:113], v[96:97], v[64:65]
    v_pk_mul_f32 v[120:121], v[104:105], v[64:65]
    v_pk_mul_f32 v[114:115], v[98:99], v[66:67]
    v_pk_mul_f32 v[122:123], v[106:107], v[66:67]
    v_pk_mul_f32 v[116:117], v[100:101], v[68:69]
    v_pk_mul_f32 v[124:125], v[108:109], v[68:69]
    v_pk_mul_f32 v[118:119], v[102:103], v[70:71]
    v_pk_mul_f32 v[126:127], v[110:111], v[70:71]
    v_pk_fma_f32 v[112:113], v[104:105], v[72:73], v[112:113]
    v_pk_fma_f32 v[120:121], v[96:97], v[72:73], v[120:121] neg_lo:[1,0,0] neg_hi:[1,0,0]
    v_pk_fma_f32 v[114:115], v[106:107], v[74:75], v[114:115]
    v_pk_fma_f32 v[122:123], v[98:99], v[74:75], v[122:123] neg_lo:[1,0,0] neg_hi:[1,0,0]
    v_pk_fma_f32 v[116:117], v[108:109], v[76:77], v[116:117]
    v_pk_fma_f32 v[124:125], v[100:101], v[76:77], v[124:125] neg_lo:[1,0,0] neg_hi:[1,0,0]
    v_pk_fma_f32 v[118:119], v[110:111], v[78:79], v[118:119]
    v_pk_fma_f32 v[126:127], v[102:103], v[78:79], v[126:127] neg_lo:[1,0,0] neg_hi:[1,0,0]
    v_cvt_pk_bf16_f32 v16, v112, v120
    v_cvt_pk_bf16_f32 v17, v113, v121
    v_cvt_pk_bf16_f32 v18, v114, v122
    v_cvt_pk_bf16_f32 v19, v115, v123
    v_cvt_pk_bf16_f32 v20, v116, v124
    v_cvt_pk_bf16_f32 v21, v117, v125
    v_cvt_pk_bf16_f32 v22, v118, v126
    v_cvt_pk_bf16_f32 v23, v119, v127
    v_mfma_f32_16x16x32_bf16 v[96:99], v[224:227], v[16:19], 0
    v_mfma_f32_16x16x32_bf16 v[104:107], v[240:243], v[16:19], 0
    v_mfma_f32_16x16x32_bf16 v[100:103], v[232:235], v[16:19], 0
    v_mfma_f32_16x16x32_bf16 v[108:111], v[248:251], v[16:19], 0
    v_mfma_f32_16x16x32_bf16 v[96:99], v[228:231], v[20:23], v[96:99]
    v_mfma_f32_16x16x32_bf16 v[104:107], v[244:247], v[20:23], v[104:107]
    v_mfma_f32_16x16x32_bf16 v[100:103], v[236:239], v[20:23], v[100:103]
    v_mfma_f32_16x16x32_bf16 v[108:111], v[252:255], v[20:23], v[108:111]
    s_nop 4
    v_pk_mul_f32 v[112:113], v[96:97], v[80:81]
    v_pk_mul_f32 v[120:121], v[96:97], v[88:89] neg_lo:[1,0] neg_hi:[1,0]
    v_pk_mul_f32 v[114:115], v[98:99], v[82:83]
    v_pk_mul_f32 v[122:123], v[98:99], v[90:91] neg_lo:[1,0] neg_hi:[1,0]
    v_pk_mul_f32 v[116:117], v[100:101], v[84:85]
    v_pk_mul_f32 v[124:125], v[100:101], v[92:93] neg_lo:[1,0] neg_hi:[1,0]
    v_pk_mul_f32 v[118:119], v[102:103], v[86:87]
    v_pk_mul_f32 v[126:127], v[102:103], v[94:95] neg_lo:[1,0] neg_hi:[1,0]
    v_pk_fma_f32 v[112:113], v[104:105], v[88:89], v[112:113] neg_lo:[1,0,0] neg_hi:[1,0,0]
    v_pk_fma_f32 v[120:121], v[104:105], v[80:81], v[120:121] neg_lo:[1,0,0] neg_hi:[1,0,0]
    v_pk_fma_f32 v[114:115], v[106:107], v[90:91], v[114:115] neg_lo:[1,0,0] neg_hi:[1,0,0]
    v_pk_fma_f32 v[122:123], v[106:107], v[82:83], v[122:123] neg_lo:[1,0,0] neg_hi:[1,0,0]
    v_pk_fma_f32 v[116:117], v[108:109], v[92:93], v[116:117] neg_lo:[1,0,0] neg_hi:[1,0,0]
    v_pk_fma_f32 v[124:125], v[108:109], v[84:85], v[124:125] neg_lo:[1,0,0] neg_hi:[1,0,0]
    v_pk_fma_f32 v[118:119], v[110:111], v[94:95], v[118:119] neg_lo:[1,0,0] neg_hi:[1,0,0]
    v_pk_fma_f32 v[126:127], v[110:111], v[86:87], v[126:127] neg_lo:[1,0,0] neg_hi:[1,0,0]
    v_cvt_pk_bf16_f32 v16, v112, v120
    v_cvt_pk_bf16_f32 v17, v113, v121
    v_cvt_pk_bf16_f32 v18, v114, v122
    v_cvt_pk_bf16_f32 v19, v115, v123
    v_cvt_pk_bf16_f32 v20, v116, v124
    v_cvt_pk_bf16_f32 v21, v117, v125
    v_cvt_pk_bf16_f32 v22, v118, v126
    v_cvt_pk_bf16_f32 v23, v119, v127
    v_mfma_f32_16x16x32_bf16 v[96:99], v[224:227], v[16:19], 0
    v_mfma_f32_16x16x32_bf16 v[104:107], v[240:243], v[16:19], 0
    v_mfma_f32_16x16x32_bf16 v[100:103], v[232:235], v[16:19], 0
    v_mfma_f32_16x16x32_bf16 v[108:111], v[248:251], v[16:19], 0
    v_mfma_f32_16x16x32_bf16 v[96:99], v[228:231], v[20:23], v[96:99]
    v_mfma_f32_16x16x32_bf16 v[104:107], v[244:247], v[20:23], v[104:107]
    v_mfma_f32_16x16x32_bf16 v[100:103], v[236:239], v[20:23], v[100:103]
    v_mfma_f32_16x16x32_bf16 v[108:111], v[252:255], v[20:23], v[108:111]
    s_nop 4
    v_pk_mul_f32 v[112:113], v[96:97], v[64:65]
    v_pk_mul_f32 v[120:121], v[104:105], v[64:65]
    v_pk_mul_f32 v[114:115], v[98:99], v[66:67]
    v_pk_mul_f32 v[122:123], v[106:107], v[66:67]
    v_pk_mul_f32 v[116:117], v[100:101], v[68:69]
    v_pk_mul_f32 v[124:125], v[108:109], v[68:69]
    v_pk_mul_f32 v[118:119], v[102:103], v[70:71]
    v_pk_mul_f32 v[126:127], v[110:111], v[70:71]
    v_pk_fma_f32 v[112:113], v[104:105], v[72:73], v[112:113]
    v_pk_fma_f32 v[120:121], v[96:97], v[72:73], v[120:121] neg_lo:[1,0,0] neg_hi:[1,0,0]
    v_pk_fma_f32 v[114:115], v[106:107], v[74:75], v[114:115]
    v_pk_fma_f32 v[122:123], v[98:99], v[74:75], v[122:123] neg_lo:[1,0,0] neg_hi:[1,0,0]
    v_pk_fma_f32 v[116:117], v[108:109], v[76:77], v[116:117]
    v_pk_fma_f32 v[124:125], v[100:101], v[76:77], v[124:125] neg_lo:[1,0,0] neg_hi:[1,0,0]
    v_pk_fma_f32 v[118:119], v[110:111], v[78:79], v[118:119]
    v_pk_fma_f32 v[126:127], v[102:103], v[78:79], v[126:127] neg_lo:[1,0,0] neg_hi:[1,0,0]
    v_cvt_pk_bf16_f32 v16, v112, v120
    v_cvt_pk_bf16_f32 v17, v113, v121
    v_cvt_pk_bf16_f32 v18, v114, v122
    v_cvt_pk_bf16_f32 v19, v115, v123
    v_cvt_pk_bf16_f32 v20, v116, v124
    v_cvt_pk_bf16_f32 v21, v117, v125
    v_cvt_pk_bf16_f32 v22, v118, v126
    v_cvt_pk_bf16_f32 v23, v119, v127
    ds_write_b32 v60, v16 offset:0
    ds_write_b32 v60, v17 offset:272
    ds_write_b32 v60, v18 offset:544
    ds_write_b32 v60, v19 offset:816
    ds_write_b32 v60, v20 offset:4352
    ds_write_b32 v60, v21 offset:4624
    ds_write_b32 v60, v22 offset:4896
    ds_write_b32 v60, v23 offset:5168
    s_mov_b64 exec, 1
    ds_add_rtn_u32 v56, v57, v58
    s_waitcnt lgkmcnt(0)
    v_cmp_gt_u32 vcc, 11, v56
    s_cbranch_vccz L_adaLN_cond__spectral_gfnet__glu_gated_bilinear__prompt_kernel_gsd_59
    s_mov_b32 s97, 0
L_adaLN_cond__spectral_gfnet__glu_gated_bilinear__prompt_kernel_gs_60:
    ds_read_b32 v56, v57
    s_waitcnt lgkmcnt(0)
    v_cmp_gt_u32 vcc, 12, v56
    s_cbranch_vccz L_adaLN_cond__spectral_gfnet__glu_gated_bilinear__prompt_kernel_gs_60_x
    s_add_u32 s97, s97, 1
    s_cmp_lt_u32 s97, s96
    s_cbranch_scc1 L_adaLN_cond__spectral_gfnet__glu_gated_bilinear__prompt_kernel_gs_60
    s_mov_b32 s96, 0
L_adaLN_cond__spectral_gfnet__glu_gated_bilinear__prompt_kernel_gs_60_x:
L_adaLN_cond__spectral_gfnet__glu_gated_bilinear__prompt_kernel_gsd_59:
    s_mov_b64 exec, -1
    ds_read_b128 v[24:27], v62 offset:0
    ds_read_b128 v[28:31], v62 offset:64
    ds_read_b128 v[32:35], v62 offset:128
    ds_read_b128 v[36:39], v62 offset:192
    ds_read_b128 v[40:43], v62 offset:4352
    ds_read_b128 v[44:47], v62 offset:4416
    ds_read_b128 v[48:51], v62 offset:4480
    ds_read_b128 v[52:55], v62 offset:4544
    s_and_b32 s16, s10, 3
    s_lshl_b32 s16, s16, 11
    s_lshl_b32 s17, s34, 13
    s_add_u32 s16, s16, s17
    s_add_u32 s16, s16, 4194304
    v_and_b32 v6, 7, v2
    v_lshlrev_b32 v6, 8, v6
    v_lshrrev_b32 v7, 3, v2
    v_lshlrev_b32 v7, 6, v7
    v_add_u32 v6, v6, v7
    v_lshlrev_b32 v7, 4, v3
    v_add_u32 v6, v6, v7
    v_add_u32 v8, s16, v6
    v_add_u32 v9, 128, v8
    s_waitcnt lgkmcnt(0)
    v_mfma_f32_16x16x32_bf16 v[96:99], v[192:195], v[24:27], 0
    v_mfma_f32_16x16x32_bf16 v[104:107], v[208:211], v[24:27], 0
    v_mfma_f32_16x16x32_bf16 v[100:103], v[192:195], v[40:43], 0
    v_mfma_f32_16x16x32_bf16 v[108:111], v[208:211], v[40:43], 0
    v_mfma_f32_16x16x32_bf16 v[96:99], v[196:199], v[28:31], v[96:99]
    v_mfma_f32_16x16x32_bf16 v[104:107], v[212:215], v[28:31], v[104:107]
    v_mfma_f32_16x16x32_bf16 v[100:103], v[196:199], v[44:47], v[100:103]
    v_mfma_f32_16x16x32_bf16 v[108:111], v[212:215], v[44:47], v[108:111]
    v_mfma_f32_16x16x32_bf16 v[96:99], v[200:203], v[32:35], v[96:99]
    v_mfma_f32_16x16x32_bf16 v[104:107], v[216:219], v[32:35], v[104:107]
    v_mfma_f32_16x16x32_bf16 v[100:103], v[200:203], v[48:51], v[100:103]
    v_mfma_f32_16x16x32_bf16 v[108:111], v[216:219], v[48:51], v[108:111]
    v_mfma_f32_16x16x32_bf16 v[96:99], v[204:207], v[36:39], v[96:99]
    v_mfma_f32_16x16x32_bf16 v[104:107], v[220:223], v[36:39], v[104:107]
    v_mfma_f32_16x16x32_bf16 v[100:103], v[204:207], v[52:55], v[100:103]
    v_mfma_f32_16x16x32_bf16 v[108:111], v[220:223], v[52:55], v[108:111]
    s_nop 5
    v_cvt_pk_bf16_f32 v16, v96, v104
    v_cvt_pk_bf16_f32 v17, v97, v105
    v_cvt_pk_bf16_f32 v18, v98, v106
    v_cvt_pk_bf16_f32 v19, v99, v107
    v_cvt_pk_bf16_f32 v20, v100, v108
    v_cvt_pk_bf16_f32 v21, v101, v109
    v_cvt_pk_bf16_f32 v22, v102, v110
    v_cvt_pk_bf16_f32 v23, v103, v111
    global_store_dwordx4 v8, v[16:19], s[6:7] sc1
    global_store_dwordx4 v9, v[20:23], s[6:7] sc1
    s_setprio 0
    s_branch L_adaLN_cond__spectral_gfnet__glu_gated_bilinear__prompt_kernel_p2end_36
L_adaLN_cond__spectral_gfnet__glu_gated_bilinear__prompt_kernel_p2act_32:
    s_cmp_lt_u32 s2, 32
    s_cbranch_scc1 L_adaLN_cond__spectral_gfnet__glu_gated_bilinear__prompt_kernel_p2actm_33
    s_lshl_b32 s16, s37, 4
    s_add_u32 s16, s16, 32
    s_lshl_b32 s16, s16, 7
    s_add_u32 s16, s16, 196608
    v_and_b32 v129, 15, v1
    v_lshlrev_b32 v129, 7, v129
    v_add_u32 v129, s16, v129
    v_and_b32 v2, 15, v1
    v_lshrrev_b32 v3, 4, v1
    s_and_b32 s15, s10, 3
    s_lshl_b32 s15, s15, 4
    v_add_u32 v12, s15, v2
    v_cvt_f32_u32 v58, v12
    v_mul_f32 v58, 0x3a000000, v58
    v_lshlrev_b32 v59, 2, v3
    v_cvt_f32_u32 v59, v59
    v_mul_f32 v59, v59, v58
    s_mov_b32 s16, 0x0
    v_fma_f32 v72, v58, s16, v59
    s_mov_b32 s16, 0x3f800000
    v_fma_f32 v73, v58, s16, v59
    s_mov_b32 s16, 0x40000000
    v_fma_f32 v74, v58, s16, v59
    s_mov_b32 s16, 0x40400000
    v_fma_f32 v75, v58, s16, v59
    s_mov_b32 s16, 0x41800000
    v_fma_f32 v76, v58, s16, v59
    s_mov_b32 s16, 0x41880000
    v_fma_f32 v77, v58, s16, v59
    s_mov_b32 s16, 0x41900000
    v_fma_f32 v78, v58, s16, v59
    s_mov_b32 s16, 0x41980000
    v_fma_f32 v79, v58, s16, v59
    v_cos_f32 v64, v72
    v_cos_f32 v65, v73
    v_cos_f32 v66, v74
    v_cos_f32 v67, v75
    v_cos_f32 v68, v76
    v_cos_f32 v69, v77
    v_cos_f32 v70, v78
    v_cos_f32 v71, v79
    v_sin_f32 v72, v72
    v_sin_f32 v73, v73
    v_sin_f32 v74, v74
    v_sin_f32 v75, v75
    v_sin_f32 v76, v76
    v_sin_f32 v77, v77
    v_sin_f32 v78, v78
    v_sin_f32 v79, v79
    s_mov_b32 s16, 0x3ab504f3
    s_and_b32 s17, s34, 255
    s_cmp_eq_u32 s17, 0
    s_cselect_b32 s16, 0x3a800000, s16
    v_pk_mul_f32 v[64:65], v[64:65], s[16:17] op_sel_hi:[1,0]
    v_pk_mul_f32 v[72:73], v[72:73], s[16:17] op_sel_hi:[1,0]
    v_pk_mul_f32 v[66:67], v[66:67], s[16:17] op_sel_hi:[1,0]
    v_pk_mul_f32 v[74:75], v[74:75], s[16:17] op_sel_hi:[1,0]
    v_pk_mul_f32 v[68:69], v[68:69], s[16:17] op_sel_hi:[1,0]
    v_pk_mul_f32 v[76:77], v[76:77], s[16:17] op_sel_hi:[1,0]
    v_pk_mul_f32 v[70:71], v[70:71], s[16:17] op_sel_hi:[1,0]
    v_pk_mul_f32 v[78:79], v[78:79], s[16:17] op_sel_hi:[1,0]
    s_mov_b32 s33, 49152
    s_cmp_lt_u32 s10, 4
    s_cselect_b32 s33, 131072, s33
    s_lshr_b32 s32, s10, 2
    s_mul_i32 s32, s32, 8704
    s_add_u32 s32, s32, 0
    v_mul_u32_u24 v60, 1088, v3
    v_lshlrev_b32 v61, 2, v12
    v_add_u32 v60, v60, v61
    v_add_u32 v60, s32, v60
    v_mul_u32_u24 v61, 272, v2
    v_lshlrev_b32 v62, 4, v3
    v_add_u32 v61, v61, v62
    v_add_u32 v62, s32, v61
    v_add_u32 v61, s33, v61
    s_lshr_b32 s16, s10, 2
    s_lshl_b32 s16, s16, 4
    s_add_u32 s16, s16, 163088
    v_mov_b32 v57, s16
    v_mov_b32 v58, 1
    v_and_b32 v4, 255, v0
    v_lshrrev_b32 v5, 1, v4
    v_mul_u32_u24 v8, 8320, v5
    v_and_b32 v6, 1, v4
    v_lshlrev_b32 v6, 4, v6
    v_add_u32 v8, v8, v6
    s_lshl_b32 s16, s34, 5
    s_add_u32 s17, s16, 1048576
    v_add_u32 v8, s17, v8
    v_add_u32 v9, 1064960, v8
    v_and_b32 v10, 31, v5
    v_mul_u32_u24 v10, 272, v10
    v_lshrrev_b32 v11, 5, v5
    v_lshlrev_b32 v11, 5, v11
    v_add_u32 v10, v10, v11
    v_add_u32 v10, v10, v6
    v_add_u32 v10, s33, v10
    v_lshlrev_b32 v13, 5, v3
    v_lshrrev_b32 v14, 3, v2
    v_add_u32 v13, v13, v14
    s_and_b32 s17, s10, 3
    s_lshl_b32 s17, s17, 1
    v_add_u32 v13, s17, v13
    v_mul_u32_u24 v13, 8320, v13
    v_and_b32 v14, 7, v2
    v_lshlrev_b32 v14, 2, v14
    v_add_u32 v13, v13, v14
    s_add_u32 s17, s16, 7340032
    v_add_u32 v13, s17, v13
    s_lshl_b32 s25, s37, 3
    s_add_u32 s25, s25, s10
    s_lshl_b32 s25, s25, 15
    s_add_u32 s25, s25, 16777216
    s_add_u32 s40, s6, s25
    s_addc_u32 s41, s7, 0
    s_mov_b32 s42, 32768
    s_mov_b32 s43, 0x20000
    s_cmp_eq_u32 s10, 0
    s_cbranch_scc1 L_adaLN_cond__spectral_gfnet__glu_gated_bilinear__prompt_kernel_aw0_61
    s_waitcnt vmcnt(1)
    s_branch L_adaLN_cond__spectral_gfnet__glu_gated_bilinear__prompt_kernel_aw1_62
L_adaLN_cond__spectral_gfnet__glu_gated_bilinear__prompt_kernel_aw0_61:
    s_waitcnt vmcnt(2)
L_adaLN_cond__spectral_gfnet__glu_gated_bilinear__prompt_kernel_aw1_62:
    v_cmp_ne_u32 vcc, s3, v92
    s_cbranch_vccz L_adaLN_cond__spectral_gfnet__glu_gated_bilinear__prompt_kernel_fok_63
    s_mov_b32 s97, 0
L_adaLN_cond__spectral_gfnet__glu_gated_bilinear__prompt_kernel_flaw_64:
    global_load_dword v92, v93, s[6:7] sc1
    s_waitcnt vmcnt(0)
    v_cmp_ne_u32 vcc, s3, v92
    s_cbranch_vccz L_adaLN_cond__spectral_gfnet__glu_gated_bilinear__prompt_kernel_flaw_64_x
    s_add_u32 s97, s97, 1
    s_cmp_lt_u32 s97, s96
    s_cbranch_scc1 L_adaLN_cond__spectral_gfnet__glu_gated_bilinear__prompt_kernel_flaw_64
    s_mov_b32 s96, 0
L_adaLN_cond__spectral_gfnet__glu_gated_bilinear__prompt_kernel_flaw_64_x:
L_adaLN_cond__spectral_gfnet__glu_gated_bilinear__prompt_kernel_fok_63:
    s_mov_b64 exec, 1
    ds_add_rtn_u32 v56, v57, v58
    s_waitcnt lgkmcnt(0)
    v_cmp_gt_u32 vcc, 3, v56
    s_cbranch_vccz L_adaLN_cond__spectral_gfnet__glu_gated_bilinear__prompt_kernel_gsd_65
    s_mov_b32 s97, 0
L_adaLN_cond__spectral_gfnet__glu_gated_bilinear__prompt_kernel_gs_66:
    ds_read_b32 v56, v57
    s_waitcnt lgkmcnt(0)
    v_cmp_gt_u32 vcc, 4, v56
    s_cbranch_vccz L_adaLN_cond__spectral_gfnet__glu_gated_bilinear__prompt_kernel_gs_66_x
    s_add_u32 s97, s97, 1
    s_cmp_lt_u32 s97, s96
    s_cbranch_scc1 L_adaLN_cond__spectral_gfnet__glu_gated_bilinear__prompt_kernel_gs_66
    s_mov_b32 s96, 0
L_adaLN_cond__spectral_gfnet__glu_gated_bilinear__prompt_kernel_gs_66_x:
L_adaLN_cond__spectral_gfnet__glu_gated_bilinear__prompt_kernel_gsd_65:
    s_mov_b64 exec, -1
    s_add_u32 s18, s6, 0
    s_addc_u32 s19, s7, 0
    global_load_dword v48, v13, s[18:19] sc1
    s_add_u32 s18, s6, 66560
    s_addc_u32 s19, s7, 0
    global_load_dword v49, v13, s[18:19] sc1
    s_add_u32 s18, s6, 133120
    s_addc_u32 s19, s7, 0
    global_load_dword v50, v13, s[18:19] sc1
    s_add_u32 s18, s6, 199680
    s_addc_u32 s19, s7, 0
    global_load_dword v51, v13, s[18:19] sc1
    s_add_u32 s18, s6, 1064960
    s_addc_u32 s19, s7, 0
    global_load_dword v52, v13, s[18:19] sc1
    s_add_u32 s18, s6, 1131520
    s_addc_u32 s19, s7, 0
    global_load_dword v53, v13, s[18:19] sc1
    s_add_u32 s18, s6, 1198080
    s_addc_u32 s19, s7, 0
    global_load_dword v54, v13, s[18:19] sc1
    s_add_u32 s18, s6, 1264640
    s_addc_u32 s19, s7, 0
    global_load_dword v55, v13, s[18:19] sc1
    global_load_dword v128, v129, s[6:7] sc1
    s_mov_b32 s97, 0
L_adaLN_cond__spectral_gfnet__glu_gated_bilinear__prompt_kernel_z1p_67:
    global_load_dwordx4 v[16:19], v8, s[6:7] sc1
    global_load_dwordx4 v[20:23], v9, s[6:7] sc1
    s_waitcnt vmcnt(0)
    v_max3_u32 v24, v16, v17, v18
    v_max3_u32 v24, v24, v19, v20
    v_max3_u32 v24, v24, v21, v22
    v_max_u32 v24, v24, v23
    v_cmp_eq_u32 vcc, -1, v24
    s_cbranch_vccz L_adaLN_cond__spectral_gfnet__glu_gated_bilinear__prompt_kernel_z1p_67_x
    s_mov_b64 exec, vcc
    s_add_u32 s97, s97, 1
    s_cmp_lt_u32 s97, s96
    s_cbranch_scc1 L_adaLN_cond__spectral_gfnet__glu_gated_bilinear__prompt_kernel_z1p_67
    s_mov_b32 s96, 0
L_adaLN_cond__spectral_gfnet__glu_gated_bilinear__prompt_kernel_z1p_67_x:
    s_mov_b64 exec, -1
    ds_write_b128 v10, v[16:19]
    ds_write_b128 v10, v[20:23] offset:128
    v_cmp_ne_u32 vcc, s3, v128
    s_cbranch_vccz L_adaLN_cond__spectral_gfnet__glu_gated_bilinear__prompt_kernel_fok_68
    s_mov_b32 s97, 0
L_adaLN_cond__spectral_gfnet__glu_gated_bilinear__prompt_kernel_c16a_69:
    global_load_dword v128, v129, s[6:7] sc1
    s_waitcnt vmcnt(0)
    v_cmp_ne_u32 vcc, s3, v128
    s_cbranch_vccz L_adaLN_cond__spectral_gfnet__glu_gated_bilinear__prompt_kernel_c16a_69_x
    s_add_u32 s97, s97, 1
    s_cmp_lt_u32 s97, s96
    s_cbranch_scc1 L_adaLN_cond__spectral_gfnet__glu_gated_bilinear__prompt_kernel_c16a_69
    s_mov_b32 s96, 0
L_adaLN_cond__spectral_gfnet__glu_gated_bilinear__prompt_kernel_c16a_69_x:
L_adaLN_cond__spectral_gfnet__glu_gated_bilinear__prompt_kernel_fok_68:
    v_lshlrev_b32 v63, 4, v1
    v_and_b32 v63, 0x300, v63
    v_lshl_add_u32 v63, v1, 4, v63
    v_lshlrev_b32 v80, 16, v48
    v_and_b32 v88, 0xffff0000, v48
    v_lshlrev_b32 v81, 16, v49
    v_and_b32 v89, 0xffff0000, v49
    v_lshlrev_b32 v82, 16, v50
    v_and_b32 v90, 0xffff0000, v50
    v_lshlrev_b32 v83, 16, v51
    v_and_b32 v91, 0xffff0000, v51
    v_lshlrev_b32 v84, 16, v52
    v_and_b32 v92, 0xffff0000, v52
    v_lshlrev_b32 v85, 16, v53
    v_and_b32 v93, 0xffff0000, v53
    v_lshlrev_b32 v86, 16, v54
    v_and_b32 v94, 0xffff0000, v54
    v_lshlrev_b32 v87, 16, v55
    v_and_b32 v95, 0xffff0000, v55
    s_mov_b64 exec, 1
    ds_add_rtn_u32 v56, v57, v58
    s_waitcnt lgkmcnt(0)
    v_cmp_gt_u32 vcc, 7, v56
    s_cbranch_vccz L_adaLN_cond__spectral_gfnet__glu_gated_bilinear__prompt_kernel_gsd_70
    s_mov_b32 s97, 0
L_adaLN_cond__spectral_gfnet__glu_gated_bilinear__prompt_kernel_gs_71:
    ds_read_b32 v56, v57
    s_waitcnt lgkmcnt(0)
    v_cmp_gt_u32 vcc, 8, v56
    s_cbranch_vccz L_adaLN_cond__spectral_gfnet__glu_gated_bilinear__prompt_kernel_gs_71_x
    s_add_u32 s97, s97, 1
    s_cmp_lt_u32 s97, s96
    s_cbranch_scc1 L_adaLN_cond__spectral_gfnet__glu_gated_bilinear__prompt_kernel_gs_71
    s_mov_b32 s96, 0
L_adaLN_cond__spectral_gfnet__glu_gated_bilinear__prompt_kernel_gs_71_x:
L_adaLN_cond__spectral_gfnet__glu_gated_bilinear__prompt_kernel_gsd_70:
    s_mov_b64 exec, -1
    ds_read_b128 v[16:19], v61 offset:0
    ds_read_b128 v[20:23], v61 offset:64
    ds_read_b128 v[24:27], v61 offset:128
    ds_read_b128 v[28:31], v61 offset:192
    ds_read_b128 v[32:35], v61 offset:4352
    ds_read_b128 v[36:39], v61 offset:4416
    ds_read_b128 v[40:43], v61 offset:4480
    ds_read_b128 v[44:47], v61 offset:4544
    s_mov_b32 s28, 0
    buffer_load_dwordx4 v[128:131], v63, s[40:43], s28 offen offset:0 sc1
    s_mov_b32 s28, 0
    buffer_load_dwordx4 v[132:135], v63, s[40:43], s28 offen offset:256 sc1
    s_mov_b32 s28, 0
    buffer_load_dwordx4 v[136:139], v63, s[40:43], s28 offen offset:2048 sc1
    s_mov_b32 s28, 0
    buffer_load_dwordx4 v[140:143], v63, s[40:43], s28 offen offset:2304 sc1
    s_waitcnt lgkmcnt(0)
    v_mfma_f32_16x16x32_bf16 v[96:99], v[16:19], v[192:195], 0
    v_mfma_f32_16x16x32_bf16 v[104:107], v[16:19], v[208:211], 0
    v_mfma_f32_16x16x32_bf16 v[100:103], v[32:35], v[192:195], 0
    v_mfma_f32_16x16x32_bf16 v[108:111], v[32:35], v[208:211], 0
    v_mfma_f32_16x16x32_bf16 v[96:99], v[20:23], v[196:199], v[96:99]
    v_mfma_f32_16x16x32_bf16 v[104:107], v[20:23], v[212:215], v[104:107]
    v_mfma_f32_16x16x32_bf16 v[100:103], v[36:39], v[196:199], v[100:103]
    v_mfma_f32_16x16x32_bf16 v[108:111], v[36:39], v[212:215], v[108:111]
    v_mfma_f32_16x16x32_bf16 v[96:99], v[24:27], v[200:203], v[96:99]
    v_mfma_f32_16x16x32_bf16 v[104:107], v[24:27], v[216:219], v[104:107]
    v_mfma_f32_16x16x32_bf16 v[100:103], v[40:43], v[200:203], v[100:103]
    v_mfma_f32_16x16x32_bf16 v[108:111], v[40:43], v[216:219], v[108:111]
    v_mfma_f32_16x16x32_bf16 v[96:99], v[28:31], v[204:207], v[96:99]
    v_mfma_f32_16x16x32_bf16 v[104:107], v[28:31], v[220:223], v[104:107]
    v_mfma_f32_16x16x32_bf16 v[100:103], v[44:47], v[204:207], v[100:103]
    v_mfma_f32_16x16x32_bf16 v[108:111], v[44:47], v[220:223], v[108:111]
    s_nop 4
    v_pk_mul_f32 v[112:113], v[96:97], v[64:65]
    v_pk_mul_f32 v[120:121], v[104:105], v[64:65]
    v_pk_mul_f32 v[114:115], v[98:99], v[66:67]
    v_pk_mul_f32 v[122:123], v[106:107], v[66:67]
    v_pk_mul_f32 v[116:117], v[100:101], v[68:69]
    v_pk_mul_f32 v[124:125], v[108:109], v[68:69]
    v_pk_mul_f32 v[118:119], v[102:103], v[70:71]
    v_pk_mul_f32 v[126:127], v[110:111], v[70:71]
    v_pk_fma_f32 v[112:113], v[104:105], v[72:73], v[112:113]
    v_pk_fma_f32 v[120:121], v[96:97], v[72:73], v[120:121] neg_lo:[1,0,0] neg_hi:[1,0,0]
    v_pk_fma_f32 v[114:115], v[106:107], v[74:75], v[114:115]
    v_pk_fma_f32 v[122:123], v[98:99], v[74:75], v[122:123] neg_lo:[1,0,0] neg_hi:[1,0,0]
    v_pk_fma_f32 v[116:117], v[108:109], v[76:77], v[116:117]
    v_pk_fma_f32 v[124:125], v[100:101], v[76:77], v[124:125] neg_lo:[1,0,0] neg_hi:[1,0,0]
    v_pk_fma_f32 v[118:119], v[110:111], v[78:79], v[118:119]
    v_pk_fma_f32 v[126:127], v[102:103], v[78:79], v[126:127] neg_lo:[1,0,0] neg_hi:[1,0,0]
    v_cvt_pk_bf16_f32 v16, v112, v120
    v_cvt_pk_bf16_f32 v17, v113, v121
    v_cvt_pk_bf16_f32 v18, v114, v122
    v_cvt_pk_bf16_f32 v19, v115, v123
    v_cvt_pk_bf16_f32 v20, v116, v124
    v_cvt_pk_bf16_f32 v21, v117, v125
    v_cvt_pk_bf16_f32 v22, v118, v126
    v_cvt_pk_bf16_f32 v23, v119, v127
    v_mfma_f32_16x16x32_bf16 v[96:99], v[224:227], v[16:19], 0
    v_mfma_f32_16x16x32_bf16 v[104:107], v[240:243], v[16:19], 0
    v_mfma_f32_16x16x32_bf16 v[100:103], v[232:235], v[16:19], 0
    v_mfma_f32_16x16x32_bf16 v[108:111], v[248:251], v[16:19], 0
    v_mfma_f32_16x16x32_bf16 v[96:99], v[228:231], v[20:23], v[96:99]
    v_mfma_f32_16x16x32_bf16 v[104:107], v[244:247], v[20:23], v[104:107]
    v_mfma_f32_16x16x32_bf16 v[100:103], v[236:239], v[20:23], v[100:103]
    v_mfma_f32_16x16x32_bf16 v[108:111], v[252:255], v[20:23], v[108:111]
    s_mov_b32 s28, 4096
    buffer_load_dwordx4 v[144:147], v63, s[40:43], s28 offen offset:0 sc1
    s_mov_b32 s28, 4096
    buffer_load_dwordx4 v[148:151], v63, s[40:43], s28 offen offset:256 sc1
    s_mov_b32 s28, 4096
    buffer_load_dwordx4 v[152:155], v63, s[40:43], s28 offen offset:2048 sc1
    s_mov_b32 s28, 4096
    buffer_load_dwordx4 v[156:159], v63, s[40:43], s28 offen offset:2304 sc1
    v_pk_mul_f32 v[112:113], v[96:97], v[80:81]
    v_pk_mul_f32 v[120:121], v[96:97], v[88:89] neg_lo:[1,0] neg_hi:[1,0]
    v_pk_mul_f32 v[114:115], v[98:99], v[82:83]
    v_pk_mul_f32 v[122:123], v[98:99], v[90:91] neg_lo:[1,0] neg_hi:[1,0]
    v_pk_mul_f32 v[116:117], v[100:101], v[84:85]
    v_pk_mul_f32 v[124:125], v[100:101], v[92:93] neg_lo:[1,0] neg_hi:[1,0]
    v_pk_mul_f32 v[118:119], v[102:103], v[86:87]
    v_pk_mul_f32 v[126:127], v[102:103], v[94:95] neg_lo:[1,0] neg_hi:[1,0]
    v_pk_fma_f32 v[112:113], v[104:105], v[88:89], v[112:113] neg_lo:[1,0,0] neg_hi:[1,0,0]
    v_pk_fma_f32 v[120:121], v[104:105], v[80:81], v[120:121] neg_lo:[1,0,0] neg_hi:[1,0,0]
    v_pk_fma_f32 v[114:115], v[106:107], v[90:91], v[114:115] neg_lo:[1,0,0] neg_hi:[1,0,0]
    v_pk_fma_f32 v[122:123], v[106:107], v[82:83], v[122:123] neg_lo:[1,0,0] neg_hi:[1,0,0]
    v_pk_fma_f32 v[116:117], v[108:109], v[92:93], v[116:117] neg_lo:[1,0,0] neg_hi:[1,0,0]
    v_pk_fma_f32 v[124:125], v[108:109], v[84:85], v[124:125] neg_lo:[1,0,0] neg_hi:[1,0,0]
    v_pk_fma_f32 v[118:119], v[110:111], v[94:95], v[118:119] neg_lo:[1,0,0] neg_hi:[1,0,0]
    v_pk_fma_f32 v[126:127], v[110:111], v[86:87], v[126:127] neg_lo:[1,0,0] neg_hi:[1,0,0]
    v_cvt_pk_bf16_f32 v16, v112, v120
    v_cvt_pk_bf16_f32 v17, v113, v121
    v_cvt_pk_bf16_f32 v18, v114, v122
    v_cvt_pk_bf16_f32 v19, v115, v123
    v_cvt_pk_bf16_f32 v20, v116, v124
    v_cvt_pk_bf16_f32 v21, v117, v125
    v_cvt_pk_bf16_f32 v22, v118, v126
    v_cvt_pk_bf16_f32 v23, v119, v127
    v_mfma_f32_16x16x32_bf16 v[96:99], v[224:227], v[16:19], 0
    v_mfma_f32_16x16x32_bf16 v[104:107], v[240:243], v[16:19], 0
    v_mfma_f32_16x16x32_bf16 v[100:103], v[232:235], v[16:19], 0
    v_mfma_f32_16x16x32_bf16 v[108:111], v[248:251], v[16:19], 0
    v_mfma_f32_16x16x32_bf16 v[96:99], v[228:231], v[20:23], v[96:99]
    v_mfma_f32_16x16x32_bf16 v[104:107], v[244:247], v[20:23], v[104:107]
    v_mfma_f32_16x16x32_bf16 v[100:103], v[236:239], v[20:23], v[100:103]
    v_mfma_f32_16x16x32_bf16 v[108:111], v[252:255], v[20:23], v[108:111]
    s_mov_b32 s28, 8192
    buffer_load_dwordx4 v[160:163], v63, s[40:43], s28 offen offset:0 sc1
    s_mov_b32 s28, 8192
    buffer_load_dwordx4 v[164:167], v63, s[40:43], s28 offen offset:256 sc1
    s_mov_b32 s28, 8192
    buffer_load_dwordx4 v[168:171], v63, s[40:43], s28 offen offset:2048 sc1
    s_mov_b32 s28, 8192
    buffer_load_dwordx4 v[172:175], v63, s[40:43], s28 offen offset:2304 sc1
    v_pk_mul_f32 v[112:113], v[96:97], v[64:65]
    v_pk_mul_f32 v[120:121], v[104:105], v[64:65]
    v_pk_mul_f32 v[114:115], v[98:99], v[66:67]
    v_pk_mul_f32 v[122:123], v[106:107], v[66:67]
    v_pk_mul_f32 v[116:117], v[100:101], v[68:69]
    v_pk_mul_f32 v[124:125], v[108:109], v[68:69]
    v_pk_mul_f32 v[118:119], v[102:103], v[70:71]
    v_pk_mul_f32 v[126:127], v[110:111], v[70:71]
    v_pk_fma_f32 v[112:113], v[104:105], v[72:73], v[112:113]
    v_pk_fma_f32 v[120:121], v[96:97], v[72:73], v[120:121] neg_lo:[1,0,0] neg_hi:[1,0,0]
    v_pk_fma_f32 v[114:115], v[106:107], v[74:75], v[114:115]
    v_pk_fma_f32 v[122:123], v[98:99], v[74:75], v[122:123] neg_lo:[1,0,0] neg_hi:[1,0,0]
    v_pk_fma_f32 v[116:117], v[108:109], v[76:77], v[116:117]
    v_pk_fma_f32 v[124:125], v[100:101], v[76:77], v[124:125] neg_lo:[1,0,0] neg_hi:[1,0,0]
    v_pk_fma_f32 v[118:119], v[110:111], v[78:79], v[118:119]
    v_pk_fma_f32 v[126:127], v[102:103], v[78:79], v[126:127] neg_lo:[1,0,0] neg_hi:[1,0,0]
    v_cvt_pk_bf16_f32 v16, v112, v120
    v_cvt_pk_bf16_f32 v17, v113, v121
    v_cvt_pk_bf16_f32 v18, v114, v122
    v_cvt_pk_bf16_f32 v19, v115, v123
    v_cvt_pk_bf16_f32 v20, v116, v124
    v_cvt_pk_bf16_f32 v21, v117, v125
    v_cvt_pk_bf16_f32 v22, v118, v126
    v_cvt_pk_bf16_f32 v23, v119, v127
    ds_write_b32 v60, v16 offset:0
    ds_write_b32 v60, v17 offset:272
    ds_write_b32 v60, v18 offset:544
    ds_write_b32 v60, v19 offset:816
    ds_write_b32 v60, v20 offset:4352
    ds_write_b32 v60, v21 offset:4624
    ds_write_b32 v60, v22 offset:4896
    ds_write_b32 v60, v23 offset:5168
    s_mov_b64 exec, 1
    ds_add_rtn_u32 v56, v57, v58
    s_waitcnt lgkmcnt(0)
    v_cmp_gt_u32 vcc, 11, v56
    s_cbranch_vccz L_adaLN_cond__spectral_gfnet__glu_gated_bilinear__prompt_kernel_gsd_72
    s_mov_b32 s97, 0
L_adaLN_cond__spectral_gfnet__glu_gated_bilinear__prompt_kernel_gs_73:
    ds_read_b32 v56, v57
    s_waitcnt lgkmcnt(0)
    v_cmp_gt_u32 vcc, 12, v56
    s_cbranch_vccz L_adaLN_cond__spectral_gfnet__glu_gated_bilinear__prompt_kernel_gs_73_x
    s_add_u32 s97, s97, 1
    s_cmp_lt_u32 s97, s96
    s_cbranch_scc1 L_adaLN_cond__spectral_gfnet__glu_gated_bilinear__prompt_kernel_gs_73
    s_mov_b32 s96, 0
L_adaLN_cond__spectral_gfnet__glu_gated_bilinear__prompt_kernel_gs_73_x:
L_adaLN_cond__spectral_gfnet__glu_gated_bilinear__prompt_kernel_gsd_72:
    s_mov_b64 exec, -1
    ds_read_b128 v[24:27], v62 offset:0
    ds_read_b128 v[28:31], v62 offset:64
    ds_read_b128 v[32:35], v62 offset:128
    ds_read_b128 v[36:39], v62 offset:192
    ds_read_b128 v[40:43], v62 offset:4352
    ds_read_b128 v[44:47], v62 offset:4416
    ds_read_b128 v[48:51], v62 offset:4480
    ds_read_b128 v[52:55], v62 offset:4544
    v_mov_b32 v59, 163136
    ds_read_b32 v56, v59
    s_mov_b32 s28, 12288
    buffer_load_dwordx4 v[176:179], v63, s[40:43], s28 offen offset:0 sc1
    s_mov_b32 s28, 12288
    buffer_load_dwordx4 v[180:183], v63, s[40:43], s28 offen offset:256 sc1
    s_mov_b32 s28, 12288
    buffer_load_dwordx4 v[184:187], v63, s[40:43], s28 offen offset:2048 sc1
    s_mov_b32 s28, 12288
    buffer_load_dwordx4 v[188:191], v63, s[40:43], s28 offen offset:2304 sc1
    s_and_b32 s16, s10, 3
    s_lshl_b32 s16, s16, 11
    s_lshl_b32 s17, s34, 13
    s_add_u32 s16, s16, s17
    s_add_u32 s16, s16, 4194304
    v_and_b32 v6, 7, v2
    v_lshlrev_b32 v6, 8, v6
    v_lshrrev_b32 v7, 3, v2
    v_lshlrev_b32 v7, 6, v7
    v_add_u32 v6, v6, v7
    v_lshlrev_b32 v7, 4, v3
    v_add_u32 v6, v6, v7
    v_add_u32 v8, s16, v6
    v_add_u32 v9, 128, v8
    s_waitcnt lgkmcnt(0)
    v_mfma_f32_16x16x32_bf16 v[96:99], v[192:195], v[24:27], 0
    v_mfma_f32_16x16x32_bf16 v[104:107], v[208:211], v[24:27], 0
    v_mfma_f32_16x16x32_bf16 v[100:103], v[192:195], v[40:43], 0
    v_mfma_f32_16x16x32_bf16 v[108:111], v[208:211], v[40:43], 0
    v_mfma_f32_16x16x32_bf16 v[96:99], v[196:199], v[28:31], v[96:99]
    v_mfma_f32_16x16x32_bf16 v[104:107], v[212:215], v[28:31], v[104:107]
    v_mfma_f32_16x16x32_bf16 v[100:103], v[196:199], v[44:47], v[100:103]
    v_mfma_f32_16x16x32_bf16 v[108:111], v[212:215], v[44:47], v[108:111]
    v_mfma_f32_16x16x32_bf16 v[96:99], v[200:203], v[32:35], v[96:99]
    v_mfma_f32_16x16x32_bf16 v[104:107], v[216:219], v[32:35], v[104:107]
    v_mfma_f32_16x16x32_bf16 v[100:103], v[200:203], v[48:51], v[100:103]
    v_mfma_f32_16x16x32_bf16 v[108:111], v[216:219], v[48:51], v[108:111]
    v_mfma_f32_16x16x32_bf16 v[96:99], v[204:207], v[36:39], v[96:99]
    v_mfma_f32_16x16x32_bf16 v[104:107], v[220:223], v[36:39], v[104:107]
    v_mfma_f32_16x16x32_bf16 v[100:103], v[204:207], v[52:55], v[100:103]
    v_mfma_f32_16x16x32_bf16 v[108:111], v[220:223], v[52:55], v[108:111]
    v_cmp_gt_u32 vcc, 4, v56
    s_cbranch_vccz L_adaLN_cond__spectral_gfnet__glu_gated_bilinear__prompt_kernel_zcok_74
    s_mov_b32 s97, 0
L_adaLN_cond__spectral_gfnet__glu_gated_bilinear__prompt_kernel_zc_75:
    ds_read_b32 v56, v59
    s_waitcnt lgkmcnt(0)
    v_cmp_gt_u32 vcc, 4, v56
    s_cbranch_vccz L_adaLN_cond__spectral_gfnet__glu_gated_bilinear__prompt_kernel_zc_75_x
    s_add_u32 s97, s97, 1
    s_cmp_lt_u32 s97, s96
    s_cbranch_scc1 L_adaLN_cond__spectral_gfnet__glu_gated_bilinear__prompt_kernel_zc_75
    s_mov_b32 s96, 0
L_adaLN_cond__spectral_gfnet__glu_gated_bilinear__prompt_kernel_zc_75_x:
L_adaLN_cond__spectral_gfnet__glu_gated_bilinear__prompt_kernel_zcok_74:
    v_cvt_pk_bf16_f32 v16, v96, v104
    v_cvt_pk_bf16_f32 v17, v97, v105
    v_cvt_pk_bf16_f32 v18, v98, v106
    v_cvt_pk_bf16_f32 v19, v99, v107
    v_cvt_pk_bf16_f32 v20, v100, v108
    v_cvt_pk_bf16_f32 v21, v101, v109
    v_cvt_pk_bf16_f32 v22, v102, v110
    v_cvt_pk_bf16_f32 v23, v103, v111
    global_store_dwordx4 v8, v[16:19], s[6:7] sc1
    global_store_dwordx4 v9, v[20:23], s[6:7] sc1
    s_branch L_adaLN_cond__spectral_gfnet__glu_gated_bilinear__prompt_kernel_p2end_36
L_adaLN_cond__spectral_gfnet__glu_gated_bilinear__prompt_kernel_p2actm_33:
    v_and_b32 v2, 15, v1
    v_lshrrev_b32 v3, 4, v1
    s_and_b32 s15, s10, 3
    s_lshl_b32 s15, s15, 4
    v_add_u32 v12, s15, v2
    v_cvt_f32_u32 v58, v12
    v_mul_f32 v58, 0x3a000000, v58
    v_lshlrev_b32 v59, 2, v3
    v_cvt_f32_u32 v59, v59
    v_mul_f32 v59, v59, v58
    s_mov_b32 s16, 0x0
    v_fma_f32 v72, v58, s16, v59
    s_mov_b32 s16, 0x3f800000
    v_fma_f32 v73, v58, s16, v59
    s_mov_b32 s16, 0x40000000
    v_fma_f32 v74, v58, s16, v59
    s_mov_b32 s16, 0x40400000
    v_fma_f32 v75, v58, s16, v59
    s_mov_b32 s16, 0x41800000
    v_fma_f32 v76, v58, s16, v59
    s_mov_b32 s16, 0x41880000
    v_fma_f32 v77, v58, s16, v59
    s_mov_b32 s16, 0x41900000
    v_fma_f32 v78, v58, s16, v59
    s_mov_b32 s16, 0x41980000
    v_fma_f32 v79, v58, s16, v59
    v_cos_f32 v64, v72
    v_cos_f32 v65, v73
    v_cos_f32 v66, v74
    v_cos_f32 v67, v75
    v_cos_f32 v68, v76
    v_cos_f32 v69, v77
    v_cos_f32 v70, v78
    v_cos_f32 v71, v79
    v_sin_f32 v72, v72
    v_sin_f32 v73, v73
    v_sin_f32 v74, v74
    v_sin_f32 v75, v75
    v_sin_f32 v76, v76
    v_sin_f32 v77, v77
    v_sin_f32 v78, v78
    v_sin_f32 v79, v79
    s_mov_b32 s16, 0x3ab504f3
    s_and_b32 s17, s34, 255
    s_cmp_eq_u32 s17, 0
    s_cselect_b32 s16, 0x3a800000, s16
    v_pk_mul_f32 v[64:65], v[64:65], s[16:17] op_sel_hi:[1,0]
    v_pk_mul_f32 v[72:73], v[72:73], s[16:17] op_sel_hi:[1,0]
    v_pk_mul_f32 v[66:67], v[66:67], s[16:17] op_sel_hi:[1,0]
    v_pk_mul_f32 v[74:75], v[74:75], s[16:17] op_sel_hi:[1,0]
    v_pk_mul_f32 v[68:69], v[68:69], s[16:17] op_sel_hi:[1,0]
    v_pk_mul_f32 v[76:77], v[76:77], s[16:17] op_sel_hi:[1,0]
    v_pk_mul_f32 v[70:71], v[70:71], s[16:17] op_sel_hi:[1,0]
    v_pk_mul_f32 v[78:79], v[78:79], s[16:17] op_sel_hi:[1,0]
    s_mov_b32 s33, 49152
    s_cmp_lt_u32 s10, 4
    s_cselect_b32 s33, 131072, s33
    s_lshr_b32 s32, s10, 2
    s_mul_i32 s32, s32, 8704
    s_add_u32 s32, s32, 0
    v_mul_u32_u24 v60, 1088, v3
    v_lshlrev_b32 v61, 2, v12
    v_add_u32 v60, v60, v61
    v_add_u32 v60, s32, v60
    v_mul_u32_u24 v61, 272, v2
    v_lshlrev_b32 v62, 4, v3
    v_add_u32 v61, v61, v62
    v_add_u32 v62, s32, v61
    v_add_u32 v61, s33, v61
    s_lshr_b32 s16, s10, 2
    s_lshl_b32 s16, s16, 4
    s_add_u32 s16, s16, 163088
    v_mov_b32 v57, s16
    v_mov_b32 v58, 1
    v_and_b32 v4, 255, v0
    v_lshrrev_b32 v5, 1, v4
    v_mul_u32_u24 v8, 8320, v5
    v_and_b32 v6, 1, v4
    v_lshlrev_b32 v6, 4, v6
    v_add_u32 v8, v8, v6
    s_lshl_b32 s16, s34, 5
    s_add_u32 s17, s16, 1048576
    v_add_u32 v8, s17, v8
    v_add_u32 v9, 1064960, v8
    v_and_b32 v10, 31, v5
    v_mul_u32_u24 v10, 272, v10
    v_lshrrev_b32 v11, 5, v5
    v_lshlrev_b32 v11, 5, v11
    v_add_u32 v10, v10, v11
    v_add_u32 v10, v10, v6
    v_add_u32 v10, s33, v10
    v_lshlrev_b32 v13, 5, v3
    v_lshrrev_b32 v14, 3, v2
    v_add_u32 v13, v13, v14
    s_and_b32 s17, s10, 3
    s_lshl_b32 s17, s17, 1
    v_add_u32 v13, s17, v13
    v_mul_u32_u24 v13, 8320, v13
    v_and_b32 v14, 7, v2
    v_lshlrev_b32 v14, 2, v14
    v_add_u32 v13, v13, v14
    s_add_u32 s17, s16, 7340032
    v_add_u32 v13, s17, v13
    s_cmp_eq_u32 s10, 0
    s_cbranch_scc1 L_adaLN_cond__spectral_gfnet__glu_gated_bilinear__prompt_kernel_aw0_76
    s_waitcnt vmcnt(1)
    s_branch L_adaLN_cond__spectral_gfnet__glu_gated_bilinear__prompt_kernel_aw1_77
L_adaLN_cond__spectral_gfnet__glu_gated_bilinear__prompt_kernel_aw0_76:
    s_waitcnt vmcnt(2)
L_adaLN_cond__spectral_gfnet__glu_gated_bilinear__prompt_kernel_aw1_77:
    v_cmp_ne_u32 vcc, s3, v92
    s_cbranch_vccz L_adaLN_cond__spectral_gfnet__glu_gated_bilinear__prompt_kernel_fok_78
    s_mov_b32 s97, 0
L_adaLN_cond__spectral_gfnet__glu_gated_bilinear__prompt_kernel_flam_79:
    global_load_dword v92, v93, s[6:7] sc1
    s_waitcnt vmcnt(0)
    v_cmp_ne_u32 vcc, s3, v92
    s_cbranch_vccz L_adaLN_cond__spectral_gfnet__glu_gated_bilinear__prompt_kernel_flam_79_x
    s_add_u32 s97, s97, 1
    s_cmp_lt_u32 s97, s96
    s_cbranch_scc1 L_adaLN_cond__spectral_gfnet__glu_gated_bilinear__prompt_kernel_flam_79
    s_mov_b32 s96, 0
L_adaLN_cond__spectral_gfnet__glu_gated_bilinear__prompt_kernel_flam_79_x:
L_adaLN_cond__spectral_gfnet__glu_gated_bilinear__prompt_kernel_fok_78:
    s_mov_b64 exec, 1
    ds_add_rtn_u32 v56, v57, v58
    s_waitcnt lgkmcnt(0)
    v_cmp_gt_u32 vcc, 3, v56
    s_cbranch_vccz L_adaLN_cond__spectral_gfnet__glu_gated_bilinear__prompt_kernel_gsd_80
    s_mov_b32 s97, 0
L_adaLN_cond__spectral_gfnet__glu_gated_bilinear__prompt_kernel_gs_81:
    ds_read_b32 v56, v57
    s_waitcnt lgkmcnt(0)
    v_cmp_gt_u32 vcc, 4, v56
    s_cbranch_vccz L_adaLN_cond__spectral_gfnet__glu_gated_bilinear__prompt_kernel_gs_81_x
    s_add_u32 s97, s97, 1
    s_cmp_lt_u32 s97, s96
    s_cbranch_scc1 L_adaLN_cond__spectral_gfnet__glu_gated_bilinear__prompt_kernel_gs_81
    s_mov_b32 s96, 0
L_adaLN_cond__spectral_gfnet__glu_gated_bilinear__prompt_kernel_gs_81_x:
L_adaLN_cond__spectral_gfnet__glu_gated_bilinear__prompt_kernel_gsd_80:
    s_mov_b64 exec, -1
    s_add_u32 s18, s6, 0
    s_addc_u32 s19, s7, 0
    global_load_dword v48, v13, s[18:19] sc1
    s_add_u32 s18, s6, 66560
    s_addc_u32 s19, s7, 0
    global_load_dword v49, v13, s[18:19] sc1
    s_add_u32 s18, s6, 133120
    s_addc_u32 s19, s7, 0
    global_load_dword v50, v13, s[18:19] sc1
    s_add_u32 s18, s6, 199680
    s_addc_u32 s19, s7, 0
    global_load_dword v51, v13, s[18:19] sc1
    s_add_u32 s18, s6, 1064960
    s_addc_u32 s19, s7, 0
    global_load_dword v52, v13, s[18:19] sc1
    s_add_u32 s18, s6, 1131520
    s_addc_u32 s19, s7, 0
    global_load_dword v53, v13, s[18:19] sc1
    s_add_u32 s18, s6, 1198080
    s_addc_u32 s19, s7, 0
    global_load_dword v54, v13, s[18:19] sc1
    s_add_u32 s18, s6, 1264640
    s_addc_u32 s19, s7, 0
    global_load_dword v55, v13, s[18:19] sc1
    s_mov_b32 s97, 0
L_adaLN_cond__spectral_gfnet__glu_gated_bilinear__prompt_kernel_z1p_82:
    global_load_dwordx4 v[16:19], v8, s[6:7] sc1
    global_load_dwordx4 v[20:23], v9, s[6:7] sc1
    s_waitcnt vmcnt(0)
    v_max3_u32 v24, v16, v17, v18
    v_max3_u32 v24, v24, v19, v20
    v_max3_u32 v24, v24, v21, v22
    v_max_u32 v24, v24, v23
    v_cmp_eq_u32 vcc, -1, v24
    s_cbranch_vccz L_adaLN_cond__spectral_gfnet__glu_gated_bilinear__prompt_kernel_z1p_82_x
    s_mov_b64 exec, vcc
    s_add_u32 s97, s97, 1
    s_cmp_lt_u32 s97, s96
    s_cbranch_scc1 L_adaLN_cond__spectral_gfnet__glu_gated_bilinear__prompt_kernel_z1p_82
    s_mov_b32 s96, 0
L_adaLN_cond__spectral_gfnet__glu_gated_bilinear__prompt_kernel_z1p_82_x:
    s_mov_b64 exec, -1
    ds_write_b128 v10, v[16:19]
    ds_write_b128 v10, v[20:23] offset:128
    v_and_b32 v129, 255, v0
    v_lshlrev_b32 v129, 7, v129
    v_add_u32 v129, 196608, v129
    v_and_b32 v136, 255, v0
    v_lshlrev_b32 v136, 3, v136
    v_add_u32 v136, 24576, v136
    global_load_dword v128, v129, s[6:7] sc1
    global_load_dwordx2 v[130:131], v136, s[6:7] offset:0 sc1
    global_load_dwordx2 v[132:133], v136, s[6:7] offset:2048 sc1
    v_add_u32 v137, 4096, v136
    global_load_dwordx2 v[134:135], v137, s[6:7] sc1
    v_lshlrev_b32 v80, 16, v48
    v_and_b32 v88, 0xffff0000, v48
    v_lshlrev_b32 v81, 16, v49
    v_and_b32 v89, 0xffff0000, v49
    v_lshlrev_b32 v82, 16, v50
    v_and_b32 v90, 0xffff0000, v50
    v_lshlrev_b32 v83, 16, v51
    v_and_b32 v91, 0xffff0000, v51
    v_lshlrev_b32 v84, 16, v52
    v_and_b32 v92, 0xffff0000, v52
    v_lshlrev_b32 v85, 16, v53
    v_and_b32 v93, 0xffff0000, v53
    v_lshlrev_b32 v86, 16, v54
    v_and_b32 v94, 0xffff0000, v54
    v_lshlrev_b32 v87, 16, v55
    v_and_b32 v95, 0xffff0000, v55
    s_mov_b64 exec, 1
    ds_add_rtn_u32 v56, v57, v58
    s_waitcnt lgkmcnt(0)
    v_cmp_gt_u32 vcc, 7, v56
    s_cbranch_vccz L_adaLN_cond__spectral_gfnet__glu_gated_bilinear__prompt_kernel_gsd_83
    s_mov_b32 s97, 0
L_adaLN_cond__spectral_gfnet__glu_gated_bilinear__prompt_kernel_gs_84:
    ds_read_b32 v56, v57
    s_waitcnt lgkmcnt(0)
    v_cmp_gt_u32 vcc, 8, v56
    s_cbranch_vccz L_adaLN_cond__spectral_gfnet__glu_gated_bilinear__prompt_kernel_gs_84_x
    s_add_u32 s97, s97, 1
    s_cmp_lt_u32 s97, s96
    s_cbranch_scc1 L_adaLN_cond__spectral_gfnet__glu_gated_bilinear__prompt_kernel_gs_84
    s_mov_b32 s96, 0
L_adaLN_cond__spectral_gfnet__glu_gated_bilinear__prompt_kernel_gs_84_x:
L_adaLN_cond__spectral_gfnet__glu_gated_bilinear__prompt_kernel_gsd_83:
    s_mov_b64 exec, -1
    ds_read_b128 v[16:19], v61 offset:0
    ds_read_b128 v[20:23], v61 offset:64
    ds_read_b128 v[24:27], v61 offset:128
    ds_read_b128 v[28:31], v61 offset:192
    ds_read_b128 v[32:35], v61 offset:4352
    ds_read_b128 v[36:39], v61 offset:4416
    ds_read_b128 v[40:43], v61 offset:4480
    ds_read_b128 v[44:47], v61 offset:4544
    s_waitcnt lgkmcnt(0)
    v_mfma_f32_16x16x32_bf16 v[96:99], v[16:19], v[192:195], 0
    v_mfma_f32_16x16x32_bf16 v[104:107], v[16:19], v[208:211], 0
    v_mfma_f32_16x16x32_bf16 v[100:103], v[32:35], v[192:195], 0
    v_mfma_f32_16x16x32_bf16 v[108:111], v[32:35], v[208:211], 0
    v_mfma_f32_16x16x32_bf16 v[96:99], v[20:23], v[196:199], v[96:99]
    v_mfma_f32_16x16x32_bf16 v[104:107], v[20:23], v[212:215], v[104:107]
    v_mfma_f32_16x16x32_bf16 v[100:103], v[36:39], v[196:199], v[100:103]
    v_mfma_f32_16x16x32_bf16 v[108:111], v[36:39], v[212:215], v[108:111]
    v_mfma_f32_16x16x32_bf16 v[96:99], v[24:27], v[200:203], v[96:99]
    v_mfma_f32_16x16x32_bf16 v[104:107], v[24:27], v[216:219], v[104:107]
    v_mfma_f32_16x16x32_bf16 v[100:103], v[40:43], v[200:203], v[100:103]
    v_mfma_f32_16x16x32_bf16 v[108:111], v[40:43], v[216:219], v[108:111]
    v_mfma_f32_16x16x32_bf16 v[96:99], v[28:31], v[204:207], v[96:99]
    v_mfma_f32_16x16x32_bf16 v[104:107], v[28:31], v[220:223], v[104:107]
    v_mfma_f32_16x16x32_bf16 v[100:103], v[44:47], v[204:207], v[100:103]
    v_mfma_f32_16x16x32_bf16 v[108:111], v[44:47], v[220:223], v[108:111]
    s_nop 4
    v_pk_mul_f32 v[112:113], v[96:97], v[64:65]
    v_pk_mul_f32 v[120:121], v[104:105], v[64:65]
    v_pk_mul_f32 v[114:115], v[98:99], v[66:67]
    v_pk_mul_f32 v[122:123], v[106:107], v[66:67]
    v_pk_mul_f32 v[116:117], v[100:101], v[68:69]
    v_pk_mul_f32 v[124:125], v[108:109], v[68:69]
    v_pk_mul_f32 v[118:119], v[102:103], v[70:71]
    v_pk_mul_f32 v[126:127], v[110:111], v[70:71]
    v_pk_fma_f32 v[112:113], v[104:105], v[72:73], v[112:113]
    v_pk_fma_f32 v[120:121], v[96:97], v[72:73], v[120:121] neg_lo:[1,0,0] neg_hi:[1,0,0]
    v_pk_fma_f32 v[114:115], v[106:107], v[74:75], v[114:115]
    v_pk_fma_f32 v[122:123], v[98:99], v[74:75], v[122:123] neg_lo:[1,0,0] neg_hi:[1,0,0]
    v_pk_fma_f32 v[116:117], v[108:109], v[76:77], v[116:117]
    v_pk_fma_f32 v[124:125], v[100:101], v[76:77], v[124:125] neg_lo:[1,0,0] neg_hi:[1,0,0]
    v_pk_fma_f32 v[118:119], v[110:111], v[78:79], v[118:119]
    v_pk_fma_f32 v[126:127], v[102:103], v[78:79], v[126:127] neg_lo:[1,0,0] neg_hi:[1,0,0]
    v_cvt_pk_bf16_f32 v16, v112, v120
    v_cvt_pk_bf16_f32 v17, v113, v121
    v_cvt_pk_bf16_f32 v18, v114, v122
    v_cvt_pk_bf16_f32 v19, v115, v123
    v_cvt_pk_bf16_f32 v20, v116, v124
    v_cvt_pk_bf16_f32 v21, v117, v125
    v_cvt_pk_bf16_f32 v22, v118, v126
    v_cvt_pk_bf16_f32 v23, v119, v127
    v_mfma_f32_16x16x32_bf16 v[96:99], v[224:227], v[16:19], 0
    v_mfma_f32_16x16x32_bf16 v[104:107], v[240:243], v[16:19], 0
    v_mfma_f32_16x16x32_bf16 v[100:103], v[232:235], v[16:19], 0
    v_mfma_f32_16x16x32_bf16 v[108:111], v[248:251], v[16:19], 0
    v_mfma_f32_16x16x32_bf16 v[96:99], v[228:231], v[20:23], v[96:99]
    v_mfma_f32_16x16x32_bf16 v[104:107], v[244:247], v[20:23], v[104:107]
    v_mfma_f32_16x16x32_bf16 v[100:103], v[236:239], v[20:23], v[100:103]
    v_mfma_f32_16x16x32_bf16 v[108:111], v[252:255], v[20:23], v[108:111]
    s_nop 4
    v_pk_mul_f32 v[112:113], v[96:97], v[80:81]
    v_pk_mul_f32 v[120:121], v[96:97], v[88:89] neg_lo:[1,0] neg_hi:[1,0]
    v_pk_mul_f32 v[114:115], v[98:99], v[82:83]
    v_pk_mul_f32 v[122:123], v[98:99], v[90:91] neg_lo:[1,0] neg_hi:[1,0]
    v_pk_mul_f32 v[116:117], v[100:101], v[84:85]
    v_pk_mul_f32 v[124:125], v[100:101], v[92:93] neg_lo:[1,0] neg_hi:[1,0]
    v_pk_mul_f32 v[118:119], v[102:103], v[86:87]
    v_pk_mul_f32 v[126:127], v[102:103], v[94:95] neg_lo:[1,0] neg_hi:[1,0]
    v_pk_fma_f32 v[112:113], v[104:105], v[88:89], v[112:113] neg_lo:[1,0,0] neg_hi:[1,0,0]
    v_pk_fma_f32 v[120:121], v[104:105], v[80:81], v[120:121] neg_lo:[1,0,0] neg_hi:[1,0,0]
    v_pk_fma_f32 v[114:115], v[106:107], v[90:91], v[114:115] neg_lo:[1,0,0] neg_hi:[1,0,0]
    v_pk_fma_f32 v[122:123], v[106:107], v[82:83], v[122:123] neg_lo:[1,0,0] neg_hi:[1,0,0]
    v_pk_fma_f32 v[116:117], v[108:109], v[92:93], v[116:117] neg_lo:[1,0,0] neg_hi:[1,0,0]
    v_pk_fma_f32 v[124:125], v[108:109], v[84:85], v[124:125] neg_lo:[1,0,0] neg_hi:[1,0,0]
    v_pk_fma_f32 v[118:119], v[110:111], v[94:95], v[118:119] neg_lo:[1,0,0] neg_hi:[1,0,0]
    v_pk_fma_f32 v[126:127], v[110:111], v[86:87], v[126:127] neg_lo:[1,0,0] neg_hi:[1,0,0]
    v_cvt_pk_bf16_f32 v16, v112, v120
    v_cvt_pk_bf16_f32 v17, v113, v121
    v_cvt_pk_bf16_f32 v18, v114, v122
    v_cvt_pk_bf16_f32 v19, v115, v123
    v_cvt_pk_bf16_f32 v20, v116, v124
    v_cvt_pk_bf16_f32 v21, v117, v125
    v_cvt_pk_bf16_f32 v22, v118, v126
    v_cvt_pk_bf16_f32 v23, v119, v127
    v_mfma_f32_16x16x32_bf16 v[96:99], v[224:227], v[16:19], 0
    v_mfma_f32_16x16x32_bf16 v[104:107], v[240:243], v[16:19], 0
    v_mfma_f32_16x16x32_bf16 v[100:103], v[232:235], v[16:19], 0
    v_mfma_f32_16x16x32_bf16 v[108:111], v[248:251], v[16:19], 0
    v_mfma_f32_16x16x32_bf16 v[96:99], v[228:231], v[20:23], v[96:99]
    v_mfma_f32_16x16x32_bf16 v[104:107], v[244:247], v[20:23], v[104:107]
    v_mfma_f32_16x16x32_bf16 v[100:103], v[236:239], v[20:23], v[100:103]
    v_mfma_f32_16x16x32_bf16 v[108:111], v[252:255], v[20:23], v[108:111]
    s_nop 4
    v_pk_mul_f32 v[112:113], v[96:97], v[64:65]
    v_pk_mul_f32 v[120:121], v[104:105], v[64:65]
    v_pk_mul_f32 v[114:115], v[98:99], v[66:67]
    v_pk_mul_f32 v[122:123], v[106:107], v[66:67]
    v_pk_mul_f32 v[116:117], v[100:101], v[68:69]
    v_pk_mul_f32 v[124:125], v[108:109], v[68:69]
    v_pk_mul_f32 v[118:119], v[102:103], v[70:71]
    v_pk_mul_f32 v[126:127], v[110:111], v[70:71]
    v_pk_fma_f32 v[112:113], v[104:105], v[72:73], v[112:113]
    v_pk_fma_f32 v[120:121], v[96:97], v[72:73], v[120:121] neg_lo:[1,0,0] neg_hi:[1,0,0]
    v_pk_fma_f32 v[114:115], v[106:107], v[74:75], v[114:115]
    v_pk_fma_f32 v[122:123], v[98:99], v[74:75], v[122:123] neg_lo:[1,0,0] neg_hi:[1,0,0]
    v_pk_fma_f32 v[116:117], v[108:109], v[76:77], v[116:117]
    v_pk_fma_f32 v[124:125], v[100:101], v[76:77], v[124:125] neg_lo:[1,0,0] neg_hi:[1,0,0]
    v_pk_fma_f32 v[118:119], v[110:111], v[78:79], v[118:119]
    v_pk_fma_f32 v[126:127], v[102:103], v[78:79], v[126:127] neg_lo:[1,0,0] neg_hi:[1,0,0]
    v_cvt_pk_bf16_f32 v16, v112, v120
    v_cvt_pk_bf16_f32 v17, v113, v121
    v_cvt_pk_bf16_f32 v18, v114, v122
    v_cvt_pk_bf16_f32 v19, v115, v123
    v_cvt_pk_bf16_f32 v20, v116, v124
    v_cvt_pk_bf16_f32 v21, v117, v125
    v_cvt_pk_bf16_f32 v22, v118, v126
    v_cvt_pk_bf16_f32 v23, v119, v127
    ds_write_b32 v60, v16 offset:0
    ds_write_b32 v60, v17 offset:272
    ds_write_b32 v60, v18 offset:544
    ds_write_b32 v60, v19 offset:816
    ds_write_b32 v60, v20 offset:4352
    ds_write_b32 v60, v21 offset:4624
    ds_write_b32 v60, v22 offset:4896
    ds_write_b32 v60, v23 offset:5168
    s_mov_b64 exec, 1
    ds_add_rtn_u32 v56, v57, v58
    s_waitcnt lgkmcnt(0)
    v_cmp_gt_u32 vcc, 11, v56
    s_cbranch_vccz L_adaLN_cond__spectral_gfnet__glu_gated_bilinear__prompt_kernel_gsd_85
    s_mov_b32 s97, 0
L_adaLN_cond__spectral_gfnet__glu_gated_bilinear__prompt_kernel_gs_86:
    ds_read_b32 v56, v57
    s_waitcnt lgkmcnt(0)
    v_cmp_gt_u32 vcc, 12, v56
    s_cbranch_vccz L_adaLN_cond__spectral_gfnet__glu_gated_bilinear__prompt_kernel_gs_86_x
    s_add_u32 s97, s97, 1
    s_cmp_lt_u32 s97, s96
    s_cbranch_scc1 L_adaLN_cond__spectral_gfnet__glu_gated_bilinear__prompt_kernel_gs_86
    s_mov_b32 s96, 0
L_adaLN_cond__spectral_gfnet__glu_gated_bilinear__prompt_kernel_gs_86_x:
L_adaLN_cond__spectral_gfnet__glu_gated_bilinear__prompt_kernel_gsd_85:
    s_mov_b64 exec, -1
    ds_read_b128 v[24:27], v62 offset:0
    ds_read_b128 v[28:31], v62 offset:64
    ds_read_b128 v[32:35], v62 offset:128
    ds_read_b128 v[36:39], v62 offset:192
    ds_read_b128 v[40:43], v62 offset:4352
    ds_read_b128 v[44:47], v62 offset:4416
    ds_read_b128 v[48:51], v62 offset:4480
    ds_read_b128 v[52:55], v62 offset:4544
    v_mov_b32 v59, 163136
    ds_read_b32 v56, v59
    s_and_b32 s16, s10, 3
    s_lshl_b32 s16, s16, 11
    s_lshl_b32 s17, s34, 13
    s_add_u32 s16, s16, s17
    s_add_u32 s16, s16, 4194304
    v_and_b32 v6, 7, v2
    v_lshlrev_b32 v6, 8, v6
    v_lshrrev_b32 v7, 3, v2
    v_lshlrev_b32 v7, 6, v7
    v_add_u32 v6, v6, v7
    v_lshlrev_b32 v7, 4, v3
    v_add_u32 v6, v6, v7
    v_add_u32 v8, s16, v6
    v_add_u32 v9, 128, v8
    s_waitcnt lgkmcnt(0)
    v_mfma_f32_16x16x32_bf16 v[96:99], v[192:195], v[24:27], 0
    v_mfma_f32_16x16x32_bf16 v[104:107], v[208:211], v[24:27], 0
    v_mfma_f32_16x16x32_bf16 v[100:103], v[192:195], v[40:43], 0
    v_mfma_f32_16x16x32_bf16 v[108:111], v[208:211], v[40:43], 0
    v_mfma_f32_16x16x32_bf16 v[96:99], v[196:199], v[28:31], v[96:99]
    v_mfma_f32_16x16x32_bf16 v[104:107], v[212:215], v[28:31], v[104:107]
    v_mfma_f32_16x16x32_bf16 v[100:103], v[196:199], v[44:47], v[100:103]
    v_mfma_f32_16x16x32_bf16 v[108:111], v[212:215], v[44:47], v[108:111]
    v_mfma_f32_16x16x32_bf16 v[96:99], v[200:203], v[32:35], v[96:99]
    v_mfma_f32_16x16x32_bf16 v[104:107], v[216:219], v[32:35], v[104:107]
    v_mfma_f32_16x16x32_bf16 v[100:103], v[200:203], v[48:51], v[100:103]
    v_mfma_f32_16x16x32_bf16 v[108:111], v[216:219], v[48:51], v[108:111]
    v_mfma_f32_16x16x32_bf16 v[96:99], v[204:207], v[36:39], v[96:99]
    v_mfma_f32_16x16x32_bf16 v[104:107], v[220:223], v[36:39], v[104:107]
    v_mfma_f32_16x16x32_bf16 v[100:103], v[204:207], v[52:55], v[100:103]
    v_mfma_f32_16x16x32_bf16 v[108:111], v[220:223], v[52:55], v[108:111]
    v_cmp_gt_u32 vcc, 4, v56
    s_cbranch_vccz L_adaLN_cond__spectral_gfnet__glu_gated_bilinear__prompt_kernel_zcok_87
    s_mov_b32 s97, 0
L_adaLN_cond__spectral_gfnet__glu_gated_bilinear__prompt_kernel_zc_88:
    ds_read_b32 v56, v59
    s_waitcnt lgkmcnt(0)
    v_cmp_gt_u32 vcc, 4, v56
    s_cbranch_vccz L_adaLN_cond__spectral_gfnet__glu_gated_bilinear__prompt_kernel_zc_88_x
    s_add_u32 s97, s97, 1
    s_cmp_lt_u32 s97, s96
    s_cbranch_scc1 L_adaLN_cond__spectral_gfnet__glu_gated_bilinear__prompt_kernel_zc_88
    s_mov_b32 s96, 0
L_adaLN_cond__spectral_gfnet__glu_gated_bilinear__prompt_kernel_zc_88_x:
L_adaLN_cond__spectral_gfnet__glu_gated_bilinear__prompt_kernel_zcok_87:
    v_cvt_pk_bf16_f32 v16, v96, v104
    v_cvt_pk_bf16_f32 v17, v97, v105
    v_cvt_pk_bf16_f32 v18, v98, v106
    v_cvt_pk_bf16_f32 v19, v99, v107
    v_cvt_pk_bf16_f32 v20, v100, v108
    v_cvt_pk_bf16_f32 v21, v101, v109
    v_cvt_pk_bf16_f32 v22, v102, v110
    v_cvt_pk_bf16_f32 v23, v103, v111
    global_store_dwordx4 v8, v[16:19], s[6:7] sc1
    global_store_dwordx4 v9, v[20:23], s[6:7] sc1
    s_waitcnt vmcnt(2)
    v_xor_b32 v137, s3, v128
    v_xor_b32 v138, s3, v131
    v_or_b32 v137, v137, v138
    v_xor_b32 v138, s3, v133
    v_xor_b32 v139, s3, v135
    v_or3_b32 v137, v137, v138, v139
    v_cmp_ne_u32 vcc, 0, v137
    s_cbranch_vccz L_adaLN_cond__spectral_gfnet__glu_gated_bilinear__prompt_kernel_s2ok_89
    s_mov_b32 s97, 0
L_adaLN_cond__spectral_gfnet__glu_gated_bilinear__prompt_kernel_s2r_90:
    global_load_dword v128, v129, s[6:7] sc1
    global_load_dwordx2 v[130:131], v136, s[6:7] offset:0 sc1
    global_load_dwordx2 v[132:133], v136, s[6:7] offset:2048 sc1
    v_add_u32 v137, 4096, v136
    global_load_dwordx2 v[134:135], v137, s[6:7] sc1
    s_waitcnt vmcnt(0)
    v_xor_b32 v137, s3, v128
    v_xor_b32 v138, s3, v131
    v_or_b32 v137, v137, v138
    v_xor_b32 v138, s3, v133
    v_xor_b32 v139, s3, v135
    v_or3_b32 v137, v137, v138, v139
    v_cmp_ne_u32 vcc, 0, v137
    s_cbranch_vccz L_adaLN_cond__spectral_gfnet__glu_gated_bilinear__prompt_kernel_s2r_90_x
    s_add_u32 s97, s97, 1
    s_cmp_lt_u32 s97, s96
    s_cbranch_scc1 L_adaLN_cond__spectral_gfnet__glu_gated_bilinear__prompt_kernel_s2r_90
    s_mov_b32 s96, 0
L_adaLN_cond__spectral_gfnet__glu_gated_bilinear__prompt_kernel_s2r_90_x:
L_adaLN_cond__spectral_gfnet__glu_gated_bilinear__prompt_kernel_s2ok_89:
    v_subrev_u32 v137, 24576, v136
    v_add_u32 v137, 40960, v137
    v_and_b32 v131, 0xffff0000, v130
    v_lshlrev_b32 v130, 16, v130
    ds_write_b64 v137, v[130:131] offset:0
    v_and_b32 v133, 0xffff0000, v132
    v_lshlrev_b32 v132, 16, v132
    ds_write_b64 v137, v[132:133] offset:2048
    v_and_b32 v135, 0xffff0000, v134
    v_lshlrev_b32 v134, 16, v134
    ds_write_b64 v137, v[134:135] offset:4096
L_adaLN_cond__spectral_gfnet__glu_gated_bilinear__prompt_kernel_p2end_36:
    v_lshrrev_b32 v6, 3, v2
    v_lshlrev_b32 v6, 13, v6
    v_lshlrev_b32 v7, 19, v3
    v_add_u32 v6, v6, v7
    v_and_b32 v7, 7, v2
    v_lshlrev_b32 v7, 2, v7
    v_add_u32 v6, v6, v7
    s_lshl_b32 s13, s10, 14
    s_lshr_b32 s14, s12, 1
    s_lshl_b32 s14, s14, 11
    s_and_b32 s15, s11, 7
    s_lshl_b32 s15, s15, 8
    s_add_u32 s14, s14, s15
    s_lshr_b32 s15, s11, 3
    s_lshl_b32 s15, s15, 6
    s_add_u32 s14, s14, s15
    s_and_b32 s15, s12, 1
    s_lshl_b32 s15, s15, 5
    s_add_u32 s14, s14, s15
    s_add_u32 s14, s14, 4194304
    s_add_u32 s13, s13, s14
    v_add_u32 v6, s13, v6
    s_lshl_b32 s15, s10, 2
    s_add_u32 s15, s15, s14
    s_add_u32 s15, s15, 2097152
    v_mov_b32 v7, s15
    s_lshl_b32 s17, s10, 10
    s_add_u32 s17, s17, 32768
    v_lshlrev_b32 v8, 6, v2
    v_lshlrev_b32 v9, 3, v3
    v_add_u32 v8, v8, v9
    v_lshlrev_b32 v10, 1, v8
    v_add_u32 v9, s17, v8
    v_add_u32 v10, 40960, v10
    ds_read_b64 v[22:23], v9
    ds_read_b64 v[24:25], v9 offset:32
    s_add_u32 s20, s6, 0
    s_addc_u32 s21, s7, 0
    s_add_u32 s22, s6, 131072
    s_addc_u32 s23, s7, 0
    s_add_u32 s24, s6, 262144
    s_addc_u32 s25, s7, 0
    s_add_u32 s26, s6, 393216
    s_addc_u32 s27, s7, 0
    v_cvt_f32_u32 v12, v1
    v_mul_f32 v12, 0x3c800000, v12
    v_cos_f32 v13, v12
    v_sin_f32 v12, v12
    s_nop 0
    v_cvt_pk_bf16_f32 v4, v13, v12
    s_mov_b32 s18, 0x8000
    v_lshlrev_b32 v12, 3, v2
    v_add_u32 v12, 0, v12
    v_lshlrev_b32 v13, 2, v3
    v_mul_u32_u24 v13, v13, v12
    v_mad_u32_u24 v64, v12, 0, v13
    v_mad_u32_u24 v65, v12, 1, v13
    v_mad_u32_u24 v66, v12, 2, v13
    v_mad_u32_u24 v67, v12, 3, v13
    v_lshlrev_b32 v12, 3, v2
    v_add_u32 v12, 128, v12
    v_lshlrev_b32 v13, 2, v3
    v_mul_u32_u24 v13, v13, v12
    v_mad_u32_u24 v68, v12, 0, v13
    v_mad_u32_u24 v69, v12, 1, v13
    v_mad_u32_u24 v70, v12, 2, v13
    v_mad_u32_u24 v71, v12, 3, v13
    v_lshlrev_b32 v12, 4, v2
    v_lshlrev_b32 v13, 2, v3
    v_mul_u32_u24 v13, v13, v12
    v_mad_u32_u24 v76, v12, 0, v13
    v_mad_u32_u24 v77, v12, 1, v13
    v_mad_u32_u24 v78, v12, 2, v13
    v_mad_u32_u24 v79, v12, 3, v13
    ds_bpermute_b32 v56, v64, v4
    ds_bpermute_b32 v57, v65, v4
    ds_bpermute_b32 v58, v66, v4
    ds_bpermute_b32 v59, v67, v4
    ds_bpermute_b32 v60, v68, v4
    ds_bpermute_b32 v61, v69, v4
    ds_bpermute_b32 v62, v70, v4
    ds_bpermute_b32 v63, v71, v4
    ds_bpermute_b32 v72, v76, v4
    ds_bpermute_b32 v73, v77, v4
    ds_bpermute_b32 v74, v78, v4
    ds_bpermute_b32 v75, v79, v4
    v_lshrrev_b32 v12, 3, v2
    s_lshl_b32 s19, s10, 1
    v_add_u32 v12, s19, v12
    v_cvt_f32_u32 v14, v12
    v_mul_f32 v14, 0x3b000000, v14
    v_lshlrev_b32 v13, 2, v3
    v_cvt_f32_u32 v13, v13
    v_mul_f32 v13, v13, v14
    s_waitcnt lgkmcnt(0)
    s_mov_b32 s19, 0x0
    v_fma_f32 v84, v14, s19, v13
    s_mov_b32 s19, 0x3f800000
    v_fma_f32 v85, v14, s19, v13
    s_mov_b32 s19, 0x40000000
    v_fma_f32 v86, v14, s19, v13
    s_mov_b32 s19, 0x40400000
    v_fma_f32 v87, v14, s19, v13
    s_mov_b32 s19, 0x41800000
    v_fma_f32 v88, v14, s19, v13
    s_mov_b32 s19, 0x41880000
    v_fma_f32 v89, v14, s19, v13
    s_mov_b32 s19, 0x41900000
    v_fma_f32 v90, v14, s19, v13
    s_mov_b32 s19, 0x41980000
    v_fma_f32 v91, v14, s19, v13
    v_cos_f32 v76, v84
    v_cos_f32 v77, v85
    v_cos_f32 v78, v86
    v_cos_f32 v79, v87
    v_cos_f32 v80, v88
    v_cos_f32 v81, v89
    v_cos_f32 v82, v90
    v_cos_f32 v83, v91
    v_sin_f32 v84, v84
    v_sin_f32 v85, v85
    v_sin_f32 v86, v86
    v_sin_f32 v87, v87
    v_sin_f32 v88, v88
    v_sin_f32 v89, v89
    v_sin_f32 v90, v90
    v_sin_f32 v91, v91
    v_alignbit_b32 v64, v56, v56, 16
    v_alignbit_b32 v65, v57, v57, 16
    v_alignbit_b32 v66, v58, v58, 16
    v_alignbit_b32 v67, v59, v59, 16
    v_alignbit_b32 v68, v60, v60, 16
    v_alignbit_b32 v69, v61, v61, 16
    v_alignbit_b32 v70, v62, v62, 16
    v_alignbit_b32 v71, v63, v63, 16
    v_xor_b32 v64, s18, v64
    v_xor_b32 v65, s18, v65
    v_xor_b32 v66, s18, v66
    v_xor_b32 v67, s18, v67
    v_xor_b32 v68, s18, v68
    v_xor_b32 v69, s18, v69
    v_xor_b32 v70, s18, v70
    v_xor_b32 v71, s18, v71
    v_and_b32 v15, 7, v2
    v_mul_u32_u24 v15, 2336, v15
    v_mul_u32_u24 v12, 144, v12
    v_add_u32 v15, v15, v12
    v_lshlrev_b32 v12, 4, v3
    v_add_u32 v15, v15, v12
    v_add_u32 v15, 131072, v15
    s_mul_i32 s19, s10, 2336
    s_add_u32 s19, s19, 131072
    v_mul_u32_u24 v21, 576, v3
    v_lshlrev_b32 v12, 2, v2
    v_add_u32 v21, v21, v12
    v_add_u32 v21, s19, v21
    v_mul_u32_u24 v26, 80, v2
    v_lshlrev_b32 v12, 3, v3
    v_add_u32 v26, v26, v12
    v_add_u32 v26, s19, v26
    v_lshrrev_b32 v27, 2, v1
    v_mul_u32_u24 v27, 80, v27
    v_and_b32 v12, 3, v1
    v_lshlrev_b32 v12, 4, v12
    v_add_u32 v27, v27, v12
    v_add_u32 v27, s19, v27
    s_lshl_b32 s16, s11, 6
    s_lshl_b32 s17, s12, 3
    s_add_u32 s16, s16, s17
    s_lshl_b32 s16, s16, 10
    s_add_u32 s16, s16, 10485760
    v_lshlrev_b32 v52, 4, v0
    v_add_u32 v52, s16, v52
    s_lshr_b32 s16, s11, 1
    s_lshl_b32 s16, s16, 17
    s_and_b32 s17, s11, 1
    s_lshl_b32 s17, s17, 1
    s_lshr_b32 s18, s12, 2
    s_add_u32 s17, s17, s18
    s_lshl_b32 s17, s17, 15
    s_add_u32 s16, s16, s17
    s_and_b32 s18, s12, 3
    s_lshl_b32 s18, s18, 7
    s_add_u32 s16, s16, s18
    s_add_u32 s16, s16, 12582912
    v_lshrrev_b32 v53, 3, v0
    v_lshlrev_b32 v53, 9, v53
    v_and_b32 v12, 7, v0
    v_lshlrev_b32 v12, 4, v12
    v_add_u32 v53, v53, v12
    v_add_u32 v53, s16, v53
    v_lshlrev_b32 v12, 2, v2
    v_add_u32 v12, v12, v3
    v_add_u32 v13, s10, v12
    v_and_b32 v13, 7, v13
    v_lshlrev_b32 v13, 4, v13
    v_lshlrev_b32 v12, 7, v12
    v_add_u32 v12, v12, v13
    v_add_u32 v54, 149760, v12
    v_lshrrev_b32 v12, 3, v0
    v_add_u32 v13, v12, v0
    v_and_b32 v13, 7, v13
    v_lshlrev_b32 v13, 4, v13
    v_lshlrev_b32 v14, 7, v12
    v_add_u32 v13, v13, v14
    v_add_u32 v55, 149760, v13
L_adaLN_cond__spectral_gfnet__glu_gated_bilinear__prompt_kernel_p2e2_38:
    s_waitcnt lgkmcnt(0)
    s_barrier
    ds_read_b128 v[28:31], v10 offset:0
    ds_read_b128 v[36:39], v10 offset:2048
    ds_read_b128 v[44:47], v10 offset:4096
    ds_read_b128 v[32:35], v10 offset:64
    ds_read_b128 v[40:43], v10 offset:2112
    ds_read_b128 v[48:51], v10 offset:4160
    s_mov_b32 s97, 0
L_adaLN_cond__spectral_gfnet__glu_gated_bilinear__prompt_kernel_z2p_91:
    global_load_dword v16, v6, s[20:21] sc1
    global_load_dword v17, v6, s[22:23] sc1
    global_load_dword v18, v6, s[24:25] sc1
    global_load_dword v19, v6, s[26:27] sc1
    global_load_dword v20, v7, s[6:7] sc1
    s_waitcnt vmcnt(0)
    v_max3_u32 v12, v16, v17, v18
    v_max3_u32 v12, v12, v19, v20
    v_cmp_eq_u32 vcc, -1, v12
    s_cbranch_vccz L_adaLN_cond__spectral_gfnet__glu_gated_bilinear__prompt_kernel_z2p_91_x
    s_add_u32 s97, s97, 1
    s_cmp_lt_u32 s97, s96
    s_cbranch_scc1 L_adaLN_cond__spectral_gfnet__glu_gated_bilinear__prompt_kernel_z2p_91
    s_mov_b32 s96, 0
L_adaLN_cond__spectral_gfnet__glu_gated_bilinear__prompt_kernel_z2p_91_x:
    v_mfma_f32_16x16x32_bf16 v[96:99], v[56:59], v[16:19], 0
    v_mfma_f32_16x16x32_bf16 v[104:107], v[64:67], v[16:19], 0
    v_mfma_f32_16x16x32_bf16 v[100:103], v[60:63], v[16:19], 0
    v_mfma_f32_16x16x32_bf16 v[108:111], v[68:71], v[16:19], 0
    s_cmp_lt_u32 s2, 32
    s_cbranch_scc1 L_adaLN_cond__spectral_gfnet__glu_gated_bilinear__prompt_kernel_nobg3_92
    s_cmp_ge_u32 s10, 4
    s_cbranch_scc1 L_adaLN_cond__spectral_gfnet__glu_gated_bilinear__prompt_kernel_nobg3_92
    v_lshlrev_b32 v92, 4, v1
    v_and_b32 v92, 0x300, v92
    v_lshl_add_u32 v92, v1, 4, v92
    s_mov_b32 s28, 16384
    buffer_load_dwordx4 v[192:195], v92, s[40:43], s28 offen offset:0 sc1
    s_mov_b32 s28, 16384
    buffer_load_dwordx4 v[196:199], v92, s[40:43], s28 offen offset:256 sc1
    s_mov_b32 s28, 16384
    buffer_load_dwordx4 v[200:203], v92, s[40:43], s28 offen offset:2048 sc1
    s_mov_b32 s28, 16384
    buffer_load_dwordx4 v[204:207], v92, s[40:43], s28 offen offset:2304 sc1
    s_mov_b32 s28, 20480
    buffer_load_dwordx4 v[208:211], v92, s[40:43], s28 offen offset:0 sc1
    s_mov_b32 s28, 20480
    buffer_load_dwordx4 v[212:215], v92, s[40:43], s28 offen offset:256 sc1
    s_mov_b32 s28, 20480
    buffer_load_dwordx4 v[216:219], v92, s[40:43], s28 offen offset:2048 sc1
    s_mov_b32 s28, 20480
    buffer_load_dwordx4 v[220:223], v92, s[40:43], s28 offen offset:2304 sc1
L_adaLN_cond__spectral_gfnet__glu_gated_bilinear__prompt_kernel_nobg3_92:
    v_pk_mul_f32 v[112:113], v[96:97], v[76:77]
    v_pk_mul_f32 v[120:121], v[104:105], v[76:77]
    v_pk_mul_f32 v[114:115], v[98:99], v[78:79]
    v_pk_mul_f32 v[122:123], v[106:107], v[78:79]
    v_pk_mul_f32 v[116:117], v[100:101], v[80:81]
    v_pk_mul_f32 v[124:125], v[108:109], v[80:81]
    v_pk_mul_f32 v[118:119], v[102:103], v[82:83]
    v_pk_mul_f32 v[126:127], v[110:111], v[82:83]
    v_pk_fma_f32 v[112:113], v[104:105], v[84:85], v[112:113]
    v_pk_fma_f32 v[120:121], v[96:97], v[84:85], v[120:121] neg_lo:[1,0,0] neg_hi:[1,0,0]
    v_pk_fma_f32 v[114:115], v[106:107], v[86:87], v[114:115]
    v_pk_fma_f32 v[122:123], v[98:99], v[86:87], v[122:123] neg_lo:[1,0,0] neg_hi:[1,0,0]
    v_pk_fma_f32 v[116:117], v[108:109], v[88:89], v[116:117]
    v_pk_fma_f32 v[124:125], v[100:101], v[88:89], v[124:125] neg_lo:[1,0,0] neg_hi:[1,0,0]
    v_pk_fma_f32 v[118:119], v[110:111], v[90:91], v[118:119]
    v_pk_fma_f32 v[126:127], v[102:103], v[90:91], v[126:127] neg_lo:[1,0,0] neg_hi:[1,0,0]
    v_cvt_pk_bf16_f32 v96, v112, v120
    v_cvt_pk_bf16_f32 v97, v113, v121
    v_cvt_pk_bf16_f32 v98, v114, v122
    v_cvt_pk_bf16_f32 v99, v115, v123
    v_cvt_pk_bf16_f32 v100, v116, v124
    v_cvt_pk_bf16_f32 v101, v117, v125
    v_cvt_pk_bf16_f32 v102, v118, v126
    v_cvt_pk_bf16_f32 v103, v119, v127
    ds_write_b128 v15, v[96:99] offset:0
    ds_write_b128 v15, v[100:103] offset:64
    v_lshlrev_b32 v20, 16, v20
    v_mov_b32 v112, v20
    v_sub_f32 v113, 0, v20
    v_mov_b32 v114, v20
    v_sub_f32 v115, 0, v20
    v_mov_b32 v116, v20
    v_sub_f32 v117, 0, v20
    v_mov_b32 v118, v20
    v_sub_f32 v119, 0, v20
    s_waitcnt lgkmcnt(0)
    s_barrier
    ds_read_b32 v104, v21 offset:0
    ds_read_b32 v105, v21 offset:144
    ds_read_b32 v106, v21 offset:288
    ds_read_b32 v107, v21 offset:432
    ds_read_b32 v108, v21 offset:64
    ds_read_b32 v109, v21 offset:208
    ds_read_b32 v110, v21 offset:352
    ds_read_b32 v111, v21 offset:496
    s_cmp_lt_u32 s2, 32
    s_cbranch_scc1 L_adaLN_cond__spectral_gfnet__glu_gated_bilinear__prompt_kernel_nobg3_93
    s_cmp_ge_u32 s10, 4
    s_cbranch_scc1 L_adaLN_cond__spectral_gfnet__glu_gated_bilinear__prompt_kernel_nobg3_93
    v_lshlrev_b32 v92, 4, v1
    v_and_b32 v92, 0x300, v92
    v_lshl_add_u32 v92, v1, 4, v92
    s_mov_b32 s28, 24576
    buffer_load_dwordx4 v[224:227], v92, s[40:43], s28 offen offset:0 sc1
    s_mov_b32 s28, 24576
    buffer_load_dwordx4 v[228:231], v92, s[40:43], s28 offen offset:256 sc1
    s_mov_b32 s28, 24576
    buffer_load_dwordx4 v[232:235], v92, s[40:43], s28 offen offset:2048 sc1
    s_mov_b32 s28, 24576
    buffer_load_dwordx4 v[236:239], v92, s[40:43], s28 offen offset:2304 sc1
    s_mov_b32 s28, 28672
    buffer_load_dwordx4 v[240:243], v92, s[40:43], s28 offen offset:0 sc1
    s_mov_b32 s28, 28672
    buffer_load_dwordx4 v[244:247], v92, s[40:43], s28 offen offset:256 sc1
    s_mov_b32 s28, 28672
    buffer_load_dwordx4 v[248:251], v92, s[40:43], s28 offen offset:2048 sc1
    s_mov_b32 s28, 28672
    buffer_load_dwordx4 v[252:255], v92, s[40:43], s28 offen offset:2304 sc1
L_adaLN_cond__spectral_gfnet__glu_gated_bilinear__prompt_kernel_nobg3_93:
    v_lshlrev_b32 v96, 16, v22
    v_and_b32 v97, 0xffff0000, v22
    v_lshlrev_b32 v98, 16, v23
    v_and_b32 v99, 0xffff0000, v23
    v_lshlrev_b32 v100, 16, v24
    v_and_b32 v101, 0xffff0000, v24
    v_lshlrev_b32 v102, 16, v25
    v_and_b32 v103, 0xffff0000, v25
    s_waitcnt lgkmcnt(0)
    v_mfma_f32_16x16x32_bf16 v[112:115], v[104:107], v[72:75], v[112:115]
    v_mfma_f32_16x16x32_bf16 v[116:119], v[108:111], v[72:75], v[116:119]
    s_nop 6
    v_pk_fma_f32 v[96:97], v[112:113], v[28:29], v[96:97]
    v_pk_fma_f32 v[98:99], v[114:115], v[30:31], v[98:99]
    v_pk_fma_f32 v[100:101], v[116:117], v[32:33], v[100:101]
    v_pk_fma_f32 v[102:103], v[118:119], v[34:35], v[102:103]
    v_cvt_pk_bf16_f32 v22, v96, v97
    v_cvt_pk_bf16_f32 v23, v98, v99
    v_cvt_pk_bf16_f32 v24, v100, v101
    v_cvt_pk_bf16_f32 v25, v102, v103
    ds_write_b64 v26, v[22:23]
    ds_write_b64 v26, v[24:25] offset:32
    v_lshlrev_b32 v96, 16, v22
    v_and_b32 v97, 0xffff0000, v22
    v_lshlrev_b32 v98, 16, v23
    v_and_b32 v99, 0xffff0000, v23
    v_lshlrev_b32 v100, 16, v24
    v_and_b32 v101, 0xffff0000, v24
    v_lshlrev_b32 v102, 16, v25
    v_and_b32 v103, 0xffff0000, v25
    v_readfirstlane_b32 s30, v96
    s_waitcnt lgkmcnt(0)
    ds_read_b128 v[16:19], v27
    v_pk_add_f32 v[96:97], v[96:97], s[30:31] op_sel_hi:[1,0] neg_lo:[0,1] neg_hi:[0,1]
    v_pk_add_f32 v[98:99], v[98:99], s[30:31] op_sel_hi:[1,0] neg_lo:[0,1] neg_hi:[0,1]
    v_pk_add_f32 v[100:101], v[100:101], s[30:31] op_sel_hi:[1,0] neg_lo:[0,1] neg_hi:[0,1]
    v_pk_add_f32 v[102:103], v[102:103], s[30:31] op_sel_hi:[1,0] neg_lo:[0,1] neg_hi:[0,1]
    v_pk_add_f32 v[120:121], v[96:97], v[98:99]
    v_pk_mul_f32 v[122:123], v[96:97], v[96:97]
    v_pk_add_f32 v[124:125], v[100:101], v[102:103]
    v_pk_fma_f32 v[122:123], v[98:99], v[98:99], v[122:123]
    v_pk_add_f32 v[120:121], v[120:121], v[124:125]
    v_pk_fma_f32 v[122:123], v[100:101], v[100:101], v[122:123]
    v_add_f32 v120, v120, v121
    v_pk_fma_f32 v[122:123], v[102:103], v[102:103], v[122:123]
    v_add_f32 v122, v122, v123
    s_waitcnt lgkmcnt(0)
    global_store_dwordx4 v52, v[16:19], s[6:7] sc1
    v_add_f32_dpp v120, v120, v120 row_shr:1 row_mask:0xf bank_mask:0xf bound_ctrl:0
    v_add_f32_dpp v122, v122, v122 row_shr:1 row_mask:0xf bank_mask:0xf bound_ctrl:0
    s_nop 0
    v_add_f32_dpp v120, v120, v120 row_shr:2 row_mask:0xf bank_mask:0xf bound_ctrl:0
    v_add_f32_dpp v122, v122, v122 row_shr:2 row_mask:0xf bank_mask:0xf bound_ctrl:0
    s_nop 0
    v_add_f32_dpp v120, v120, v120 row_shr:4 row_mask:0xf bank_mask:0xf bound_ctrl:0
    v_add_f32_dpp v122, v122, v122 row_shr:4 row_mask:0xf bank_mask:0xf bound_ctrl:0
    s_nop 0
    v_add_f32_dpp v120, v120, v120 row_shr:8 row_mask:0xf bank_mask:0xf bound_ctrl:0
    v_add_f32_dpp v122, v122, v122 row_shr:8 row_mask:0xf bank_mask:0xf bound_ctrl:0
    s_nop 0
    v_add_f32_dpp v120, v120, v120 row_bcast:15 row_mask:0xa bank_mask:0xf
    v_add_f32_dpp v122, v122, v122 row_bcast:15 row_mask:0xa bank_mask:0xf
    s_nop 0
    v_add_f32_dpp v120, v120, v120 row_bcast:31 row_mask:0xc bank_mask:0xf
    v_add_f32_dpp v122, v122, v122 row_bcast:31 row_mask:0xc bank_mask:0xf
    v_mul_f32 v120, 0x3b000000, v120
    v_mul_f32 v122, 0x3b000000, v122
    v_fma_f32 v122, -v120, v120, v122
    v_add_f32 v122, 0x3727c5ac, v122
    v_rsq_f32 v122, v122
    v_readlane_b32 s30, v120, 63
    v_readlane_b32 s32, v122, 63
    s_nop 0
    v_pk_add_f32 v[96:97], v[96:97], s[30:31] op_sel_hi:[1,0] neg_lo:[0,1] neg_hi:[0,1]
    v_pk_add_f32 v[98:99], v[98:99], s[30:31] op_sel_hi:[1,0] neg_lo:[0,1] neg_hi:[0,1]
    v_pk_add_f32 v[100:101], v[100:101], s[30:31] op_sel_hi:[1,0] neg_lo:[0,1] neg_hi:[0,1]
    v_pk_add_f32 v[102:103], v[102:103], s[30:31] op_sel_hi:[1,0] neg_lo:[0,1] neg_hi:[0,1]
    v_pk_mul_f32 v[96:97], v[96:97], s[32:33] op_sel_hi:[1,0]
    v_pk_mul_f32 v[98:99], v[98:99], s[32:33] op_sel_hi:[1,0]
    v_pk_mul_f32 v[100:101], v[100:101], s[32:33] op_sel_hi:[1,0]
    v_pk_mul_f32 v[102:103], v[102:103], s[32:33] op_sel_hi:[1,0]
    v_pk_fma_f32 v[96:97], v[96:97], v[44:45], v[36:37]
    v_pk_fma_f32 v[98:99], v[98:99], v[46:47], v[38:39]
    v_pk_fma_f32 v[100:101], v[100:101], v[48:49], v[40:41]
    v_pk_fma_f32 v[102:103], v[102:103], v[50:51], v[42:43]
    v_cvt_pk_bf16_f32 v16, v96, v97
    v_cvt_pk_bf16_f32 v17, v98, v99
    v_cvt_pk_bf16_f32 v18, v100, v101
    v_cvt_pk_bf16_f32 v19, v102, v103
    ds_write_b128 v54, v[16:19]
    s_waitcnt lgkmcnt(0)
    s_barrier
    ds_read_b128 v[16:19], v55
    s_waitcnt lgkmcnt(0)
    global_store_dwordx4 v53, v[16:19], s[6:7] sc1
    s_cmp_lt_u32 s2, 32
    s_cbranch_scc1 L_adaLN_cond__spectral_gfnet__glu_gated_bilinear__prompt_kernel_rm5_94
    v_lshlrev_b32 v3, 4, v1
    s_lshl_b32 s26, s36, 17
    s_add_u32 s26, s26, 12582912
    s_add_u32 s16, s6, s26
    s_addc_u32 s17, s7, 0
    s_mov_b32 s18, 131072
    s_mov_b32 s19, 0x20000
    s_lshr_b32 s20, s10, 1
    s_lshl_b32 s20, s20, 15
    s_and_b32 s21, s10, 1
    s_lshl_b32 s21, s21, 12
    s_add_u32 s20, s20, s21
    s_add_u32 s21, s20, 0
    s_mul_i32 s25, s39, 112
    s_mul_i32 s26, s10, 14
    s_add_u32 s25, s25, s26
    s_lshl_b32 s25, s25, 11
    s_add_u32 s25, s25, 20971520
    s_add_u32 s12, s6, s25
    s_addc_u32 s13, s7, 0
    s_mov_b32 s14, 28672
    s_mov_b32 s15, 0x20000
    v_add_u32 v6, s20, v3
    v_add_u32 v7, 0, v6
    v_lshlrev_b32 v4, 4, v1
    v_and_b32 v4, 0x300, v4
    v_lshl_add_u32 v4, v1, 4, v4
    v_add_u32 v5, 65536, v4
    v_add_u32 v4, 0, v4
    s_waitcnt vmcnt(0)
    s_mov_b32 s97, 0
L_adaLN_cond__spectral_gfnet__glu_gated_bilinear__prompt_kernel_h2p_96:
    s_setprio 1
    s_add_u32 m0, s21, 0
    s_mov_b32 s27, 0
    buffer_load_dwordx4 v6, s[16:19], s27 offen offset:0 sc1 lds
    buffer_load_dwordx4 v6, s[16:19], s27 offen offset:1024 sc1 lds
    buffer_load_dwordx4 v6, s[16:19], s27 offen offset:2048 sc1 lds
    buffer_load_dwordx4 v6, s[16:19], s27 offen offset:3072 sc1 lds
    s_setprio 0
    s_waitcnt vmcnt(0)
    ds_read_b128 v[8:11], v7 offset:0
    ds_read_b128 v[12:15], v7 offset:1024
    ds_read_b128 v[16:19], v7 offset:2048
    ds_read_b128 v[20:23], v7 offset:3072
    s_waitcnt lgkmcnt(0)
    v_max3_u32 v24, v8, v9, v10
    v_max3_u32 v25, v11, v12, v13
    v_max3_u32 v26, v14, v15, v16
    v_max3_u32 v27, v17, v18, v19
    v_max3_u32 v24, v24, v20, v21
    v_max3_u32 v25, v25, v22, v23
    v_max3_u32 v24, v24, v25, v26
    v_max_u32 v24, v24, v27
    v_cmp_eq_u32 vcc, -1, v24
    s_cbranch_vccz L_adaLN_cond__spectral_gfnet__glu_gated_bilinear__prompt_kernel_h2p_96_x
    s_add_u32 s97, s97, 1
    s_cmp_lt_u32 s97, s96
    s_cbranch_scc1 L_adaLN_cond__spectral_gfnet__glu_gated_bilinear__prompt_kernel_h2p_96
    s_mov_b32 s96, 0
L_adaLN_cond__spectral_gfnet__glu_gated_bilinear__prompt_kernel_h2p_96_x:
    s_add_u32 m0, s21, 8192
    s_mov_b32 s27, 8192
    buffer_load_dwordx4 v6, s[16:19], s27 offen offset:0 sc1 lds
    buffer_load_dwordx4 v6, s[16:19], s27 offen offset:1024 sc1 lds
    buffer_load_dwordx4 v6, s[16:19], s27 offen offset:2048 sc1 lds
    buffer_load_dwordx4 v6, s[16:19], s27 offen offset:3072 sc1 lds
    s_barrier
    s_lshl_b32 s25, s2, 7
    s_add_u32 s29, s25, 262144
    s_cmp_lg_u32 s10, 0
    s_cbranch_scc1 L_adaLN_cond__spectral_gfnet__glu_gated_bilinear__prompt_kernel_fs_97
    v_mov_b32 v24, s29
    v_mov_b32 v25, s3
    s_mov_b64 exec, 1
    global_store_dword v24, v25, s[6:7] sc1
    s_mov_b64 exec, -1
L_adaLN_cond__spectral_gfnet__glu_gated_bilinear__prompt_kernel_fs_97:
    v_lshrrev_b32 v25, 1, v3
    v_xor_b32 v25, v25, v3
    v_and_b32 v25, 0x100, v25
    v_mul_u32_u24 v25, 3, v25
    v_xor_b32 v24, v3, v25
    s_lshl_b32 s25, s36, 2
    s_mul_i32 s25, s25, 112
    s_lshl_b32 s26, s37, 3
    s_add_u32 s25, s25, s26
    s_add_u32 s25, s25, s10
    s_lshl_b32 s25, s25, 10
    s_add_u32 s25, s25, 25165824
    v_add_u32 v2, s25, v24
    ds_read_b128 v[96:99], v4 offset:0
    ds_read_b128 v[100:103], v4 offset:256
    ds_read_b128 v[104:107], v4 offset:32768
    ds_read_b128 v[108:111], v4 offset:33024
    ds_read_b128 v[112:115], v5 offset:0
    ds_read_b128 v[116:119], v5 offset:256
    ds_read_b128 v[120:123], v5 offset:32768
    s_waitcnt lgkmcnt(6)
    v_mfma_f32_16x16x32_bf16 v[32:35], v[128:131], v[96:99], 0
    v_mfma_f32_16x16x32_bf16 v[36:39], v[132:135], v[96:99], 0
    ds_read_b128 v[124:127], v5 offset:33024
    s_waitcnt lgkmcnt(6)
    v_mfma_f32_16x16x32_bf16 v[40:43], v[128:131], v[100:103], 0
    v_mfma_f32_16x16x32_bf16 v[44:47], v[132:135], v[100:103], 0
    ds_read_b128 v[96:99], v4 offset:2048
    s_waitcnt lgkmcnt(6)
    v_mfma_f32_16x16x32_bf16 v[48:51], v[128:131], v[104:107], 0
    v_mfma_f32_16x16x32_bf16 v[52:55], v[132:135], v[104:107], 0
    ds_read_b128 v[100:103], v4 offset:2304
    s_waitcnt lgkmcnt(6)
    v_mfma_f32_16x16x32_bf16 v[56:59], v[128:131], v[108:111], 0
    v_mfma_f32_16x16x32_bf16 v[60:63], v[132:135], v[108:111], 0
    ds_read_b128 v[104:107], v4 offset:34816
    s_waitcnt lgkmcnt(6)
    v_mfma_f32_16x16x32_bf16 v[64:67], v[128:131], v[112:115], 0
    v_mfma_f32_16x16x32_bf16 v[68:71], v[132:135], v[112:115], 0
    ds_read_b128 v[108:111], v4 offset:35072
    s_waitcnt lgkmcnt(6)
    v_mfma_f32_16x16x32_bf16 v[72:75], v[128:131], v[116:119], 0
    s_add_u32 m0, s21, 16384
    s_mov_b32 s27, 16384
    buffer_load_dwordx4 v6, s[16:19], s27 offen offset:0 sc1 lds
    v_mfma_f32_16x16x32_bf16 v[76:79], v[132:135], v[116:119], 0
    ds_read_b128 v[112:115], v5 offset:2048
    s_waitcnt lgkmcnt(6)
    v_mfma_f32_16x16x32_bf16 v[80:83], v[128:131], v[120:123], 0
    v_mfma_f32_16x16x32_bf16 v[84:87], v[132:135], v[120:123], 0
    ds_read_b128 v[116:119], v5 offset:2304
    s_waitcnt lgkmcnt(6)
    v_mfma_f32_16x16x32_bf16 v[88:91], v[128:131], v[124:127], 0
    v_mfma_f32_16x16x32_bf16 v[92:95], v[132:135], v[124:127], 0
    ds_read_b128 v[120:123], v5 offset:34816
    s_waitcnt lgkmcnt(6)
    v_mfma_f32_16x16x32_bf16 v[32:35], v[136:139], v[96:99], v[32:35]
    v_mfma_f32_16x16x32_bf16 v[36:39], v[140:143], v[96:99], v[36:39]
    ds_read_b128 v[124:127], v5 offset:35072
    s_waitcnt lgkmcnt(6)
    v_mfma_f32_16x16x32_bf16 v[40:43], v[136:139], v[100:103], v[40:43]
    s_add_u32 m0, s21, 16384
    s_mov_b32 s27, 16384
    buffer_load_dwordx4 v6, s[16:19], s27 offen offset:1024 sc1 lds
    v_mfma_f32_16x16x32_bf16 v[44:47], v[140:143], v[100:103], v[44:47]
    ds_read_b128 v[96:99], v4 offset:4096
    s_waitcnt lgkmcnt(6)
    v_mfma_f32_16x16x32_bf16 v[48:51], v[136:139], v[104:107], v[48:51]
    v_mfma_f32_16x16x32_bf16 v[52:55], v[140:143], v[104:107], v[52:55]
    ds_read_b128 v[100:103], v4 offset:4352
    s_waitcnt lgkmcnt(6)
    v_mfma_f32_16x16x32_bf16 v[56:59], v[136:139], v[108:111], v[56:59]
    s_mov_b32 s28, 0
    buffer_load_dwordx4 v[128:131], v3, s[12:15], s28 offen offset:0 sc1
    v_mfma_f32_16x16x32_bf16 v[60:63], v[140:143], v[108:111], v[60:63]
    ds_read_b128 v[104:107], v4 offset:36864
    s_waitcnt lgkmcnt(6)
    v_mfma_f32_16x16x32_bf16 v[64:67], v[136:139], v[112:115], v[64:67]
    v_mfma_f32_16x16x32_bf16 v[68:71], v[140:143], v[112:115], v[68:71]
    ds_read_b128 v[108:111], v4 offset:37120
    s_waitcnt lgkmcnt(6)
    v_mfma_f32_16x16x32_bf16 v[72:75], v[136:139], v[116:119], v[72:75]
    s_add_u32 m0, s21, 16384
    s_mov_b32 s27, 16384
    buffer_load_dwordx4 v6, s[16:19], s27 offen offset:2048 sc1 lds
    v_mfma_f32_16x16x32_bf16 v[76:79], v[140:143], v[116:119], v[76:79]
    ds_read_b128 v[112:115], v5 offset:4096
    s_waitcnt lgkmcnt(6)
    v_mfma_f32_16x16x32_bf16 v[80:83], v[136:139], v[120:123], v[80:83]
    v_mfma_f32_16x16x32_bf16 v[84:87], v[140:143], v[120:123], v[84:87]
    ds_read_b128 v[116:119], v5 offset:4352
    s_waitcnt lgkmcnt(6)
    v_mfma_f32_16x16x32_bf16 v[88:91], v[136:139], v[124:127], v[88:91]
    s_mov_b32 s28, 0
    buffer_load_dwordx4 v[132:135], v3, s[12:15], s28 offen offset:1024 sc1
    v_mfma_f32_16x16x32_bf16 v[92:95], v[140:143], v[124:127], v[92:95]
    ds_read_b128 v[120:123], v5 offset:36864
    s_waitcnt lgkmcnt(6)
    v_mfma_f32_16x16x32_bf16 v[32:35], v[144:147], v[96:99], v[32:35]
    v_mfma_f32_16x16x32_bf16 v[36:39], v[148:151], v[96:99], v[36:39]
    ds_read_b128 v[124:127], v5 offset:37120
    s_waitcnt lgkmcnt(6)
    v_mfma_f32_16x16x32_bf16 v[40:43], v[144:147], v[100:103], v[40:43]
    s_add_u32 m0, s21, 16384
    s_mov_b32 s27, 16384
    buffer_load_dwordx4 v6, s[16:19], s27 offen offset:3072 sc1 lds
    v_mfma_f32_16x16x32_bf16 v[44:47], v[148:151], v[100:103], v[44:47]
    ds_read_b128 v[96:99], v4 offset:6144
    s_waitcnt lgkmcnt(6)
    v_mfma_f32_16x16x32_bf16 v[48:51], v[144:147], v[104:107], v[48:51]
    v_mfma_f32_16x16x32_bf16 v[52:55], v[148:151], v[104:107], v[52:55]
    s_waitcnt vmcnt(6)
    ds_read_b128 v[8:11], v7 offset:8192
    ds_read_b128 v[12:15], v7 offset:9216
    ds_read_b128 v[16:19], v7 offset:10240
    ds_read_b128 v[20:23], v7 offset:11264
    ds_read_b128 v[100:103], v4 offset:6400
    s_waitcnt lgkmcnt(6)
    v_mfma_f32_16x16x32_bf16 v[56:59], v[144:147], v[108:111], v[56:59]
    s_mov_b32 s28, 0
    buffer_load_dwordx4 v[136:139], v3, s[12:15], s28 offen offset:2048 sc1
    v_mfma_f32_16x16x32_bf16 v[60:63], v[148:151], v[108:111], v[60:63]
    ds_read_b128 v[104:107], v4 offset:38912
    s_waitcnt lgkmcnt(6)
    v_mfma_f32_16x16x32_bf16 v[64:67], v[144:147], v[112:115], v[64:67]
    v_mfma_f32_16x16x32_bf16 v[68:71], v[148:151], v[112:115], v[68:71]
    ds_read_b128 v[108:111], v4 offset:39168
    s_waitcnt lgkmcnt(6)
    v_mfma_f32_16x16x32_bf16 v[72:75], v[144:147], v[116:119], v[72:75]
    v_mfma_f32_16x16x32_bf16 v[76:79], v[148:151], v[116:119], v[76:79]
    ds_read_b128 v[112:115], v5 offset:6144
    s_waitcnt lgkmcnt(6)
    v_mfma_f32_16x16x32_bf16 v[80:83], v[144:147], v[120:123], v[80:83]
    v_mfma_f32_16x16x32_bf16 v[84:87], v[148:151], v[120:123], v[84:87]
    ds_read_b128 v[116:119], v5 offset:6400
    s_waitcnt lgkmcnt(6)
    v_mfma_f32_16x16x32_bf16 v[88:91], v[144:147], v[124:127], v[88:91]
    s_mov_b32 s28, 0
    buffer_load_dwordx4 v[140:143], v3, s[12:15], s28 offen offset:3072 sc1
    v_mfma_f32_16x16x32_bf16 v[92:95], v[148:151], v[124:127], v[92:95]
    ds_read_b128 v[120:123], v5 offset:38912
    s_waitcnt lgkmcnt(6)
    v_mfma_f32_16x16x32_bf16 v[32:35], v[152:155], v[96:99], v[32:35]
    v_mfma_f32_16x16x32_bf16 v[36:39], v[156:159], v[96:99], v[36:39]
    v_max3_u32 v24, v8, v9, v10
    v_max3_u32 v25, v11, v12, v13
    v_max3_u32 v26, v14, v15, v16
    v_max3_u32 v27, v17, v18, v19
    v_max3_u32 v24, v24, v20, v21
    v_max3_u32 v25, v25, v22, v23
    v_max3_u32 v24, v24, v25, v26
    v_max_u32 v24, v24, v27
    v_cmp_eq_u32 vcc, -1, v24
    s_cbranch_vccnz L_adaLN_cond__spectral_gfnet__glu_gated_bilinear__prompt_kernel_h2w_98
L_adaLN_cond__spectral_gfnet__glu_gated_bilinear__prompt_kernel_ok_99:
    ds_read_b128 v[124:127], v5 offset:39168
    s_waitcnt lgkmcnt(6)
    v_mfma_f32_16x16x32_bf16 v[40:43], v[152:155], v[100:103], v[40:43]
    v_mfma_f32_16x16x32_bf16 v[44:47], v[156:159], v[100:103], v[44:47]
    s_barrier
    ds_read_b128 v[96:99], v4 offset:8192
    s_waitcnt lgkmcnt(6)
    v_mfma_f32_16x16x32_bf16 v[48:51], v[152:155], v[104:107], v[48:51]
    v_mfma_f32_16x16x32_bf16 v[52:55], v[156:159], v[104:107], v[52:55]
    ds_read_b128 v[100:103], v4 offset:8448
    s_waitcnt lgkmcnt(6)
    v_mfma_f32_16x16x32_bf16 v[56:59], v[152:155], v[108:111], v[56:59]
    s_mov_b32 s28, 4096
    buffer_load_dwordx4 v[144:147], v3, s[12:15], s28 offen offset:0 sc1
    v_mfma_f32_16x16x32_bf16 v[60:63], v[156:159], v[108:111], v[60:63]
    ds_read_b128 v[104:107], v4 offset:40960
    s_waitcnt lgkmcnt(6)
    v_mfma_f32_16x16x32_bf16 v[64:67], v[152:155], v[112:115], v[64:67]
    v_mfma_f32_16x16x32_bf16 v[68:71], v[156:159], v[112:115], v[68:71]
    ds_read_b128 v[108:111], v4 offset:41216
    s_waitcnt lgkmcnt(6)
    v_mfma_f32_16x16x32_bf16 v[72:75], v[152:155], v[116:119], v[72:75]
    v_mfma_f32_16x16x32_bf16 v[76:79], v[156:159], v[116:119], v[76:79]
    ds_read_b128 v[112:115], v5 offset:8192
    s_waitcnt lgkmcnt(6)
    v_mfma_f32_16x16x32_bf16 v[80:83], v[152:155], v[120:123], v[80:83]
    v_mfma_f32_16x16x32_bf16 v[84:87], v[156:159], v[120:123], v[84:87]
    ds_read_b128 v[116:119], v5 offset:8448
    s_waitcnt lgkmcnt(6)
    v_mfma_f32_16x16x32_bf16 v[88:91], v[152:155], v[124:127], v[88:91]
    s_mov_b32 s28, 4096
    buffer_load_dwordx4 v[148:151], v3, s[12:15], s28 offen offset:1024 sc1
    v_mfma_f32_16x16x32_bf16 v[92:95], v[156:159], v[124:127], v[92:95]
    ds_read_b128 v[120:123], v5 offset:40960
    s_waitcnt lgkmcnt(6)
    v_mfma_f32_16x16x32_bf16 v[32:35], v[160:163], v[96:99], v[32:35]
    v_mfma_f32_16x16x32_bf16 v[36:39], v[164:167], v[96:99], v[36:39]
    ds_read_b128 v[124:127], v5 offset:41216
    s_waitcnt lgkmcnt(6)
    v_mfma_f32_16x16x32_bf16 v[40:43], v[160:163], v[100:103], v[40:43]
    v_mfma_f32_16x16x32_bf16 v[44:47], v[164:167], v[100:103], v[44:47]
    ds_read_b128 v[96:99], v4 offset:10240
    s_waitcnt lgkmcnt(6)
    v_mfma_f32_16x16x32_bf16 v[48:51], v[160:163], v[104:107], v[48:51]
    v_mfma_f32_16x16x32_bf16 v[52:55], v[164:167], v[104:107], v[52:55]
    ds_read_b128 v[100:103], v4 offset:10496
    s_waitcnt lgkmcnt(6)
    v_mfma_f32_16x16x32_bf16 v[56:59], v[160:163], v[108:111], v[56:59]
    s_mov_b32 s28, 4096
    buffer_load_dwordx4 v[152:155], v3, s[12:15], s28 offen offset:2048 sc1
    v_mfma_f32_16x16x32_bf16 v[60:63], v[164:167], v[108:111], v[60:63]
    ds_read_b128 v[104:107], v4 offset:43008
    s_waitcnt lgkmcnt(6)
    v_mfma_f32_16x16x32_bf16 v[64:67], v[160:163], v[112:115], v[64:67]
    v_mfma_f32_16x16x32_bf16 v[68:71], v[164:167], v[112:115], v[68:71]
    ds_read_b128 v[108:111], v4 offset:43264
    s_waitcnt lgkmcnt(6)
    v_mfma_f32_16x16x32_bf16 v[72:75], v[160:163], v[116:119], v[72:75]
    s_add_u32 m0, s21, 24576
    s_mov_b32 s27, 24576
    buffer_load_dwordx4 v6, s[16:19], s27 offen offset:0 sc1 lds
    v_mfma_f32_16x16x32_bf16 v[76:79], v[164:167], v[116:119], v[76:79]
    ds_read_b128 v[112:115], v5 offset:10240
    s_waitcnt lgkmcnt(6)
    v_mfma_f32_16x16x32_bf16 v[80:83], v[160:163], v[120:123], v[80:83]
    v_mfma_f32_16x16x32_bf16 v[84:87], v[164:167], v[120:123], v[84:87]
    ds_read_b128 v[116:119], v5 offset:10496
    s_waitcnt lgkmcnt(6)
    v_mfma_f32_16x16x32_bf16 v[88:91], v[160:163], v[124:127], v[88:91]
    s_mov_b32 s28, 4096
    buffer_load_dwordx4 v[156:159], v3, s[12:15], s28 offen offset:3072 sc1
    v_mfma_f32_16x16x32_bf16 v[92:95], v[164:167], v[124:127], v[92:95]
    ds_read_b128 v[120:123], v5 offset:43008
    s_waitcnt lgkmcnt(6)
    v_mfma_f32_16x16x32_bf16 v[32:35], v[168:171], v[96:99], v[32:35]
    v_mfma_f32_16x16x32_bf16 v[36:39], v[172:175], v[96:99], v[36:39]
    ds_read_b128 v[124:127], v5 offset:43264
    s_waitcnt lgkmcnt(6)
    v_mfma_f32_16x16x32_bf16 v[40:43], v[168:171], v[100:103], v[40:43]
    s_add_u32 m0, s21, 24576
    s_mov_b32 s27, 24576
    buffer_load_dwordx4 v6, s[16:19], s27 offen offset:1024 sc1 lds
    v_mfma_f32_16x16x32_bf16 v[44:47], v[172:175], v[100:103], v[44:47]
    ds_read_b128 v[96:99], v4 offset:12288
    s_waitcnt lgkmcnt(6)
    v_mfma_f32_16x16x32_bf16 v[48:51], v[168:171], v[104:107], v[48:51]
    v_mfma_f32_16x16x32_bf16 v[52:55], v[172:175], v[104:107], v[52:55]
    ds_read_b128 v[100:103], v4 offset:12544
    s_waitcnt lgkmcnt(6)
    v_mfma_f32_16x16x32_bf16 v[56:59], v[168:171], v[108:111], v[56:59]
    s_mov_b32 s28, 8192
    buffer_load_dwordx4 v[160:163], v3, s[12:15], s28 offen offset:0 sc1
    v_mfma_f32_16x16x32_bf16 v[60:63], v[172:175], v[108:111], v[60:63]
    ds_read_b128 v[104:107], v4 offset:45056
    s_waitcnt lgkmcnt(6)
    v_mfma_f32_16x16x32_bf16 v[64:67], v[168:171], v[112:115], v[64:67]
    v_mfma_f32_16x16x32_bf16 v[68:71], v[172:175], v[112:115], v[68:71]
    ds_read_b128 v[108:111], v4 offset:45312
    s_waitcnt lgkmcnt(6)
    v_mfma_f32_16x16x32_bf16 v[72:75], v[168:171], v[116:119], v[72:75]
    s_add_u32 m0, s21, 24576
    s_mov_b32 s27, 24576
    buffer_load_dwordx4 v6, s[16:19], s27 offen offset:2048 sc1 lds
    v_mfma_f32_16x16x32_bf16 v[76:79], v[172:175], v[116:119], v[76:79]
    ds_read_b128 v[112:115], v5 offset:12288
    s_waitcnt lgkmcnt(6)
    v_mfma_f32_16x16x32_bf16 v[80:83], v[168:171], v[120:123], v[80:83]
    v_mfma_f32_16x16x32_bf16 v[84:87], v[172:175], v[120:123], v[84:87]
    ds_read_b128 v[116:119], v5 offset:12544
    s_waitcnt lgkmcnt(6)
    v_mfma_f32_16x16x32_bf16 v[88:91], v[168:171], v[124:127], v[88:91]
    s_mov_b32 s28, 8192
    buffer_load_dwordx4 v[164:167], v3, s[12:15], s28 offen offset:1024 sc1
    v_mfma_f32_16x16x32_bf16 v[92:95], v[172:175], v[124:127], v[92:95]
    ds_read_b128 v[120:123], v5 offset:45056
    s_waitcnt lgkmcnt(6)
    v_mfma_f32_16x16x32_bf16 v[32:35], v[176:179], v[96:99], v[32:35]
    v_mfma_f32_16x16x32_bf16 v[36:39], v[180:183], v[96:99], v[36:39]
    ds_read_b128 v[124:127], v5 offset:45312
    s_waitcnt lgkmcnt(6)
    v_mfma_f32_16x16x32_bf16 v[40:43], v[176:179], v[100:103], v[40:43]
    s_add_u32 m0, s21, 24576
    s_mov_b32 s27, 24576
    buffer_load_dwordx4 v6, s[16:19], s27 offen offset:3072 sc1 lds
    v_mfma_f32_16x16x32_bf16 v[44:47], v[180:183], v[100:103], v[44:47]
    ds_read_b128 v[96:99], v4 offset:14336
    s_waitcnt lgkmcnt(6)
    v_mfma_f32_16x16x32_bf16 v[48:51], v[176:179], v[104:107], v[48:51]
    v_mfma_f32_16x16x32_bf16 v[52:55], v[180:183], v[104:107], v[52:55]
    s_waitcnt vmcnt(12)
    ds_read_b128 v[8:11], v7 offset:16384
    ds_read_b128 v[12:15], v7 offset:17408
    ds_read_b128 v[16:19], v7 offset:18432
    ds_read_b128 v[20:23], v7 offset:19456
    ds_read_b128 v[100:103], v4 offset:14592
    s_waitcnt lgkmcnt(6)
    v_mfma_f32_16x16x32_bf16 v[56:59], v[176:179], v[108:111], v[56:59]
    s_mov_b32 s28, 8192
    buffer_load_dwordx4 v[168:171], v3, s[12:15], s28 offen offset:2048 sc1
    v_mfma_f32_16x16x32_bf16 v[60:63], v[180:183], v[108:111], v[60:63]
    ds_read_b128 v[104:107], v4 offset:47104
    s_waitcnt lgkmcnt(6)
    v_mfma_f32_16x16x32_bf16 v[64:67], v[176:179], v[112:115], v[64:67]
    v_mfma_f32_16x16x32_bf16 v[68:71], v[180:183], v[112:115], v[68:71]
    ds_read_b128 v[108:111], v4 offset:47360
    s_waitcnt lgkmcnt(6)
    v_mfma_f32_16x16x32_bf16 v[72:75], v[176:179], v[116:119], v[72:75]
    v_mfma_f32_16x16x32_bf16 v[76:79], v[180:183], v[116:119], v[76:79]
    ds_read_b128 v[112:115], v5 offset:14336
    s_waitcnt lgkmcnt(6)
    v_mfma_f32_16x16x32_bf16 v[80:83], v[176:179], v[120:123], v[80:83]
    v_mfma_f32_16x16x32_bf16 v[84:87], v[180:183], v[120:123], v[84:87]
    ds_read_b128 v[116:119], v5 offset:14592
    s_waitcnt lgkmcnt(6)
    v_mfma_f32_16x16x32_bf16 v[88:91], v[176:179], v[124:127], v[88:91]
    s_mov_b32 s28, 8192
    buffer_load_dwordx4 v[172:175], v3, s[12:15], s28 offen offset:3072 sc1
    v_mfma_f32_16x16x32_bf16 v[92:95], v[180:183], v[124:127], v[92:95]
    ds_read_b128 v[120:123], v5 offset:47104
    s_waitcnt lgkmcnt(6)
    v_mfma_f32_16x16x32_bf16 v[32:35], v[184:187], v[96:99], v[32:35]
    v_mfma_f32_16x16x32_bf16 v[36:39], v[188:191], v[96:99], v[36:39]
    v_max3_u32 v24, v8, v9, v10
    v_max3_u32 v25, v11, v12, v13
    v_max3_u32 v26, v14, v15, v16
    v_max3_u32 v27, v17, v18, v19
    v_max3_u32 v24, v24, v20, v21
    v_max3_u32 v25, v25, v22, v23
    v_max3_u32 v24, v24, v25, v26
    v_max_u32 v24, v24, v27
    v_cmp_eq_u32 vcc, -1, v24
    s_cbranch_vccnz L_adaLN_cond__spectral_gfnet__glu_gated_bilinear__prompt_kernel_h2w_100
L_adaLN_cond__spectral_gfnet__glu_gated_bilinear__prompt_kernel_ok_101:
    ds_read_b128 v[124:127], v5 offset:47360
    s_waitcnt lgkmcnt(6)
    v_mfma_f32_16x16x32_bf16 v[40:43], v[184:187], v[100:103], v[40:43]
    v_mfma_f32_16x16x32_bf16 v[44:47], v[188:191], v[100:103], v[44:47]
    s_barrier
    ds_read_b128 v[96:99], v4 offset:16384
    s_waitcnt lgkmcnt(6)
    v_mfma_f32_16x16x32_bf16 v[48:51], v[184:187], v[104:107], v[48:51]
    v_mfma_f32_16x16x32_bf16 v[52:55], v[188:191], v[104:107], v[52:55]
    ds_read_b128 v[100:103], v4 offset:16640
    s_waitcnt lgkmcnt(6)
    v_mfma_f32_16x16x32_bf16 v[56:59], v[184:187], v[108:111], v[56:59]
    s_mov_b32 s28, 12288
    buffer_load_dwordx4 v[176:179], v3, s[12:15], s28 offen offset:0 sc1
    v_mfma_f32_16x16x32_bf16 v[60:63], v[188:191], v[108:111], v[60:63]
    ds_read_b128 v[104:107], v4 offset:49152
    s_waitcnt lgkmcnt(6)
    v_mfma_f32_16x16x32_bf16 v[64:67], v[184:187], v[112:115], v[64:67]
    v_mfma_f32_16x16x32_bf16 v[68:71], v[188:191], v[112:115], v[68:71]
    ds_read_b128 v[108:111], v4 offset:49408
    s_waitcnt lgkmcnt(6)
    v_mfma_f32_16x16x32_bf16 v[72:75], v[184:187], v[116:119], v[72:75]
    v_mfma_f32_16x16x32_bf16 v[76:79], v[188:191], v[116:119], v[76:79]
    ds_read_b128 v[112:115], v5 offset:16384
    s_waitcnt lgkmcnt(6)
    v_mfma_f32_16x16x32_bf16 v[80:83], v[184:187], v[120:123], v[80:83]
    v_mfma_f32_16x16x32_bf16 v[84:87], v[188:191], v[120:123], v[84:87]
    ds_read_b128 v[116:119], v5 offset:16640
    s_waitcnt lgkmcnt(6)
    v_mfma_f32_16x16x32_bf16 v[88:91], v[184:187], v[124:127], v[88:91]
    s_mov_b32 s28, 12288
    buffer_load_dwordx4 v[180:183], v3, s[12:15], s28 offen offset:1024 sc1
    v_mfma_f32_16x16x32_bf16 v[92:95], v[188:191], v[124:127], v[92:95]
    ds_read_b128 v[120:123], v5 offset:49152
    s_waitcnt lgkmcnt(6)
    v_mfma_f32_16x16x32_bf16 v[32:35], v[192:195], v[96:99], v[32:35]
    v_mfma_f32_16x16x32_bf16 v[36:39], v[196:199], v[96:99], v[36:39]
    ds_read_b128 v[124:127], v5 offset:49408
    s_waitcnt lgkmcnt(6)
    v_mfma_f32_16x16x32_bf16 v[40:43], v[192:195], v[100:103], v[40:43]
    v_mfma_f32_16x16x32_bf16 v[44:47], v[196:199], v[100:103], v[44:47]
    ds_read_b128 v[96:99], v4 offset:18432
    s_waitcnt lgkmcnt(6)
    v_mfma_f32_16x16x32_bf16 v[48:51], v[192:195], v[104:107], v[48:51]
    v_mfma_f32_16x16x32_bf16 v[52:55], v[196:199], v[104:107], v[52:55]
    ds_read_b128 v[100:103], v4 offset:18688
    s_waitcnt lgkmcnt(6)
    v_mfma_f32_16x16x32_bf16 v[56:59], v[192:195], v[108:111], v[56:59]
    s_mov_b32 s28, 12288
    buffer_load_dwordx4 v[184:187], v3, s[12:15], s28 offen offset:2048 sc1
    v_mfma_f32_16x16x32_bf16 v[60:63], v[196:199], v[108:111], v[60:63]
    ds_read_b128 v[104:107], v4 offset:51200
    s_waitcnt lgkmcnt(6)
    v_mfma_f32_16x16x32_bf16 v[64:67], v[192:195], v[112:115], v[64:67]
    v_mfma_f32_16x16x32_bf16 v[68:71], v[196:199], v[112:115], v[68:71]
    ds_read_b128 v[108:111], v4 offset:51456
    s_waitcnt lgkmcnt(6)
    v_mfma_f32_16x16x32_bf16 v[72:75], v[192:195], v[116:119], v[72:75]
    v_mfma_f32_16x16x32_bf16 v[76:79], v[196:199], v[116:119], v[76:79]
    ds_read_b128 v[112:115], v5 offset:18432
    s_waitcnt lgkmcnt(6)
    v_mfma_f32_16x16x32_bf16 v[80:83], v[192:195], v[120:123], v[80:83]
    v_mfma_f32_16x16x32_bf16 v[84:87], v[196:199], v[120:123], v[84:87]
    ds_read_b128 v[116:119], v5 offset:18688
    s_waitcnt lgkmcnt(6)
    v_mfma_f32_16x16x32_bf16 v[88:91], v[192:195], v[124:127], v[88:91]
    s_mov_b32 s28, 12288
    buffer_load_dwordx4 v[188:191], v3, s[12:15], s28 offen offset:3072 sc1
    v_mfma_f32_16x16x32_bf16 v[92:95], v[196:199], v[124:127], v[92:95]
    ds_read_b128 v[120:123], v5 offset:51200
    s_waitcnt lgkmcnt(6)
    v_mfma_f32_16x16x32_bf16 v[32:35], v[200:203], v[96:99], v[32:35]
    v_mfma_f32_16x16x32_bf16 v[36:39], v[204:207], v[96:99], v[36:39]
    ds_read_b128 v[124:127], v5 offset:51456
    s_waitcnt lgkmcnt(6)
    v_mfma_f32_16x16x32_bf16 v[40:43], v[200:203], v[100:103], v[40:43]
    v_mfma_f32_16x16x32_bf16 v[44:47], v[204:207], v[100:103], v[44:47]
    ds_read_b128 v[96:99], v4 offset:20480
    s_waitcnt lgkmcnt(6)
    v_mfma_f32_16x16x32_bf16 v[48:51], v[200:203], v[104:107], v[48:51]
    v_mfma_f32_16x16x32_bf16 v[52:55], v[204:207], v[104:107], v[52:55]
    ds_read_b128 v[100:103], v4 offset:20736
    s_waitcnt lgkmcnt(6)
    v_mfma_f32_16x16x32_bf16 v[56:59], v[200:203], v[108:111], v[56:59]
    s_mov_b32 s28, 16384
    buffer_load_dwordx4 v[192:195], v3, s[12:15], s28 offen offset:0 sc1
    v_mfma_f32_16x16x32_bf16 v[60:63], v[204:207], v[108:111], v[60:63]
    ds_read_b128 v[104:107], v4 offset:53248
    s_waitcnt lgkmcnt(6)
    v_mfma_f32_16x16x32_bf16 v[64:67], v[200:203], v[112:115], v[64:67]
    v_mfma_f32_16x16x32_bf16 v[68:71], v[204:207], v[112:115], v[68:71]
    ds_read_b128 v[108:111], v4 offset:53504
    s_waitcnt lgkmcnt(6)
    v_mfma_f32_16x16x32_bf16 v[72:75], v[200:203], v[116:119], v[72:75]
    v_mfma_f32_16x16x32_bf16 v[76:79], v[204:207], v[116:119], v[76:79]
    ds_read_b128 v[112:115], v5 offset:20480
    s_waitcnt lgkmcnt(6)
    v_mfma_f32_16x16x32_bf16 v[80:83], v[200:203], v[120:123], v[80:83]
    v_mfma_f32_16x16x32_bf16 v[84:87], v[204:207], v[120:123], v[84:87]
    ds_read_b128 v[116:119], v5 offset:20736
    s_waitcnt lgkmcnt(6)
    v_mfma_f32_16x16x32_bf16 v[88:91], v[200:203], v[124:127], v[88:91]
    s_mov_b32 s28, 16384
    buffer_load_dwordx4 v[196:199], v3, s[12:15], s28 offen offset:1024 sc1
    v_mfma_f32_16x16x32_bf16 v[92:95], v[204:207], v[124:127], v[92:95]
    ds_read_b128 v[120:123], v5 offset:53248
    s_waitcnt lgkmcnt(6)
    v_mfma_f32_16x16x32_bf16 v[32:35], v[208:211], v[96:99], v[32:35]
    v_mfma_f32_16x16x32_bf16 v[36:39], v[212:215], v[96:99], v[36:39]
    ds_read_b128 v[124:127], v5 offset:53504
    s_waitcnt lgkmcnt(6)
    v_mfma_f32_16x16x32_bf16 v[40:43], v[208:211], v[100:103], v[40:43]
    v_mfma_f32_16x16x32_bf16 v[44:47], v[212:215], v[100:103], v[44:47]
    ds_read_b128 v[96:99], v4 offset:22528
    s_waitcnt lgkmcnt(6)
    v_mfma_f32_16x16x32_bf16 v[48:51], v[208:211], v[104:107], v[48:51]
    v_mfma_f32_16x16x32_bf16 v[52:55], v[212:215], v[104:107], v[52:55]
    s_waitcnt vmcnt(8)
    ds_read_b128 v[8:11], v7 offset:24576
    ds_read_b128 v[12:15], v7 offset:25600
    ds_read_b128 v[16:19], v7 offset:26624
    ds_read_b128 v[20:23], v7 offset:27648
    ds_read_b128 v[100:103], v4 offset:22784
    s_waitcnt lgkmcnt(6)
    v_mfma_f32_16x16x32_bf16 v[56:59], v[208:211], v[108:111], v[56:59]
    s_mov_b32 s28, 16384
    buffer_load_dwordx4 v[200:203], v3, s[12:15], s28 offen offset:2048 sc1
    v_mfma_f32_16x16x32_bf16 v[60:63], v[212:215], v[108:111], v[60:63]
    ds_read_b128 v[104:107], v4 offset:55296
    s_waitcnt lgkmcnt(6)
    v_mfma_f32_16x16x32_bf16 v[64:67], v[208:211], v[112:115], v[64:67]
    v_mfma_f32_16x16x32_bf16 v[68:71], v[212:215], v[112:115], v[68:71]
    ds_read_b128 v[108:111], v4 offset:55552
    s_waitcnt lgkmcnt(6)
    v_mfma_f32_16x16x32_bf16 v[72:75], v[208:211], v[116:119], v[72:75]
    v_mfma_f32_16x16x32_bf16 v[76:79], v[212:215], v[116:119], v[76:79]
    ds_read_b128 v[112:115], v5 offset:22528
    s_waitcnt lgkmcnt(6)
    v_mfma_f32_16x16x32_bf16 v[80:83], v[208:211], v[120:123], v[80:83]
    v_mfma_f32_16x16x32_bf16 v[84:87], v[212:215], v[120:123], v[84:87]
    ds_read_b128 v[116:119], v5 offset:22784
    s_waitcnt lgkmcnt(6)
    v_mfma_f32_16x16x32_bf16 v[88:91], v[208:211], v[124:127], v[88:91]
    s_mov_b32 s28, 16384
    buffer_load_dwordx4 v[204:207], v3, s[12:15], s28 offen offset:3072 sc1
    v_mfma_f32_16x16x32_bf16 v[92:95], v[212:215], v[124:127], v[92:95]
    ds_read_b128 v[120:123], v5 offset:55296
    s_waitcnt lgkmcnt(6)
    v_mfma_f32_16x16x32_bf16 v[32:35], v[216:219], v[96:99], v[32:35]
    v_mfma_f32_16x16x32_bf16 v[36:39], v[220:223], v[96:99], v[36:39]
    v_max3_u32 v24, v8, v9, v10
    v_max3_u32 v25, v11, v12, v13
    v_max3_u32 v26, v14, v15, v16
    v_max3_u32 v27, v17, v18, v19
    v_max3_u32 v24, v24, v20, v21
    v_max3_u32 v25, v25, v22, v23
    v_max3_u32 v24, v24, v25, v26
    v_max_u32 v24, v24, v27
    v_cmp_eq_u32 vcc, -1, v24
    s_cbranch_vccnz L_adaLN_cond__spectral_gfnet__glu_gated_bilinear__prompt_kernel_h2w_102
L_adaLN_cond__spectral_gfnet__glu_gated_bilinear__prompt_kernel_ok_103:
    ds_read_b128 v[124:127], v5 offset:55552
    s_waitcnt lgkmcnt(6)
    v_mfma_f32_16x16x32_bf16 v[40:43], v[216:219], v[100:103], v[40:43]
    v_mfma_f32_16x16x32_bf16 v[44:47], v[220:223], v[100:103], v[44:47]
    s_barrier
    ds_read_b128 v[96:99], v4 offset:24576
    s_waitcnt lgkmcnt(6)
    v_mfma_f32_16x16x32_bf16 v[48:51], v[216:219], v[104:107], v[48:51]
    v_mfma_f32_16x16x32_bf16 v[52:55], v[220:223], v[104:107], v[52:55]
    ds_read_b128 v[100:103], v4 offset:24832
    s_waitcnt lgkmcnt(6)
    v_mfma_f32_16x16x32_bf16 v[56:59], v[216:219], v[108:111], v[56:59]
    s_mov_b32 s28, 20480
    buffer_load_dwordx4 v[208:211], v3, s[12:15], s28 offen offset:0 sc1
    v_mfma_f32_16x16x32_bf16 v[60:63], v[220:223], v[108:111], v[60:63]
    ds_read_b128 v[104:107], v4 offset:57344
    s_waitcnt lgkmcnt(6)
    v_mfma_f32_16x16x32_bf16 v[64:67], v[216:219], v[112:115], v[64:67]
    v_mfma_f32_16x16x32_bf16 v[68:71], v[220:223], v[112:115], v[68:71]
    ds_read_b128 v[108:111], v4 offset:57600
    s_waitcnt lgkmcnt(6)
    v_mfma_f32_16x16x32_bf16 v[72:75], v[216:219], v[116:119], v[72:75]
    v_mfma_f32_16x16x32_bf16 v[76:79], v[220:223], v[116:119], v[76:79]
    ds_read_b128 v[112:115], v5 offset:24576
    s_waitcnt lgkmcnt(6)
    v_mfma_f32_16x16x32_bf16 v[80:83], v[216:219], v[120:123], v[80:83]
    v_mfma_f32_16x16x32_bf16 v[84:87], v[220:223], v[120:123], v[84:87]
    ds_read_b128 v[116:119], v5 offset:24832
    s_waitcnt lgkmcnt(6)
    v_mfma_f32_16x16x32_bf16 v[88:91], v[216:219], v[124:127], v[88:91]
    s_mov_b32 s28, 20480
    buffer_load_dwordx4 v[212:215], v3, s[12:15], s28 offen offset:1024 sc1
    v_mfma_f32_16x16x32_bf16 v[92:95], v[220:223], v[124:127], v[92:95]
    s_lshl_b32 s25, s38, 7
    s_add_u32 s26, s25, 262144
    s_add_u32 s25, s25, 327680
    v_and_b32 v30, 7, v1
    v_lshlrev_b32 v30, 12, v30
    v_add_u32 v30, s26, v30
    v_mov_b32 v29, s25
    v_cmp_gt_u32 vcc, 16, v1
    s_nop 1
    v_cndmask_b32 v29, v30, v29, vcc
    s_lshl_b32 s25, s36, 8
    s_add_u32 s25, s25, 327680
    v_lshlrev_b32 v30, 7, v1
    v_add_u32 v30, s25, v30
    v_cmp_gt_u32 vcc, 2, v1
    s_nop 1
    v_cndmask_b32 v29, v29, v30, vcc
    global_load_dword v28, v29, s[6:7] sc1
    ds_read_b128 v[120:123], v5 offset:57344
    s_waitcnt lgkmcnt(6)
    v_mfma_f32_16x16x32_bf16 v[32:35], v[224:227], v[96:99], v[32:35]
    v_mfma_f32_16x16x32_bf16 v[36:39], v[228:231], v[96:99], v[36:39]
    ds_read_b128 v[124:127], v5 offset:57600
    s_waitcnt lgkmcnt(6)
    v_mfma_f32_16x16x32_bf16 v[40:43], v[224:227], v[100:103], v[40:43]
    v_mfma_f32_16x16x32_bf16 v[44:47], v[228:231], v[100:103], v[44:47]
    ds_read_b128 v[96:99], v4 offset:26624
    s_waitcnt lgkmcnt(6)
    v_mfma_f32_16x16x32_bf16 v[48:51], v[224:227], v[104:107], v[48:51]
    v_mfma_f32_16x16x32_bf16 v[52:55], v[228:231], v[104:107], v[52:55]
    ds_read_b128 v[100:103], v4 offset:26880
    s_waitcnt lgkmcnt(6)
    v_mfma_f32_16x16x32_bf16 v[56:59], v[224:227], v[108:111], v[56:59]
    s_mov_b32 s28, 20480
    buffer_load_dwordx4 v[216:219], v3, s[12:15], s28 offen offset:2048 sc1
    v_mfma_f32_16x16x32_bf16 v[60:63], v[228:231], v[108:111], v[60:63]
    ds_read_b128 v[104:107], v4 offset:59392
    s_waitcnt lgkmcnt(6)
    v_mfma_f32_16x16x32_bf16 v[64:67], v[224:227], v[112:115], v[64:67]
    v_mfma_f32_16x16x32_bf16 v[68:71], v[228:231], v[112:115], v[68:71]
    ds_read_b128 v[108:111], v4 offset:59648
    s_waitcnt lgkmcnt(6)
    v_mfma_f32_16x16x32_bf16 v[72:75], v[224:227], v[116:119], v[72:75]
    v_mfma_f32_16x16x32_bf16 v[76:79], v[228:231], v[116:119], v[76:79]
    ds_read_b128 v[112:115], v5 offset:26624
    s_waitcnt lgkmcnt(6)
    v_mfma_f32_16x16x32_bf16 v[80:83], v[224:227], v[120:123], v[80:83]
    v_mfma_f32_16x16x32_bf16 v[84:87], v[228:231], v[120:123], v[84:87]
    ds_read_b128 v[116:119], v5 offset:26880
    s_waitcnt lgkmcnt(6)
    v_mfma_f32_16x16x32_bf16 v[88:91], v[224:227], v[124:127], v[88:91]
    s_mov_b32 s28, 20480
    buffer_load_dwordx4 v[220:223], v3, s[12:15], s28 offen offset:3072 sc1
    v_mfma_f32_16x16x32_bf16 v[92:95], v[228:231], v[124:127], v[92:95]
    ds_read_b128 v[120:123], v5 offset:59392
    s_waitcnt lgkmcnt(6)
    v_mfma_f32_16x16x32_bf16 v[32:35], v[232:235], v[96:99], v[32:35]
    v_mfma_f32_16x16x32_bf16 v[36:39], v[236:239], v[96:99], v[36:39]
    ds_read_b128 v[124:127], v5 offset:59648
    s_waitcnt lgkmcnt(6)
    v_mfma_f32_16x16x32_bf16 v[40:43], v[232:235], v[100:103], v[40:43]
    v_mfma_f32_16x16x32_bf16 v[44:47], v[236:239], v[100:103], v[44:47]
    ds_read_b128 v[96:99], v4 offset:28672
    s_waitcnt lgkmcnt(6)
    v_mfma_f32_16x16x32_bf16 v[48:51], v[232:235], v[104:107], v[48:51]
    v_mfma_f32_16x16x32_bf16 v[52:55], v[236:239], v[104:107], v[52:55]
    ds_read_b128 v[100:103], v4 offset:28928
    s_waitcnt lgkmcnt(6)
    v_mfma_f32_16x16x32_bf16 v[56:59], v[232:235], v[108:111], v[56:59]
    s_mov_b32 s28, 24576
    buffer_load_dwordx4 v[224:227], v3, s[12:15], s28 offen offset:0 sc1
    v_mfma_f32_16x16x32_bf16 v[60:63], v[236:239], v[108:111], v[60:63]
    ds_read_b128 v[104:107], v4 offset:61440
    s_waitcnt lgkmcnt(6)
    v_mfma_f32_16x16x32_bf16 v[64:67], v[232:235], v[112:115], v[64:67]
    v_mfma_f32_16x16x32_bf16 v[68:71], v[236:239], v[112:115], v[68:71]
    ds_read_b128 v[108:111], v4 offset:61696
    s_waitcnt lgkmcnt(6)
    v_mfma_f32_16x16x32_bf16 v[72:75], v[232:235], v[116:119], v[72:75]
    v_mfma_f32_16x16x32_bf16 v[76:79], v[236:239], v[116:119], v[76:79]
    ds_read_b128 v[112:115], v5 offset:28672
    s_waitcnt lgkmcnt(6)
    v_mfma_f32_16x16x32_bf16 v[80:83], v[232:235], v[120:123], v[80:83]
    v_mfma_f32_16x16x32_bf16 v[84:87], v[236:239], v[120:123], v[84:87]
    ds_read_b128 v[116:119], v5 offset:28928
    s_waitcnt lgkmcnt(6)
    v_mfma_f32_16x16x32_bf16 v[88:91], v[232:235], v[124:127], v[88:91]
    s_mov_b32 s28, 24576
    buffer_load_dwordx4 v[228:231], v3, s[12:15], s28 offen offset:1024 sc1
    v_mfma_f32_16x16x32_bf16 v[92:95], v[236:239], v[124:127], v[92:95]
    ds_read_b128 v[120:123], v5 offset:61440
    s_waitcnt lgkmcnt(6)
    v_mfma_f32_16x16x32_bf16 v[32:35], v[240:243], v[96:99], v[32:35]
    v_mfma_f32_16x16x32_bf16 v[36:39], v[244:247], v[96:99], v[36:39]
    ds_read_b128 v[124:127], v5 offset:61696
    s_waitcnt lgkmcnt(6)
    v_mfma_f32_16x16x32_bf16 v[40:43], v[240:243], v[100:103], v[40:43]
    v_mfma_f32_16x16x32_bf16 v[44:47], v[244:247], v[100:103], v[44:47]
    ds_read_b128 v[96:99], v4 offset:30720
    s_waitcnt lgkmcnt(6)
    v_mfma_f32_16x16x32_bf16 v[48:51], v[240:243], v[104:107], v[48:51]
    v_mfma_f32_16x16x32_bf16 v[52:55], v[244:247], v[104:107], v[52:55]
    ds_read_b128 v[100:103], v4 offset:30976
    s_waitcnt lgkmcnt(6)
    v_mfma_f32_16x16x32_bf16 v[56:59], v[240:243], v[108:111], v[56:59]
    s_mov_b32 s28, 24576
    buffer_load_dwordx4 v[232:235], v3, s[12:15], s28 offen offset:2048 sc1
    v_mfma_f32_16x16x32_bf16 v[60:63], v[244:247], v[108:111], v[60:63]
    ds_read_b128 v[104:107], v4 offset:63488
    s_waitcnt lgkmcnt(6)
    v_mfma_f32_16x16x32_bf16 v[64:67], v[240:243], v[112:115], v[64:67]
    v_mfma_f32_16x16x32_bf16 v[68:71], v[244:247], v[112:115], v[68:71]
    ds_read_b128 v[108:111], v4 offset:63744
    s_waitcnt lgkmcnt(6)
    v_mfma_f32_16x16x32_bf16 v[72:75], v[240:243], v[116:119], v[72:75]
    v_mfma_f32_16x16x32_bf16 v[76:79], v[244:247], v[116:119], v[76:79]
    ds_read_b128 v[112:115], v5 offset:30720
    s_waitcnt lgkmcnt(6)
    v_mfma_f32_16x16x32_bf16 v[80:83], v[240:243], v[120:123], v[80:83]
    v_mfma_f32_16x16x32_bf16 v[84:87], v[244:247], v[120:123], v[84:87]
    ds_read_b128 v[116:119], v5 offset:30976
    s_waitcnt lgkmcnt(6)
    v_mfma_f32_16x16x32_bf16 v[88:91], v[240:243], v[124:127], v[88:91]
    s_mov_b32 s28, 24576
    buffer_load_dwordx4 v[236:239], v3, s[12:15], s28 offen offset:3072 sc1
    v_mfma_f32_16x16x32_bf16 v[92:95], v[244:247], v[124:127], v[92:95]
    ds_read_b128 v[120:123], v5 offset:63488
    s_waitcnt lgkmcnt(6)
    v_mfma_f32_16x16x32_bf16 v[32:35], v[248:251], v[96:99], v[32:35]
    v_mfma_f32_16x16x32_bf16 v[36:39], v[252:255], v[96:99], v[36:39]
    ds_read_b128 v[124:127], v5 offset:63744
    s_waitcnt lgkmcnt(6)
    v_mfma_f32_16x16x32_bf16 v[40:43], v[248:251], v[100:103], v[40:43]
    v_mfma_f32_16x16x32_bf16 v[44:47], v[252:255], v[100:103], v[44:47]
    s_waitcnt lgkmcnt(5)
    v_mfma_f32_16x16x32_bf16 v[48:51], v[248:251], v[104:107], v[48:51]
    v_mfma_f32_16x16x32_bf16 v[52:55], v[252:255], v[104:107], v[52:55]
    s_waitcnt lgkmcnt(4)
    v_mfma_f32_16x16x32_bf16 v[56:59], v[248:251], v[108:111], v[56:59]
    v_mfma_f32_16x16x32_bf16 v[60:63], v[252:255], v[108:111], v[60:63]
    s_waitcnt lgkmcnt(3)
    v_mfma_f32_16x16x32_bf16 v[64:67], v[248:251], v[112:115], v[64:67]
    v_mfma_f32_16x16x32_bf16 v[68:71], v[252:255], v[112:115], v[68:71]
    s_waitcnt lgkmcnt(2)
    v_mfma_f32_16x16x32_bf16 v[72:75], v[248:251], v[116:119], v[72:75]
    v_mfma_f32_16x16x32_bf16 v[76:79], v[252:255], v[116:119], v[76:79]
    s_waitcnt lgkmcnt(1)
    v_mfma_f32_16x16x32_bf16 v[80:83], v[248:251], v[120:123], v[80:83]
    v_mfma_f32_16x16x32_bf16 v[84:87], v[252:255], v[120:123], v[84:87]
    s_waitcnt lgkmcnt(0)
    v_mfma_f32_16x16x32_bf16 v[88:91], v[248:251], v[124:127], v[88:91]
    v_mfma_f32_16x16x32_bf16 v[92:95], v[252:255], v[124:127], v[92:95]
    v_mov_b32 v24, 163072
    v_mov_b32 v25, 1
    s_mov_b64 exec, 1
    ds_add_u32 v24, v25
    s_mov_b64 exec, -1
    s_waitcnt vmcnt(6)
    v_cmp_ne_u32 vcc, s3, v28
    s_cbranch_vccz L_adaLN_cond__spectral_gfnet__glu_gated_bilinear__prompt_kernel_fok_104
    s_mov_b32 s97, 0
L_adaLN_cond__spectral_gfnet__glu_gated_bilinear__prompt_kernel_de3_105:
    global_load_dword v28, v29, s[6:7] sc1
    s_waitcnt vmcnt(0)
    v_cmp_ne_u32 vcc, s3, v28
    s_cbranch_vccz L_adaLN_cond__spectral_gfnet__glu_gated_bilinear__prompt_kernel_de3_105_x
    s_add_u32 s97, s97, 1
    s_cmp_lt_u32 s97, s96
    s_cbranch_scc1 L_adaLN_cond__spectral_gfnet__glu_gated_bilinear__prompt_kernel_de3_105
    s_mov_b32 s96, 0
L_adaLN_cond__spectral_gfnet__glu_gated_bilinear__prompt_kernel_de3_105_x:
L_adaLN_cond__spectral_gfnet__glu_gated_bilinear__prompt_kernel_fok_104:
    v_mov_b32 v6, v2
    v_pk_mul_f32 v[32:33], v[32:33], v[36:37]
    v_pk_mul_f32 v[34:35], v[34:35], v[38:39]
    v_pk_mul_f32 v[40:41], v[40:41], v[44:45]
    v_pk_mul_f32 v[42:43], v[42:43], v[46:47]
    v_cvt_pk_bf16_f32 v36, v32, v33
    v_cvt_pk_bf16_f32 v37, v34, v35
    v_cvt_pk_bf16_f32 v38, v40, v41
    v_cvt_pk_bf16_f32 v39, v42, v43
    v_add_u32 v7, 0, v6
    s_nop 0
    v_permlane32_swap_b32 v36, v38
    v_permlane32_swap_b32 v37, v39
    s_nop 1
    global_store_dwordx4 v7, v[36:39], s[6:7] sc1
    v_pk_mul_f32 v[48:49], v[48:49], v[52:53]
    v_pk_mul_f32 v[50:51], v[50:51], v[54:55]
    v_pk_mul_f32 v[56:57], v[56:57], v[60:61]
    v_pk_mul_f32 v[58:59], v[58:59], v[62:63]
    v_cvt_pk_bf16_f32 v52, v48, v49
    v_cvt_pk_bf16_f32 v53, v50, v51
    v_cvt_pk_bf16_f32 v54, v56, v57
    v_cvt_pk_bf16_f32 v55, v58, v59
    v_add_u32 v7, 114688, v6
    s_nop 0
    v_permlane32_swap_b32 v52, v54
    v_permlane32_swap_b32 v53, v55
    s_nop 1
    global_store_dwordx4 v7, v[52:55], s[6:7] sc1
    v_pk_mul_f32 v[64:65], v[64:65], v[68:69]
    v_pk_mul_f32 v[66:67], v[66:67], v[70:71]
    v_pk_mul_f32 v[72:73], v[72:73], v[76:77]
    v_pk_mul_f32 v[74:75], v[74:75], v[78:79]
    v_cvt_pk_bf16_f32 v68, v64, v65
    v_cvt_pk_bf16_f32 v69, v66, v67
    v_cvt_pk_bf16_f32 v70, v72, v73
    v_cvt_pk_bf16_f32 v71, v74, v75
    v_add_u32 v7, 229376, v6
    s_nop 0
    v_permlane32_swap_b32 v68, v70
    v_permlane32_swap_b32 v69, v71
    s_nop 1
    global_store_dwordx4 v7, v[68:71], s[6:7] sc1
    v_pk_mul_f32 v[80:81], v[80:81], v[84:85]
    v_pk_mul_f32 v[82:83], v[82:83], v[86:87]
    v_pk_mul_f32 v[88:89], v[88:89], v[92:93]
    v_pk_mul_f32 v[90:91], v[90:91], v[94:95]
    v_cvt_pk_bf16_f32 v84, v80, v81
    v_cvt_pk_bf16_f32 v85, v82, v83
    v_cvt_pk_bf16_f32 v86, v88, v89
    v_cvt_pk_bf16_f32 v87, v90, v91
    v_add_u32 v7, 344064, v6
    s_nop 0
    v_permlane32_swap_b32 v84, v86
    v_permlane32_swap_b32 v85, v87
    s_nop 1
    global_store_dwordx4 v7, v[84:87], s[6:7] sc1
    v_lshlrev_b32 v240, 4, v1
    v_mov_b32 v241, v0
    s_mul_i32 s26, s10, 14
    s_mul_i32 s27, s38, 224
    s_add_u32 s27, s27, s26
    s_lshl_b32 s27, s27, 10
    s_add_u32 s27, s27, 25165824
    s_add_u32 s16, s6, s27
    s_addc_u32 s17, s7, 0
    s_mov_b32 s18, 129024
    s_mov_b32 s19, 0x20000
    v_and_b32 v252, 15, v0
    v_lshrrev_b32 v253, 4, v0
    s_lshl_b32 s25, s38, 16
    s_lshl_b32 s26, s39, 7
    s_add_u32 s25, s25, s26
    s_add_u32 s25, s25, 10485760
    v_lshlrev_b32 v242, 10, v253
    v_lshlrev_b32 v254, 3, v252
    v_add_u32 v242, v242, v254
    v_add_u32 v242, s25, v242
    v_add_u32 v243, 32768, v242
    s_lshl_b32 s26, s39, 8
    s_add_u32 s26, s26, 30720
    v_lshlrev_b32 v254, 4, v252
    v_add_u32 v255, s26, v254
    global_load_dwordx4 v[248:251], v255, s[6:7] sc1
    s_waitcnt vmcnt(0)
    s_barrier
    global_load_dwordx2 v[244:245], v242, s[6:7] sc1
    global_load_dwordx2 v[246:247], v243, s[6:7] sc1
    s_mov_b32 s28, 0
    buffer_load_dwordx4 v[64:67], v240, s[16:19], s28 offen offset:0 sc1
    s_mov_b32 s28, 114688
    buffer_load_dwordx4 v[68:71], v240, s[16:19], s28 offen offset:0 sc1
    s_mov_b32 s28, 0
    buffer_load_dwordx4 v[72:75], v240, s[16:19], s28 offen offset:1024 sc1
    s_mov_b32 s28, 114688
    buffer_load_dwordx4 v[76:79], v240, s[16:19], s28 offen offset:1024 sc1
    s_mov_b32 s28, 0
    buffer_load_dwordx4 v[80:83], v240, s[16:19], s28 offen offset:2048 sc1
    s_mov_b32 s28, 114688
    buffer_load_dwordx4 v[84:87], v240, s[16:19], s28 offen offset:2048 sc1
    s_waitcnt vmcnt(4)
    v_max3_u32 v252, v64, v65, v66
    v_max3_u32 v253, v67, v68, v69
    v_max3_u32 v252, v252, v70, v71
    v_max_u32 v252, v252, v253
    v_cmp_eq_u32 vcc, -1, v252
    s_cbranch_vccz L_adaLN_cond__spectral_gfnet__glu_gated_bilinear__prompt_kernel_ok_106
    s_mov_b32 s97, 0
L_adaLN_cond__spectral_gfnet__glu_gated_bilinear__prompt_kernel_hhr_107:
    s_mov_b32 s28, 0
    buffer_load_dwordx4 v[64:67], v240, s[16:19], s28 offen offset:0 sc1
    s_mov_b32 s28, 114688
    buffer_load_dwordx4 v[68:71], v240, s[16:19], s28 offen offset:0 sc1
    s_waitcnt vmcnt(0)
    v_max3_u32 v252, v64, v65, v66
    v_max3_u32 v253, v67, v68, v69
    v_max3_u32 v252, v252, v70, v71
    v_max_u32 v252, v252, v253
    v_cmp_eq_u32 vcc, -1, v252
    s_cbranch_vccz L_adaLN_cond__spectral_gfnet__glu_gated_bilinear__prompt_kernel_hhr_107_x
    s_add_u32 s97, s97, 1
    s_cmp_lt_u32 s97, s96
    s_cbranch_scc1 L_adaLN_cond__spectral_gfnet__glu_gated_bilinear__prompt_kernel_hhr_107
    s_mov_b32 s96, 0
L_adaLN_cond__spectral_gfnet__glu_gated_bilinear__prompt_kernel_hhr_107_x:
L_adaLN_cond__spectral_gfnet__glu_gated_bilinear__prompt_kernel_ok_106:
    s_mov_b32 s28, 0
    buffer_load_dwordx4 v[88:91], v240, s[16:19], s28 offen offset:3072 sc1
    s_mov_b32 s28, 114688
    buffer_load_dwordx4 v[92:95], v240, s[16:19], s28 offen offset:3072 sc1
    v_mfma_f32_32x32x16_bf16 v[0:15], v[64:67], v[128:131], 0
    v_mfma_f32_32x32x16_bf16 v[16:31], v[64:67], v[132:135], 0
    v_mfma_f32_32x32x16_bf16 v[32:47], v[68:71], v[128:131], 0
    v_mfma_f32_32x32x16_bf16 v[48:63], v[68:71], v[132:135], 0
    s_waitcnt vmcnt(4)
    v_max3_u32 v252, v72, v73, v74
    v_max3_u32 v253, v75, v76, v77
    v_max3_u32 v252, v252, v78, v79
    v_max_u32 v252, v252, v253
    v_cmp_eq_u32 vcc, -1, v252
    s_cbranch_vccz L_adaLN_cond__spectral_gfnet__glu_gated_bilinear__prompt_kernel_ok_108
    s_mov_b32 s97, 0
L_adaLN_cond__spectral_gfnet__glu_gated_bilinear__prompt_kernel_hhr_109:
    s_mov_b32 s28, 0
    buffer_load_dwordx4 v[72:75], v240, s[16:19], s28 offen offset:1024 sc1
    s_mov_b32 s28, 114688
    buffer_load_dwordx4 v[76:79], v240, s[16:19], s28 offen offset:1024 sc1
    s_waitcnt vmcnt(0)
    v_max3_u32 v252, v72, v73, v74
    v_max3_u32 v253, v75, v76, v77
    v_max3_u32 v252, v252, v78, v79
    v_max_u32 v252, v252, v253
    v_cmp_eq_u32 vcc, -1, v252
    s_cbranch_vccz L_adaLN_cond__spectral_gfnet__glu_gated_bilinear__prompt_kernel_hhr_109_x
    s_add_u32 s97, s97, 1
    s_cmp_lt_u32 s97, s96
    s_cbranch_scc1 L_adaLN_cond__spectral_gfnet__glu_gated_bilinear__prompt_kernel_hhr_109
    s_mov_b32 s96, 0
L_adaLN_cond__spectral_gfnet__glu_gated_bilinear__prompt_kernel_hhr_109_x:
L_adaLN_cond__spectral_gfnet__glu_gated_bilinear__prompt_kernel_ok_108:
    s_mov_b32 s28, 4096
    buffer_load_dwordx4 v[64:67], v240, s[16:19], s28 offen offset:0 sc1
    s_mov_b32 s28, 118784
    buffer_load_dwordx4 v[68:71], v240, s[16:19], s28 offen offset:0 sc1
    v_mfma_f32_32x32x16_bf16 v[0:15], v[72:75], v[136:139], v[0:15]
    v_mfma_f32_32x32x16_bf16 v[16:31], v[72:75], v[140:143], v[16:31]
    v_mfma_f32_32x32x16_bf16 v[32:47], v[76:79], v[136:139], v[32:47]
    v_mfma_f32_32x32x16_bf16 v[48:63], v[76:79], v[140:143], v[48:63]
    s_waitcnt vmcnt(4)
    v_max3_u32 v252, v80, v81, v82
    v_max3_u32 v253, v83, v84, v85
    v_max3_u32 v252, v252, v86, v87
    v_max_u32 v252, v252, v253
    v_cmp_eq_u32 vcc, -1, v252
    s_cbranch_vccz L_adaLN_cond__spectral_gfnet__glu_gated_bilinear__prompt_kernel_ok_110
    s_mov_b32 s97, 0
L_adaLN_cond__spectral_gfnet__glu_gated_bilinear__prompt_kernel_hhr_111:
    s_mov_b32 s28, 0
    buffer_load_dwordx4 v[80:83], v240, s[16:19], s28 offen offset:2048 sc1
    s_mov_b32 s28, 114688
    buffer_load_dwordx4 v[84:87], v240, s[16:19], s28 offen offset:2048 sc1
    s_waitcnt vmcnt(0)
    v_max3_u32 v252, v80, v81, v82
    v_max3_u32 v253, v83, v84, v85
    v_max3_u32 v252, v252, v86, v87
    v_max_u32 v252, v252, v253
    v_cmp_eq_u32 vcc, -1, v252
    s_cbranch_vccz L_adaLN_cond__spectral_gfnet__glu_gated_bilinear__prompt_kernel_hhr_111_x
    s_add_u32 s97, s97, 1
    s_cmp_lt_u32 s97, s96
    s_cbranch_scc1 L_adaLN_cond__spectral_gfnet__glu_gated_bilinear__prompt_kernel_hhr_111
    s_mov_b32 s96, 0
L_adaLN_cond__spectral_gfnet__glu_gated_bilinear__prompt_kernel_hhr_111_x:
L_adaLN_cond__spectral_gfnet__glu_gated_bilinear__prompt_kernel_ok_110:
    s_mov_b32 s28, 4096
    buffer_load_dwordx4 v[72:75], v240, s[16:19], s28 offen offset:1024 sc1
    s_mov_b32 s28, 118784
    buffer_load_dwordx4 v[76:79], v240, s[16:19], s28 offen offset:1024 sc1
    v_mfma_f32_32x32x16_bf16 v[0:15], v[80:83], v[144:147], v[0:15]
    v_mfma_f32_32x32x16_bf16 v[16:31], v[80:83], v[148:151], v[16:31]
    v_mfma_f32_32x32x16_bf16 v[32:47], v[84:87], v[144:147], v[32:47]
    v_mfma_f32_32x32x16_bf16 v[48:63], v[84:87], v[148:151], v[48:63]
    s_waitcnt vmcnt(4)
    v_max3_u32 v252, v88, v89, v90
    v_max3_u32 v253, v91, v92, v93
    v_max3_u32 v252, v252, v94, v95
    v_max_u32 v252, v252, v253
    v_cmp_eq_u32 vcc, -1, v252
    s_cbranch_vccz L_adaLN_cond__spectral_gfnet__glu_gated_bilinear__prompt_kernel_ok_112
    s_mov_b32 s97, 0
L_adaLN_cond__spectral_gfnet__glu_gated_bilinear__prompt_kernel_hhr_113:
    s_mov_b32 s28, 0
    buffer_load_dwordx4 v[88:91], v240, s[16:19], s28 offen offset:3072 sc1
    s_mov_b32 s28, 114688
    buffer_load_dwordx4 v[92:95], v240, s[16:19], s28 offen offset:3072 sc1
    s_waitcnt vmcnt(0)
    v_max3_u32 v252, v88, v89, v90
    v_max3_u32 v253, v91, v92, v93
    v_max3_u32 v252, v252, v94, v95
    v_max_u32 v252, v252, v253
    v_cmp_eq_u32 vcc, -1, v252
    s_cbranch_vccz L_adaLN_cond__spectral_gfnet__glu_gated_bilinear__prompt_kernel_hhr_113_x
    s_add_u32 s97, s97, 1
    s_cmp_lt_u32 s97, s96
    s_cbranch_scc1 L_adaLN_cond__spectral_gfnet__glu_gated_bilinear__prompt_kernel_hhr_113
    s_mov_b32 s96, 0
L_adaLN_cond__spectral_gfnet__glu_gated_bilinear__prompt_kernel_hhr_113_x:
L_adaLN_cond__spectral_gfnet__glu_gated_bilinear__prompt_kernel_ok_112:
    s_mov_b32 s28, 4096
    buffer_load_dwordx4 v[80:83], v240, s[16:19], s28 offen offset:2048 sc1
    s_mov_b32 s28, 118784
    buffer_load_dwordx4 v[84:87], v240, s[16:19], s28 offen offset:2048 sc1
    v_mfma_f32_32x32x16_bf16 v[0:15], v[88:91], v[152:155], v[0:15]
    v_mfma_f32_32x32x16_bf16 v[16:31], v[88:91], v[156:159], v[16:31]
    v_mfma_f32_32x32x16_bf16 v[32:47], v[92:95], v[152:155], v[32:47]
    v_mfma_f32_32x32x16_bf16 v[48:63], v[92:95], v[156:159], v[48:63]
    s_waitcnt vmcnt(4)
    v_max3_u32 v252, v64, v65, v66
    v_max3_u32 v253, v67, v68, v69
    v_max3_u32 v252, v252, v70, v71
    v_max_u32 v252, v252, v253
    v_cmp_eq_u32 vcc, -1, v252
    s_cbranch_vccz L_adaLN_cond__spectral_gfnet__glu_gated_bilinear__prompt_kernel_ok_114
    s_mov_b32 s97, 0
L_adaLN_cond__spectral_gfnet__glu_gated_bilinear__prompt_kernel_hhr_115:
    s_mov_b32 s28, 4096
    buffer_load_dwordx4 v[64:67], v240, s[16:19], s28 offen offset:0 sc1
    s_mov_b32 s28, 118784
    buffer_load_dwordx4 v[68:71], v240, s[16:19], s28 offen offset:0 sc1
    s_waitcnt vmcnt(0)
    v_max3_u32 v252, v64, v65, v66
    v_max3_u32 v253, v67, v68, v69
    v_max3_u32 v252, v252, v70, v71
    v_max_u32 v252, v252, v253
    v_cmp_eq_u32 vcc, -1, v252
    s_cbranch_vccz L_adaLN_cond__spectral_gfnet__glu_gated_bilinear__prompt_kernel_hhr_115_x
    s_add_u32 s97, s97, 1
    s_cmp_lt_u32 s97, s96
    s_cbranch_scc1 L_adaLN_cond__spectral_gfnet__glu_gated_bilinear__prompt_kernel_hhr_115
    s_mov_b32 s96, 0
L_adaLN_cond__spectral_gfnet__glu_gated_bilinear__prompt_kernel_hhr_115_x:
L_adaLN_cond__spectral_gfnet__glu_gated_bilinear__prompt_kernel_ok_114:
    s_mov_b32 s28, 4096
    buffer_load_dwordx4 v[88:91], v240, s[16:19], s28 offen offset:3072 sc1
    s_mov_b32 s28, 118784
    buffer_load_dwordx4 v[92:95], v240, s[16:19], s28 offen offset:3072 sc1
    v_mfma_f32_32x32x16_bf16 v[0:15], v[64:67], v[160:163], v[0:15]
    v_mfma_f32_32x32x16_bf16 v[16:31], v[64:67], v[164:167], v[16:31]
    v_mfma_f32_32x32x16_bf16 v[32:47], v[68:71], v[160:163], v[32:47]
    v_mfma_f32_32x32x16_bf16 v[48:63], v[68:71], v[164:167], v[48:63]
    s_waitcnt vmcnt(4)
    v_max3_u32 v252, v72, v73, v74
    v_max3_u32 v253, v75, v76, v77
    v_max3_u32 v252, v252, v78, v79
    v_max_u32 v252, v252, v253
    v_cmp_eq_u32 vcc, -1, v252
    s_cbranch_vccz L_adaLN_cond__spectral_gfnet__glu_gated_bilinear__prompt_kernel_ok_116
    s_mov_b32 s97, 0
L_adaLN_cond__spectral_gfnet__glu_gated_bilinear__prompt_kernel_hhr_117:
    s_mov_b32 s28, 4096
    buffer_load_dwordx4 v[72:75], v240, s[16:19], s28 offen offset:1024 sc1
    s_mov_b32 s28, 118784
    buffer_load_dwordx4 v[76:79], v240, s[16:19], s28 offen offset:1024 sc1
    s_waitcnt vmcnt(0)
    v_max3_u32 v252, v72, v73, v74
    v_max3_u32 v253, v75, v76, v77
    v_max3_u32 v252, v252, v78, v79
    v_max_u32 v252, v252, v253
    v_cmp_eq_u32 vcc, -1, v252
    s_cbranch_vccz L_adaLN_cond__spectral_gfnet__glu_gated_bilinear__prompt_kernel_hhr_117_x
    s_add_u32 s97, s97, 1
    s_cmp_lt_u32 s97, s96
    s_cbranch_scc1 L_adaLN_cond__spectral_gfnet__glu_gated_bilinear__prompt_kernel_hhr_117
    s_mov_b32 s96, 0
L_adaLN_cond__spectral_gfnet__glu_gated_bilinear__prompt_kernel_hhr_117_x:
L_adaLN_cond__spectral_gfnet__glu_gated_bilinear__prompt_kernel_ok_116:
    s_mov_b32 s28, 8192
    buffer_load_dwordx4 v[64:67], v240, s[16:19], s28 offen offset:0 sc1
    s_mov_b32 s28, 122880
    buffer_load_dwordx4 v[68:71], v240, s[16:19], s28 offen offset:0 sc1
    v_mfma_f32_32x32x16_bf16 v[0:15], v[72:75], v[168:171], v[0:15]
    v_mfma_f32_32x32x16_bf16 v[16:31], v[72:75], v[172:175], v[16:31]
    v_mfma_f32_32x32x16_bf16 v[32:47], v[76:79], v[168:171], v[32:47]
    v_mfma_f32_32x32x16_bf16 v[48:63], v[76:79], v[172:175], v[48:63]
    s_waitcnt vmcnt(4)
    v_max3_u32 v252, v80, v81, v82
    v_max3_u32 v253, v83, v84, v85
    v_max3_u32 v252, v252, v86, v87
    v_max_u32 v252, v252, v253
    v_cmp_eq_u32 vcc, -1, v252
    s_cbranch_vccz L_adaLN_cond__spectral_gfnet__glu_gated_bilinear__prompt_kernel_ok_118
    s_mov_b32 s97, 0
L_adaLN_cond__spectral_gfnet__glu_gated_bilinear__prompt_kernel_hhr_119:
    s_mov_b32 s28, 4096
    buffer_load_dwordx4 v[80:83], v240, s[16:19], s28 offen offset:2048 sc1
    s_mov_b32 s28, 118784
    buffer_load_dwordx4 v[84:87], v240, s[16:19], s28 offen offset:2048 sc1
    s_waitcnt vmcnt(0)
    v_max3_u32 v252, v80, v81, v82
    v_max3_u32 v253, v83, v84, v85
    v_max3_u32 v252, v252, v86, v87
    v_max_u32 v252, v252, v253
    v_cmp_eq_u32 vcc, -1, v252
    s_cbranch_vccz L_adaLN_cond__spectral_gfnet__glu_gated_bilinear__prompt_kernel_hhr_119_x
    s_add_u32 s97, s97, 1
    s_cmp_lt_u32 s97, s96
    s_cbranch_scc1 L_adaLN_cond__spectral_gfnet__glu_gated_bilinear__prompt_kernel_hhr_119
    s_mov_b32 s96, 0
L_adaLN_cond__spectral_gfnet__glu_gated_bilinear__prompt_kernel_hhr_119_x:
L_adaLN_cond__spectral_gfnet__glu_gated_bilinear__prompt_kernel_ok_118:
    s_mov_b32 s28, 8192
    buffer_load_dwordx4 v[72:75], v240, s[16:19], s28 offen offset:1024 sc1
    s_mov_b32 s28, 122880
    buffer_load_dwordx4 v[76:79], v240, s[16:19], s28 offen offset:1024 sc1
    v_mfma_f32_32x32x16_bf16 v[0:15], v[80:83], v[176:179], v[0:15]
    v_mfma_f32_32x32x16_bf16 v[16:31], v[80:83], v[180:183], v[16:31]
    v_mfma_f32_32x32x16_bf16 v[32:47], v[84:87], v[176:179], v[32:47]
    v_mfma_f32_32x32x16_bf16 v[48:63], v[84:87], v[180:183], v[48:63]
    s_waitcnt vmcnt(4)
    v_max3_u32 v252, v88, v89, v90
    v_max3_u32 v253, v91, v92, v93
    v_max3_u32 v252, v252, v94, v95
    v_max_u32 v252, v252, v253
    v_cmp_eq_u32 vcc, -1, v252
    s_cbranch_vccz L_adaLN_cond__spectral_gfnet__glu_gated_bilinear__prompt_kernel_ok_120
    s_mov_b32 s97, 0
L_adaLN_cond__spectral_gfnet__glu_gated_bilinear__prompt_kernel_hhr_121:
    s_mov_b32 s28, 4096
    buffer_load_dwordx4 v[88:91], v240, s[16:19], s28 offen offset:3072 sc1
    s_mov_b32 s28, 118784
    buffer_load_dwordx4 v[92:95], v240, s[16:19], s28 offen offset:3072 sc1
    s_waitcnt vmcnt(0)
    v_max3_u32 v252, v88, v89, v90
    v_max3_u32 v253, v91, v92, v93
    v_max3_u32 v252, v252, v94, v95
    v_max_u32 v252, v252, v253
    v_cmp_eq_u32 vcc, -1, v252
    s_cbranch_vccz L_adaLN_cond__spectral_gfnet__glu_gated_bilinear__prompt_kernel_hhr_121_x
    s_add_u32 s97, s97, 1
    s_cmp_lt_u32 s97, s96
    s_cbranch_scc1 L_adaLN_cond__spectral_gfnet__glu_gated_bilinear__prompt_kernel_hhr_121
    s_mov_b32 s96, 0
L_adaLN_cond__spectral_gfnet__glu_gated_bilinear__prompt_kernel_hhr_121_x:
L_adaLN_cond__spectral_gfnet__glu_gated_bilinear__prompt_kernel_ok_120:
    s_mov_b32 s28, 8192
    buffer_load_dwordx4 v[80:83], v240, s[16:19], s28 offen offset:2048 sc1
    s_mov_b32 s28, 122880
    buffer_load_dwordx4 v[84:87], v240, s[16:19], s28 offen offset:2048 sc1
    v_mfma_f32_32x32x16_bf16 v[0:15], v[88:91], v[184:187], v[0:15]
    v_mfma_f32_32x32x16_bf16 v[16:31], v[88:91], v[188:191], v[16:31]
    v_mfma_f32_32x32x16_bf16 v[32:47], v[92:95], v[184:187], v[32:47]
    v_mfma_f32_32x32x16_bf16 v[48:63], v[92:95], v[188:191], v[48:63]
    s_waitcnt vmcnt(4)
    v_max3_u32 v252, v64, v65, v66
    v_max3_u32 v253, v67, v68, v69
    v_max3_u32 v252, v252, v70, v71
    v_max_u32 v252, v252, v253
    v_cmp_eq_u32 vcc, -1, v252
    s_cbranch_vccz L_adaLN_cond__spectral_gfnet__glu_gated_bilinear__prompt_kernel_ok_122
    s_mov_b32 s97, 0
L_adaLN_cond__spectral_gfnet__glu_gated_bilinear__prompt_kernel_hhr_123:
    s_mov_b32 s28, 8192
    buffer_load_dwordx4 v[64:67], v240, s[16:19], s28 offen offset:0 sc1
    s_mov_b32 s28, 122880
    buffer_load_dwordx4 v[68:71], v240, s[16:19], s28 offen offset:0 sc1
    s_waitcnt vmcnt(0)
    v_max3_u32 v252, v64, v65, v66
    v_max3_u32 v253, v67, v68, v69
    v_max3_u32 v252, v252, v70, v71
    v_max_u32 v252, v252, v253
    v_cmp_eq_u32 vcc, -1, v252
    s_cbranch_vccz L_adaLN_cond__spectral_gfnet__glu_gated_bilinear__prompt_kernel_hhr_123_x
    s_add_u32 s97, s97, 1
    s_cmp_lt_u32 s97, s96
    s_cbranch_scc1 L_adaLN_cond__spectral_gfnet__glu_gated_bilinear__prompt_kernel_hhr_123
    s_mov_b32 s96, 0
L_adaLN_cond__spectral_gfnet__glu_gated_bilinear__prompt_kernel_hhr_123_x:
L_adaLN_cond__spectral_gfnet__glu_gated_bilinear__prompt_kernel_ok_122:
    s_mov_b32 s28, 8192
    buffer_load_dwordx4 v[88:91], v240, s[16:19], s28 offen offset:3072 sc1
    s_mov_b32 s28, 122880
    buffer_load_dwordx4 v[92:95], v240, s[16:19], s28 offen offset:3072 sc1
    v_mfma_f32_32x32x16_bf16 v[0:15], v[64:67], v[192:195], v[0:15]
    v_mfma_f32_32x32x16_bf16 v[16:31], v[64:67], v[196:199], v[16:31]
    v_mfma_f32_32x32x16_bf16 v[32:47], v[68:71], v[192:195], v[32:47]
    v_mfma_f32_32x32x16_bf16 v[48:63], v[68:71], v[196:199], v[48:63]
    s_waitcnt vmcnt(4)
    v_max3_u32 v252, v72, v73, v74
    v_max3_u32 v253, v75, v76, v77
    v_max3_u32 v252, v252, v78, v79
    v_max_u32 v252, v252, v253
    v_cmp_eq_u32 vcc, -1, v252
    s_cbranch_vccz L_adaLN_cond__spectral_gfnet__glu_gated_bilinear__prompt_kernel_ok_124
    s_mov_b32 s97, 0
L_adaLN_cond__spectral_gfnet__glu_gated_bilinear__prompt_kernel_hhr_125:
    s_mov_b32 s28, 8192
    buffer_load_dwordx4 v[72:75], v240, s[16:19], s28 offen offset:1024 sc1
    s_mov_b32 s28, 122880
    buffer_load_dwordx4 v[76:79], v240, s[16:19], s28 offen offset:1024 sc1
    s_waitcnt vmcnt(0)
    v_max3_u32 v252, v72, v73, v74
    v_max3_u32 v253, v75, v76, v77
    v_max3_u32 v252, v252, v78, v79
    v_max_u32 v252, v252, v253
    v_cmp_eq_u32 vcc, -1, v252
    s_cbranch_vccz L_adaLN_cond__spectral_gfnet__glu_gated_bilinear__prompt_kernel_hhr_125_x
    s_add_u32 s97, s97, 1
    s_cmp_lt_u32 s97, s96
    s_cbranch_scc1 L_adaLN_cond__spectral_gfnet__glu_gated_bilinear__prompt_kernel_hhr_125
    s_mov_b32 s96, 0
L_adaLN_cond__spectral_gfnet__glu_gated_bilinear__prompt_kernel_hhr_125_x:
L_adaLN_cond__spectral_gfnet__glu_gated_bilinear__prompt_kernel_ok_124:
    s_mov_b32 s28, 12288
    buffer_load_dwordx4 v[64:67], v240, s[16:19], s28 offen offset:0 sc1
    s_mov_b32 s28, 126976
    buffer_load_dwordx4 v[68:71], v240, s[16:19], s28 offen offset:0 sc1
    v_mfma_f32_32x32x16_bf16 v[0:15], v[72:75], v[200:203], v[0:15]
    v_mfma_f32_32x32x16_bf16 v[16:31], v[72:75], v[204:207], v[16:31]
    v_mfma_f32_32x32x16_bf16 v[32:47], v[76:79], v[200:203], v[32:47]
    v_mfma_f32_32x32x16_bf16 v[48:63], v[76:79], v[204:207], v[48:63]
    s_waitcnt vmcnt(4)
    v_max3_u32 v252, v80, v81, v82
    v_max3_u32 v253, v83, v84, v85
    v_max3_u32 v252, v252, v86, v87
    v_max_u32 v252, v252, v253
    v_cmp_eq_u32 vcc, -1, v252
    s_cbranch_vccz L_adaLN_cond__spectral_gfnet__glu_gated_bilinear__prompt_kernel_ok_126
    s_mov_b32 s97, 0
L_adaLN_cond__spectral_gfnet__glu_gated_bilinear__prompt_kernel_hhr_127:
    s_mov_b32 s28, 8192
    buffer_load_dwordx4 v[80:83], v240, s[16:19], s28 offen offset:2048 sc1
    s_mov_b32 s28, 122880
    buffer_load_dwordx4 v[84:87], v240, s[16:19], s28 offen offset:2048 sc1
    s_waitcnt vmcnt(0)
    v_max3_u32 v252, v80, v81, v82
    v_max3_u32 v253, v83, v84, v85
    v_max3_u32 v252, v252, v86, v87
    v_max_u32 v252, v252, v253
    v_cmp_eq_u32 vcc, -1, v252
    s_cbranch_vccz L_adaLN_cond__spectral_gfnet__glu_gated_bilinear__prompt_kernel_hhr_127_x
    s_add_u32 s97, s97, 1
    s_cmp_lt_u32 s97, s96
    s_cbranch_scc1 L_adaLN_cond__spectral_gfnet__glu_gated_bilinear__prompt_kernel_hhr_127
    s_mov_b32 s96, 0
L_adaLN_cond__spectral_gfnet__glu_gated_bilinear__prompt_kernel_hhr_127_x:
L_adaLN_cond__spectral_gfnet__glu_gated_bilinear__prompt_kernel_ok_126:
    s_mov_b32 s28, 12288
    buffer_load_dwordx4 v[72:75], v240, s[16:19], s28 offen offset:1024 sc1
    s_mov_b32 s28, 126976
    buffer_load_dwordx4 v[76:79], v240, s[16:19], s28 offen offset:1024 sc1
    v_mfma_f32_32x32x16_bf16 v[0:15], v[80:83], v[208:211], v[0:15]
    v_mfma_f32_32x32x16_bf16 v[16:31], v[80:83], v[212:215], v[16:31]
    v_mfma_f32_32x32x16_bf16 v[32:47], v[84:87], v[208:211], v[32:47]
    v_mfma_f32_32x32x16_bf16 v[48:63], v[84:87], v[212:215], v[48:63]
    s_waitcnt vmcnt(4)
    v_max3_u32 v252, v88, v89, v90
    v_max3_u32 v253, v91, v92, v93
    v_max3_u32 v252, v252, v94, v95
    v_max_u32 v252, v252, v253
    v_cmp_eq_u32 vcc, -1, v252
    s_cbranch_vccz L_adaLN_cond__spectral_gfnet__glu_gated_bilinear__prompt_kernel_ok_128
    s_mov_b32 s97, 0
L_adaLN_cond__spectral_gfnet__glu_gated_bilinear__prompt_kernel_hhr_129:
    s_mov_b32 s28, 8192
    buffer_load_dwordx4 v[88:91], v240, s[16:19], s28 offen offset:3072 sc1
    s_mov_b32 s28, 122880
    buffer_load_dwordx4 v[92:95], v240, s[16:19], s28 offen offset:3072 sc1
    s_waitcnt vmcnt(0)
    v_max3_u32 v252, v88, v89, v90
    v_max3_u32 v253, v91, v92, v93
    v_max3_u32 v252, v252, v94, v95
    v_max_u32 v252, v252, v253
    v_cmp_eq_u32 vcc, -1, v252
    s_cbranch_vccz L_adaLN_cond__spectral_gfnet__glu_gated_bilinear__prompt_kernel_hhr_129_x
    s_add_u32 s97, s97, 1
    s_cmp_lt_u32 s97, s96
    s_cbranch_scc1 L_adaLN_cond__spectral_gfnet__glu_gated_bilinear__prompt_kernel_hhr_129
    s_mov_b32 s96, 0
L_adaLN_cond__spectral_gfnet__glu_gated_bilinear__prompt_kernel_hhr_129_x:
L_adaLN_cond__spectral_gfnet__glu_gated_bilinear__prompt_kernel_ok_128:
    v_mfma_f32_32x32x16_bf16 v[0:15], v[88:91], v[216:219], v[0:15]
    v_mfma_f32_32x32x16_bf16 v[16:31], v[88:91], v[220:223], v[16:31]
    v_mfma_f32_32x32x16_bf16 v[32:47], v[92:95], v[216:219], v[32:47]
    v_mfma_f32_32x32x16_bf16 v[48:63], v[92:95], v[220:223], v[48:63]
    s_waitcnt vmcnt(2)
    v_max3_u32 v252, v64, v65, v66
    v_max3_u32 v253, v67, v68, v69
    v_max3_u32 v252, v252, v70, v71
    v_max_u32 v252, v252, v253
    v_cmp_eq_u32 vcc, -1, v252
    s_cbranch_vccz L_adaLN_cond__spectral_gfnet__glu_gated_bilinear__prompt_kernel_ok_130
    s_mov_b32 s97, 0
L_adaLN_cond__spectral_gfnet__glu_gated_bilinear__prompt_kernel_hhr_131:
    s_mov_b32 s28, 12288
    buffer_load_dwordx4 v[64:67], v240, s[16:19], s28 offen offset:0 sc1
    s_mov_b32 s28, 126976
    buffer_load_dwordx4 v[68:71], v240, s[16:19], s28 offen offset:0 sc1
    s_waitcnt vmcnt(0)
    v_max3_u32 v252, v64, v65, v66
    v_max3_u32 v253, v67, v68, v69
    v_max3_u32 v252, v252, v70, v71
    v_max_u32 v252, v252, v253
    v_cmp_eq_u32 vcc, -1, v252
    s_cbranch_vccz L_adaLN_cond__spectral_gfnet__glu_gated_bilinear__prompt_kernel_hhr_131_x
    s_add_u32 s97, s97, 1
    s_cmp_lt_u32 s97, s96
    s_cbranch_scc1 L_adaLN_cond__spectral_gfnet__glu_gated_bilinear__prompt_kernel_hhr_131
    s_mov_b32 s96, 0
L_adaLN_cond__spectral_gfnet__glu_gated_bilinear__prompt_kernel_hhr_131_x:
L_adaLN_cond__spectral_gfnet__glu_gated_bilinear__prompt_kernel_ok_130:
    v_mfma_f32_32x32x16_bf16 v[0:15], v[64:67], v[224:227], v[0:15]
    v_mfma_f32_32x32x16_bf16 v[16:31], v[64:67], v[228:231], v[16:31]
    v_mfma_f32_32x32x16_bf16 v[32:47], v[68:71], v[224:227], v[32:47]
    v_mfma_f32_32x32x16_bf16 v[48:63], v[68:71], v[228:231], v[48:63]
    s_waitcnt vmcnt(0)
    v_max3_u32 v252, v72, v73, v74
    v_max3_u32 v253, v75, v76, v77
    v_max3_u32 v252, v252, v78, v79
    v_max_u32 v252, v252, v253
    v_cmp_eq_u32 vcc, -1, v252
    s_cbranch_vccz L_adaLN_cond__spectral_gfnet__glu_gated_bilinear__prompt_kernel_ok_132
    s_mov_b32 s97, 0
L_adaLN_cond__spectral_gfnet__glu_gated_bilinear__prompt_kernel_hhr_133:
    s_mov_b32 s28, 12288
    buffer_load_dwordx4 v[72:75], v240, s[16:19], s28 offen offset:1024 sc1
    s_mov_b32 s28, 126976
    buffer_load_dwordx4 v[76:79], v240, s[16:19], s28 offen offset:1024 sc1
    s_waitcnt vmcnt(0)
    v_max3_u32 v252, v72, v73, v74
    v_max3_u32 v253, v75, v76, v77
    v_max3_u32 v252, v252, v78, v79
    v_max_u32 v252, v252, v253
    v_cmp_eq_u32 vcc, -1, v252
    s_cbranch_vccz L_adaLN_cond__spectral_gfnet__glu_gated_bilinear__prompt_kernel_hhr_133_x
    s_add_u32 s97, s97, 1
    s_cmp_lt_u32 s97, s96
    s_cbranch_scc1 L_adaLN_cond__spectral_gfnet__glu_gated_bilinear__prompt_kernel_hhr_133
    s_mov_b32 s96, 0
L_adaLN_cond__spectral_gfnet__glu_gated_bilinear__prompt_kernel_hhr_133_x:
L_adaLN_cond__spectral_gfnet__glu_gated_bilinear__prompt_kernel_ok_132:
    v_mfma_f32_32x32x16_bf16 v[0:15], v[72:75], v[232:235], v[0:15]
    v_mfma_f32_32x32x16_bf16 v[16:31], v[72:75], v[236:239], v[16:31]
    v_mfma_f32_32x32x16_bf16 v[32:47], v[76:79], v[232:235], v[32:47]
    v_mfma_f32_32x32x16_bf16 v[48:63], v[76:79], v[236:239], v[48:63]
    s_mul_i32 s25, s10, 16640
    s_mov_b32 m0, s25
    s_nop 7
    ds_write_addtid_b32 v0 offset:0
    ds_write_addtid_b32 v1 offset:8320
    ds_write_addtid_b32 v2 offset:256
    ds_write_addtid_b32 v3 offset:8576
    ds_write_addtid_b32 v4 offset:512
    ds_write_addtid_b32 v5 offset:8832
    ds_write_addtid_b32 v6 offset:768
    ds_write_addtid_b32 v7 offset:9088
    ds_write_addtid_b32 v8 offset:1024
    ds_write_addtid_b32 v9 offset:9344
    ds_write_addtid_b32 v10 offset:1280
    ds_write_addtid_b32 v11 offset:9600
    ds_write_addtid_b32 v12 offset:1536
    ds_write_addtid_b32 v13 offset:9856
    ds_write_addtid_b32 v14 offset:1792
    ds_write_addtid_b32 v15 offset:10112
    ds_write_addtid_b32 v16 offset:2048
    ds_write_addtid_b32 v17 offset:10368
    ds_write_addtid_b32 v18 offset:2304
    ds_write_addtid_b32 v19 offset:10624
    ds_write_addtid_b32 v20 offset:2560
    ds_write_addtid_b32 v21 offset:10880
    ds_write_addtid_b32 v22 offset:2816
    ds_write_addtid_b32 v23 offset:11136
    ds_write_addtid_b32 v24 offset:3072
    ds_write_addtid_b32 v25 offset:11392
    ds_write_addtid_b32 v26 offset:3328
    ds_write_addtid_b32 v27 offset:11648
    ds_write_addtid_b32 v28 offset:3584
    ds_write_addtid_b32 v29 offset:11904
    ds_write_addtid_b32 v30 offset:3840
    ds_write_addtid_b32 v31 offset:12160
    ds_write_addtid_b32 v32 offset:4096
    ds_write_addtid_b32 v33 offset:12416
    ds_write_addtid_b32 v34 offset:4352
    ds_write_addtid_b32 v35 offset:12672
    ds_write_addtid_b32 v36 offset:4608
    ds_write_addtid_b32 v37 offset:12928
    ds_write_addtid_b32 v38 offset:4864
    ds_write_addtid_b32 v39 offset:13184
    ds_write_addtid_b32 v40 offset:5120
    ds_write_addtid_b32 v41 offset:13440
    ds_write_addtid_b32 v42 offset:5376
    ds_write_addtid_b32 v43 offset:13696
    ds_write_addtid_b32 v44 offset:5632
    ds_write_addtid_b32 v45 offset:13952
    ds_write_addtid_b32 v46 offset:5888
    ds_write_addtid_b32 v47 offset:14208
    ds_write_addtid_b32 v48 offset:6144
    ds_write_addtid_b32 v49 offset:14464
    ds_write_addtid_b32 v50 offset:6400
    ds_write_addtid_b32 v51 offset:14720
    ds_write_addtid_b32 v52 offset:6656
    ds_write_addtid_b32 v53 offset:14976
    ds_write_addtid_b32 v54 offset:6912
    ds_write_addtid_b32 v55 offset:15232
    ds_write_addtid_b32 v56 offset:7168
    ds_write_addtid_b32 v57 offset:15488
    ds_write_addtid_b32 v58 offset:7424
    ds_write_addtid_b32 v59 offset:15744
    ds_write_addtid_b32 v60 offset:7680
    ds_write_addtid_b32 v61 offset:16000
    ds_write_addtid_b32 v62 offset:7936
    ds_write_addtid_b32 v63 offset:16256
    v_and_b32 v72, 15, v241
    v_lshrrev_b32 v73, 4, v241
    v_lshrrev_b32 v74, 3, v72
    v_lshlrev_b32 v74, 11, v74
    v_and_b32 v75, 7, v72
    v_lshlrev_b32 v75, 4, v75
    v_add_u32 v74, v74, v75
    v_lshrrev_b32 v75, 3, v73
    v_lshlrev_b32 v75, 9, v75
    v_add_u32 v74, v74, v75
    v_bfe_u32 v75, v73, 2, 1
    v_lshlrev_b32 v75, 7, v75
    v_add_u32 v74, v74, v75
    v_bfe_u32 v75, v73, 1, 1
    v_lshlrev_b32 v75, 8, v75
    v_add_u32 v74, v74, v75
    v_and_b32 v75, 1, v73
    v_mul_u32_u24 v75, 8320, v75
    v_add_u32 v74, v74, v75
    v_add_u32 v75, 65536, v74
    s_lshl_b32 s25, s38, 10
    s_lshl_b32 s26, s39, 7
    s_add_u32 s25, s25, s26
    v_lshlrev_b32 v76, 15, v73
    v_lshlrev_b32 v77, 3, v72
    v_add_u32 v76, v76, v77
    v_add_u32 v76, s25, v76
    v_add_u32 v77, 1048576, v76
    s_waitcnt vmcnt(0)
    v_xor_b32 v252, s3, v249
    v_xor_b32 v253, s3, v251
    v_or_b32 v252, v252, v253
    v_cmp_ne_u32 vcc, 0, v252
    s_cbranch_vccz L_adaLN_cond__spectral_gfnet__glu_gated_bilinear__prompt_kernel_ok_134
    s_mov_b32 s97, 0
L_adaLN_cond__spectral_gfnet__glu_gated_bilinear__prompt_kernel_gbr_135:
    global_load_dwordx4 v[248:251], v255, s[6:7] sc1
    s_waitcnt vmcnt(0)
    v_xor_b32 v252, s3, v249
    v_xor_b32 v253, s3, v251
    v_or_b32 v252, v252, v253
    v_cmp_ne_u32 vcc, 0, v252
    s_cbranch_vccz L_adaLN_cond__spectral_gfnet__glu_gated_bilinear__prompt_kernel_gbr_135_x
    s_add_u32 s97, s97, 1
    s_cmp_lt_u32 s97, s96
    s_cbranch_scc1 L_adaLN_cond__spectral_gfnet__glu_gated_bilinear__prompt_kernel_gbr_135
    s_mov_b32 s96, 0
L_adaLN_cond__spectral_gfnet__glu_gated_bilinear__prompt_kernel_gbr_135_x:
L_adaLN_cond__spectral_gfnet__glu_gated_bilinear__prompt_kernel_ok_134:
    v_and_b32 v251, 0xffff0000, v250
    v_lshlrev_b32 v250, 16, v250
    v_and_b32 v249, 0xffff0000, v248
    v_lshlrev_b32 v248, 16, v248
    s_waitcnt lgkmcnt(0)
    s_barrier
    ds_read_b128 v[80:83], v74 offset:0
    ds_read_b128 v[84:87], v74 offset:16640
    ds_read_b128 v[88:91], v74 offset:33280
    ds_read_b128 v[92:95], v74 offset:49920
    ds_read_b128 v[96:99], v75 offset:1024
    ds_read_b128 v[100:103], v75 offset:17664
    ds_read_b128 v[104:107], v75 offset:34304
    ds_read_b128 v[108:111], v75 offset:50944
    ds_read_b128 v[112:115], v74 offset:4096
    ds_read_b128 v[116:119], v74 offset:20736
    ds_read_b128 v[120:123], v74 offset:37376
    ds_read_b128 v[124:127], v74 offset:54016
    ds_read_b128 v[128:131], v75 offset:5120
    ds_read_b128 v[132:135], v75 offset:21760
    ds_read_b128 v[136:139], v75 offset:38400
    ds_read_b128 v[140:143], v75 offset:55040
    s_waitcnt lgkmcnt(8)
    v_pk_add_f32 v[80:81], v[80:81], v[84:85]
    v_pk_add_f32 v[82:83], v[82:83], v[86:87]
    v_pk_add_f32 v[88:89], v[88:89], v[92:93]
    v_pk_add_f32 v[90:91], v[90:91], v[94:95]
    v_pk_add_f32 v[96:97], v[96:97], v[100:101]
    v_pk_add_f32 v[98:99], v[98:99], v[102:103]
    v_pk_add_f32 v[104:105], v[104:105], v[108:109]
    v_pk_add_f32 v[106:107], v[106:107], v[110:111]
    v_pk_add_f32 v[80:81], v[80:81], v[88:89]
    v_pk_add_f32 v[82:83], v[82:83], v[90:91]
    v_pk_add_f32 v[96:97], v[96:97], v[104:105]
    v_pk_add_f32 v[98:99], v[98:99], v[106:107]
    v_pk_add_f32 v[80:81], v[80:81], v[96:97]
    v_pk_add_f32 v[82:83], v[82:83], v[98:99]
    v_lshlrev_b32 v64, 16, v244
    v_and_b32 v65, 0xffff0000, v244
    v_lshlrev_b32 v66, 16, v245
    v_and_b32 v67, 0xffff0000, v245
    v_pk_fma_f32 v[64:65], v[80:81], v[248:249], v[64:65]
    v_pk_fma_f32 v[66:67], v[82:83], v[250:251], v[66:67]
    v_cvt_pk_bf16_f32 v68, v64, v65
    v_cvt_pk_bf16_f32 v69, v66, v67
    global_store_dwordx2 v76, v[68:69], s[8:9] sc1
    s_waitcnt lgkmcnt(0)
    v_pk_add_f32 v[112:113], v[112:113], v[116:117]
    v_pk_add_f32 v[114:115], v[114:115], v[118:119]
    v_pk_add_f32 v[120:121], v[120:121], v[124:125]
    v_pk_add_f32 v[122:123], v[122:123], v[126:127]
    v_pk_add_f32 v[128:129], v[128:129], v[132:133]
    v_pk_add_f32 v[130:131], v[130:131], v[134:135]
    v_pk_add_f32 v[136:137], v[136:137], v[140:141]
    v_pk_add_f32 v[138:139], v[138:139], v[142:143]
    v_pk_add_f32 v[112:113], v[112:113], v[120:121]
    v_pk_add_f32 v[114:115], v[114:115], v[122:123]
    v_pk_add_f32 v[128:129], v[128:129], v[136:137]
    v_pk_add_f32 v[130:131], v[130:131], v[138:139]
    v_pk_add_f32 v[112:113], v[112:113], v[128:129]
    v_pk_add_f32 v[114:115], v[114:115], v[130:131]
    v_lshlrev_b32 v64, 16, v246
    v_and_b32 v65, 0xffff0000, v246
    v_lshlrev_b32 v66, 16, v247
    v_and_b32 v67, 0xffff0000, v247
    v_pk_fma_f32 v[64:65], v[112:113], v[248:249], v[64:65]
    v_pk_fma_f32 v[66:67], v[114:115], v[250:251], v[66:67]
    v_cvt_pk_bf16_f32 v70, v64, v65
    v_cvt_pk_bf16_f32 v71, v66, v67
    global_store_dwordx2 v77, v[70:71], s[8:9] sc1
    s_branch L_fin
L_adaLN_cond__spectral_gfnet__glu_gated_bilinear__prompt_kernel_rm5_94:
    s_waitcnt vmcnt(0)
    s_barrier
    s_lshl_b32 s25, s2, 7
    s_add_u32 s29, s25, 262144
    s_cmp_lg_u32 s10, 0
    s_cbranch_scc1 L_adaLN_cond__spectral_gfnet__glu_gated_bilinear__prompt_kernel_fs_136
    v_mov_b32 v24, s29
    v_mov_b32 v25, s3
    s_mov_b64 exec, 1
    global_store_dword v24, v25, s[6:7] sc1
    s_mov_b64 exec, -1
L_adaLN_cond__spectral_gfnet__glu_gated_bilinear__prompt_kernel_fs_136:
    s_mul_i32 s25, s39, 112
    s_mul_i32 s26, s10, 14
    s_add_u32 s25, s25, s26
    s_lshl_b32 s25, s25, 11
    s_add_u32 s25, s25, 20971520
    s_add_u32 s12, s6, s25
    s_addc_u32 s13, s7, 0
    s_mov_b32 s14, 28672
    s_mov_b32 s15, 0x20000
    v_lshlrev_b32 v3, 4, v1
    s_cmp_ge_u32 s10, 4
    s_cbranch_scc1 L_adaLN_cond__spectral_gfnet__glu_gated_bilinear__prompt_kernel_wv_137
    s_mul_i32 s25, s2, 229376
    s_and_b32 s26, s10, 3
    s_mul_i32 s26, s26, 57344
    s_add_u32 s25, s25, s26
    s_add_u32 s25, s25, 25165824
    v_lshlrev_b32 v12, 4, v1
    v_add_u32 v12, s25, v12
    v_mov_b32 v8, -1
    v_mov_b32 v9, -1
    v_mov_b32 v10, -1
    v_mov_b32 v11, -1
    s_add_u32 s22, s6, 0
    s_addc_u32 s23, s7, 0
    global_store_dwordx4 v12, v[8:11], s[22:23] offset:0 sc1
    global_store_dwordx4 v12, v[8:11], s[22:23] offset:1024 sc1
    global_store_dwordx4 v12, v[8:11], s[22:23] offset:2048 sc1
    global_store_dwordx4 v12, v[8:11], s[22:23] offset:3072 sc1
    s_add_u32 s22, s6, 4096
    s_addc_u32 s23, s7, 0
    global_store_dwordx4 v12, v[8:11], s[22:23] offset:0 sc1
    global_store_dwordx4 v12, v[8:11], s[22:23] offset:1024 sc1
    global_store_dwordx4 v12, v[8:11], s[22:23] offset:2048 sc1
    global_store_dwordx4 v12, v[8:11], s[22:23] offset:3072 sc1
    s_add_u32 s22, s6, 8192
    s_addc_u32 s23, s7, 0
    global_store_dwordx4 v12, v[8:11], s[22:23] offset:0 sc1
    global_store_dwordx4 v12, v[8:11], s[22:23] offset:1024 sc1
    global_store_dwordx4 v12, v[8:11], s[22:23] offset:2048 sc1
    global_store_dwordx4 v12, v[8:11], s[22:23] offset:3072 sc1
    s_add_u32 s22, s6, 12288
    s_addc_u32 s23, s7, 0
    global_store_dwordx4 v12, v[8:11], s[22:23] offset:0 sc1
    global_store_dwordx4 v12, v[8:11], s[22:23] offset:1024 sc1
    global_store_dwordx4 v12, v[8:11], s[22:23] offset:2048 sc1
    global_store_dwordx4 v12, v[8:11], s[22:23] offset:3072 sc1
    s_add_u32 s22, s6, 16384
    s_addc_u32 s23, s7, 0
    global_store_dwordx4 v12, v[8:11], s[22:23] offset:0 sc1
    global_store_dwordx4 v12, v[8:11], s[22:23] offset:1024 sc1
    global_store_dwordx4 v12, v[8:11], s[22:23] offset:2048 sc1
    global_store_dwordx4 v12, v[8:11], s[22:23] offset:3072 sc1
    s_add_u32 s22, s6, 20480
    s_addc_u32 s23, s7, 0
    global_store_dwordx4 v12, v[8:11], s[22:23] offset:0 sc1
    global_store_dwordx4 v12, v[8:11], s[22:23] offset:1024 sc1
    global_store_dwordx4 v12, v[8:11], s[22:23] offset:2048 sc1
    global_store_dwordx4 v12, v[8:11], s[22:23] offset:3072 sc1
    s_add_u32 s22, s6, 24576
    s_addc_u32 s23, s7, 0
    global_store_dwordx4 v12, v[8:11], s[22:23] offset:0 sc1
    global_store_dwordx4 v12, v[8:11], s[22:23] offset:1024 sc1
    global_store_dwordx4 v12, v[8:11], s[22:23] offset:2048 sc1
    global_store_dwordx4 v12, v[8:11], s[22:23] offset:3072 sc1
    s_add_u32 s22, s6, 28672
    s_addc_u32 s23, s7, 0
    global_store_dwordx4 v12, v[8:11], s[22:23] offset:0 sc1
    global_store_dwordx4 v12, v[8:11], s[22:23] offset:1024 sc1
    global_store_dwordx4 v12, v[8:11], s[22:23] offset:2048 sc1
    global_store_dwordx4 v12, v[8:11], s[22:23] offset:3072 sc1
    s_add_u32 s22, s6, 32768
    s_addc_u32 s23, s7, 0
    global_store_dwordx4 v12, v[8:11], s[22:23] offset:0 sc1
    global_store_dwordx4 v12, v[8:11], s[22:23] offset:1024 sc1
    global_store_dwordx4 v12, v[8:11], s[22:23] offset:2048 sc1
    global_store_dwordx4 v12, v[8:11], s[22:23] offset:3072 sc1
    s_add_u32 s22, s6, 36864
    s_addc_u32 s23, s7, 0
    global_store_dwordx4 v12, v[8:11], s[22:23] offset:0 sc1
    global_store_dwordx4 v12, v[8:11], s[22:23] offset:1024 sc1
    global_store_dwordx4 v12, v[8:11], s[22:23] offset:2048 sc1
    global_store_dwordx4 v12, v[8:11], s[22:23] offset:3072 sc1
    s_add_u32 s22, s6, 40960
    s_addc_u32 s23, s7, 0
    global_store_dwordx4 v12, v[8:11], s[22:23] offset:0 sc1
    global_store_dwordx4 v12, v[8:11], s[22:23] offset:1024 sc1
    global_store_dwordx4 v12, v[8:11], s[22:23] offset:2048 sc1
    global_store_dwordx4 v12, v[8:11], s[22:23] offset:3072 sc1
    s_add_u32 s22, s6, 45056
    s_addc_u32 s23, s7, 0
    global_store_dwordx4 v12, v[8:11], s[22:23] offset:0 sc1
    global_store_dwordx4 v12, v[8:11], s[22:23] offset:1024 sc1
    global_store_dwordx4 v12, v[8:11], s[22:23] offset:2048 sc1
    global_store_dwordx4 v12, v[8:11], s[22:23] offset:3072 sc1
    s_add_u32 s22, s6, 49152
    s_addc_u32 s23, s7, 0
    global_store_dwordx4 v12, v[8:11], s[22:23] offset:0 sc1
    global_store_dwordx4 v12, v[8:11], s[22:23] offset:1024 sc1
    global_store_dwordx4 v12, v[8:11], s[22:23] offset:2048 sc1
    global_store_dwordx4 v12, v[8:11], s[22:23] offset:3072 sc1
    s_add_u32 s22, s6, 53248
    s_addc_u32 s23, s7, 0
    global_store_dwordx4 v12, v[8:11], s[22:23] offset:0 sc1
    global_store_dwordx4 v12, v[8:11], s[22:23] offset:1024 sc1
    global_store_dwordx4 v12, v[8:11], s[22:23] offset:2048 sc1
    global_store_dwordx4 v12, v[8:11], s[22:23] offset:3072 sc1
    s_waitcnt vmcnt(0)
    v_mov_b32 v14, 163168
    v_mov_b32 v15, 1
    s_mov_b64 exec, 1
    ds_add_rtn_u32 v16, v14, v15
    s_lshl_b32 s16, s2, 7
    s_add_u32 s16, s16, 327680
    v_mov_b32 v14, s16
    v_mov_b32 v15, s3
    s_waitcnt lgkmcnt(0)
    v_cmp_eq_u32 vcc, 3, v16
    s_cbranch_vccz L_adaLN_cond__spectral_gfnet__glu_gated_bilinear__prompt_kernel_sf_138
    global_store_dword v14, v15, s[6:7] sc1
L_adaLN_cond__spectral_gfnet__glu_gated_bilinear__prompt_kernel_sf_138:
    s_mov_b64 exec, -1
    s_mov_b32 s28, 0
    buffer_load_dwordx4 v[128:131], v3, s[12:15], s28 offen offset:0 sc1
    s_mov_b32 s28, 0
    buffer_load_dwordx4 v[132:135], v3, s[12:15], s28 offen offset:1024 sc1
    s_mov_b32 s28, 0
    buffer_load_dwordx4 v[136:139], v3, s[12:15], s28 offen offset:2048 sc1
    s_mov_b32 s28, 0
    buffer_load_dwordx4 v[140:143], v3, s[12:15], s28 offen offset:3072 sc1
    s_mov_b32 s28, 4096
    buffer_load_dwordx4 v[144:147], v3, s[12:15], s28 offen offset:0 sc1
    s_mov_b32 s28, 4096
    buffer_load_dwordx4 v[148:151], v3, s[12:15], s28 offen offset:1024 sc1
    s_mov_b32 s28, 4096
    buffer_load_dwordx4 v[152:155], v3, s[12:15], s28 offen offset:2048 sc1
    s_mov_b32 s28, 4096
    buffer_load_dwordx4 v[156:159], v3, s[12:15], s28 offen offset:3072 sc1
    s_mov_b32 s28, 8192
    buffer_load_dwordx4 v[160:163], v3, s[12:15], s28 offen offset:0 sc1
    s_mov_b32 s28, 8192
    buffer_load_dwordx4 v[164:167], v3, s[12:15], s28 offen offset:1024 sc1
    s_mov_b32 s28, 8192
    buffer_load_dwordx4 v[168:171], v3, s[12:15], s28 offen offset:2048 sc1
    s_mov_b32 s28, 8192
    buffer_load_dwordx4 v[172:175], v3, s[12:15], s28 offen offset:3072 sc1
    s_mov_b32 s28, 12288
    buffer_load_dwordx4 v[176:179], v3, s[12:15], s28 offen offset:0 sc1
    s_mov_b32 s28, 12288
    buffer_load_dwordx4 v[180:183], v3, s[12:15], s28 offen offset:1024 sc1
    s_mov_b32 s28, 12288
    buffer_load_dwordx4 v[184:187], v3, s[12:15], s28 offen offset:2048 sc1
    s_mov_b32 s28, 12288
    buffer_load_dwordx4 v[188:191], v3, s[12:15], s28 offen offset:3072 sc1
    s_mov_b32 s28, 16384
    buffer_load_dwordx4 v[192:195], v3, s[12:15], s28 offen offset:0 sc1
    s_mov_b32 s28, 16384
    buffer_load_dwordx4 v[196:199], v3, s[12:15], s28 offen offset:1024 sc1
    s_mov_b32 s28, 16384
    buffer_load_dwordx4 v[200:203], v3, s[12:15], s28 offen offset:2048 sc1
    s_mov_b32 s28, 16384
    buffer_load_dwordx4 v[204:207], v3, s[12:15], s28 offen offset:3072 sc1
    s_mov_b32 s28, 20480
    buffer_load_dwordx4 v[208:211], v3, s[12:15], s28 offen offset:0 sc1
    s_mov_b32 s28, 20480
    buffer_load_dwordx4 v[212:215], v3, s[12:15], s28 offen offset:1024 sc1
    s_mov_b32 s28, 20480
    buffer_load_dwordx4 v[216:219], v3, s[12:15], s28 offen offset:2048 sc1
    s_mov_b32 s28, 20480
    buffer_load_dwordx4 v[220:223], v3, s[12:15], s28 offen offset:3072 sc1
    s_mov_b32 s28, 24576
    buffer_load_dwordx4 v[224:227], v3, s[12:15], s28 offen offset:0 sc1
    s_mov_b32 s28, 24576
    buffer_load_dwordx4 v[228:231], v3, s[12:15], s28 offen offset:1024 sc1
    s_mov_b32 s28, 24576
    buffer_load_dwordx4 v[232:235], v3, s[12:15], s28 offen offset:2048 sc1
    s_mov_b32 s28, 24576
    buffer_load_dwordx4 v[236:239], v3, s[12:15], s28 offen offset:3072 sc1
L_adaLN_cond__spectral_gfnet__glu_gated_bilinear__prompt_kernel_wv_137:
    s_cmp_lt_u32 s10, 4
    s_cbranch_scc1 L_adaLN_cond__spectral_gfnet__glu_gated_bilinear__prompt_kernel_wv_139
    s_mov_b32 s28, 0
    buffer_load_dwordx4 v[128:131], v3, s[12:15], s28 offen offset:0 sc1
    s_mov_b32 s28, 0
    buffer_load_dwordx4 v[132:135], v3, s[12:15], s28 offen offset:1024 sc1
    s_mov_b32 s28, 0
    buffer_load_dwordx4 v[136:139], v3, s[12:15], s28 offen offset:2048 sc1
    s_mov_b32 s28, 0
    buffer_load_dwordx4 v[140:143], v3, s[12:15], s28 offen offset:3072 sc1
    s_mov_b32 s28, 4096
    buffer_load_dwordx4 v[144:147], v3, s[12:15], s28 offen offset:0 sc1
    s_mov_b32 s28, 4096
    buffer_load_dwordx4 v[148:151], v3, s[12:15], s28 offen offset:1024 sc1
    s_mov_b32 s28, 4096
    buffer_load_dwordx4 v[152:155], v3, s[12:15], s28 offen offset:2048 sc1
    s_mov_b32 s28, 4096
    buffer_load_dwordx4 v[156:159], v3, s[12:15], s28 offen offset:3072 sc1
    s_mov_b32 s28, 8192
    buffer_load_dwordx4 v[160:163], v3, s[12:15], s28 offen offset:0 sc1
    s_mov_b32 s28, 8192
    buffer_load_dwordx4 v[164:167], v3, s[12:15], s28 offen offset:1024 sc1
    s_mov_b32 s28, 8192
    buffer_load_dwordx4 v[168:171], v3, s[12:15], s28 offen offset:2048 sc1
    s_mov_b32 s28, 8192
    buffer_load_dwordx4 v[172:175], v3, s[12:15], s28 offen offset:3072 sc1
    s_mov_b32 s28, 12288
    buffer_load_dwordx4 v[176:179], v3, s[12:15], s28 offen offset:0 sc1
    s_mov_b32 s28, 12288
    buffer_load_dwordx4 v[180:183], v3, s[12:15], s28 offen offset:1024 sc1
    s_mov_b32 s28, 12288
    buffer_load_dwordx4 v[184:187], v3, s[12:15], s28 offen offset:2048 sc1
    s_mov_b32 s28, 12288
    buffer_load_dwordx4 v[188:191], v3, s[12:15], s28 offen offset:3072 sc1
    s_mov_b32 s28, 16384
    buffer_load_dwordx4 v[192:195], v3, s[12:15], s28 offen offset:0 sc1
    s_mov_b32 s28, 16384
    buffer_load_dwordx4 v[196:199], v3, s[12:15], s28 offen offset:1024 sc1
    s_mov_b32 s28, 16384
    buffer_load_dwordx4 v[200:203], v3, s[12:15], s28 offen offset:2048 sc1
    s_mov_b32 s28, 16384
    buffer_load_dwordx4 v[204:207], v3, s[12:15], s28 offen offset:3072 sc1
    s_mov_b32 s28, 20480
    buffer_load_dwordx4 v[208:211], v3, s[12:15], s28 offen offset:0 sc1
    s_mov_b32 s28, 20480
    buffer_load_dwordx4 v[212:215], v3, s[12:15], s28 offen offset:1024 sc1
    s_mov_b32 s28, 20480
    buffer_load_dwordx4 v[216:219], v3, s[12:15], s28 offen offset:2048 sc1
    s_mov_b32 s28, 20480
    buffer_load_dwordx4 v[220:223], v3, s[12:15], s28 offen offset:3072 sc1
    s_mov_b32 s28, 24576
    buffer_load_dwordx4 v[224:227], v3, s[12:15], s28 offen offset:0 sc1
    s_mov_b32 s28, 24576
    buffer_load_dwordx4 v[228:231], v3, s[12:15], s28 offen offset:1024 sc1
    s_mov_b32 s28, 24576
    buffer_load_dwordx4 v[232:235], v3, s[12:15], s28 offen offset:2048 sc1
    s_mov_b32 s28, 24576
    buffer_load_dwordx4 v[236:239], v3, s[12:15], s28 offen offset:3072 sc1
L_adaLN_cond__spectral_gfnet__glu_gated_bilinear__prompt_kernel_wv_139:
    v_lshlrev_b32 v240, 4, v1
    v_mov_b32 v241, v0
    s_mul_i32 s26, s10, 14
    s_mul_i32 s27, s38, 224
    s_add_u32 s27, s27, s26
    s_lshl_b32 s27, s27, 10
    s_add_u32 s27, s27, 25165824
    s_add_u32 s16, s6, s27
    s_addc_u32 s17, s7, 0
    s_mov_b32 s18, 129024
    s_mov_b32 s19, 0x20000
    v_and_b32 v252, 15, v0
    v_lshrrev_b32 v253, 4, v0
    s_lshl_b32 s25, s38, 16
    s_lshl_b32 s26, s39, 7
    s_add_u32 s25, s25, s26
    s_add_u32 s25, s25, 10485760
    v_lshlrev_b32 v242, 10, v253
    v_lshlrev_b32 v254, 3, v252
    v_add_u32 v242, v242, v254
    v_add_u32 v242, s25, v242
    v_add_u32 v243, 32768, v242
    s_lshl_b32 s26, s39, 8
    s_add_u32 s26, s26, 30720
    v_lshlrev_b32 v254, 4, v252
    v_add_u32 v255, s26, v254
    global_load_dwordx4 v[248:251], v255, s[6:7] sc1
    s_cmp_ge_u32 s10, 1
    s_cbranch_scc1 L_adaLN_cond__spectral_gfnet__glu_gated_bilinear__prompt_kernel_wv_140
    s_lshl_b32 s25, s38, 7
    s_add_u32 s26, s25, 262144
    s_add_u32 s25, s25, 327680
    v_and_b32 v30, 7, v1
    v_lshlrev_b32 v30, 12, v30
    v_add_u32 v30, s26, v30
    v_mov_b32 v29, s25
    v_cmp_gt_u32 vcc, 16, v1
    s_nop 1
    v_cndmask_b32 v29, v30, v29, vcc
    s_mov_b32 s97, 0
L_adaLN_cond__spectral_gfnet__glu_gated_bilinear__prompt_kernel_dem_141:
    global_load_dword v28, v29, s[6:7] sc1
    s_waitcnt vmcnt(0)
    v_cmp_ne_u32 vcc, s3, v28
    s_cbranch_vccz L_adaLN_cond__spectral_gfnet__glu_gated_bilinear__prompt_kernel_dem_141_x
    s_add_u32 s97, s97, 1
    s_cmp_lt_u32 s97, s96
    s_sleep 8
    s_cbranch_scc1 L_adaLN_cond__spectral_gfnet__glu_gated_bilinear__prompt_kernel_dem_141
    s_mov_b32 s96, 0
L_adaLN_cond__spectral_gfnet__glu_gated_bilinear__prompt_kernel_dem_141_x:
L_adaLN_cond__spectral_gfnet__glu_gated_bilinear__prompt_kernel_wv_140:
    s_waitcnt vmcnt(0)
    s_barrier
    s_mov_b32 s97, 0
L_adaLN_cond__spectral_gfnet__glu_gated_bilinear__prompt_kernel_hhe_142:
    s_mov_b32 s28, 0
    buffer_load_dwordx4 v[64:67], v240, s[16:19], s28 offen offset:0 sc1
    s_mov_b32 s28, 114688
    buffer_load_dwordx4 v[68:71], v240, s[16:19], s28 offen offset:0 sc1
    s_waitcnt vmcnt(0)
    v_max3_u32 v252, v64, v65, v66
    v_max3_u32 v253, v67, v68, v69
    v_max3_u32 v252, v252, v70, v71
    v_max_u32 v252, v252, v253
    v_cmp_eq_u32 vcc, -1, v252
    s_cbranch_vccz L_adaLN_cond__spectral_gfnet__glu_gated_bilinear__prompt_kernel_hhe_142_x
    s_add_u32 s97, s97, 1
    s_cmp_lt_u32 s97, s96
    s_sleep 8
    s_cbranch_scc1 L_adaLN_cond__spectral_gfnet__glu_gated_bilinear__prompt_kernel_hhe_142
    s_mov_b32 s96, 0
L_adaLN_cond__spectral_gfnet__glu_gated_bilinear__prompt_kernel_hhe_142_x:
    global_load_dwordx2 v[244:245], v242, s[6:7] sc1
    global_load_dwordx2 v[246:247], v243, s[6:7] sc1
    s_mov_b32 s28, 0
    buffer_load_dwordx4 v[64:67], v240, s[16:19], s28 offen offset:0 sc1
    s_mov_b32 s28, 114688
    buffer_load_dwordx4 v[68:71], v240, s[16:19], s28 offen offset:0 sc1
    s_mov_b32 s28, 0
    buffer_load_dwordx4 v[72:75], v240, s[16:19], s28 offen offset:1024 sc1
    s_mov_b32 s28, 114688
    buffer_load_dwordx4 v[76:79], v240, s[16:19], s28 offen offset:1024 sc1
    s_mov_b32 s28, 0
    buffer_load_dwordx4 v[80:83], v240, s[16:19], s28 offen offset:2048 sc1
    s_mov_b32 s28, 114688
    buffer_load_dwordx4 v[84:87], v240, s[16:19], s28 offen offset:2048 sc1
    s_waitcnt vmcnt(4)
    v_max3_u32 v252, v64, v65, v66
    v_max3_u32 v253, v67, v68, v69
    v_max3_u32 v252, v252, v70, v71
    v_max_u32 v252, v252, v253
    v_cmp_eq_u32 vcc, -1, v252
    s_cbranch_vccz L_adaLN_cond__spectral_gfnet__glu_gated_bilinear__prompt_kernel_ok_143
    s_mov_b32 s97, 0
L_adaLN_cond__spectral_gfnet__glu_gated_bilinear__prompt_kernel_hhr_144:
    s_mov_b32 s28, 0
    buffer_load_dwordx4 v[64:67], v240, s[16:19], s28 offen offset:0 sc1
    s_mov_b32 s28, 114688
    buffer_load_dwordx4 v[68:71], v240, s[16:19], s28 offen offset:0 sc1
    s_waitcnt vmcnt(0)
    v_max3_u32 v252, v64, v65, v66
    v_max3_u32 v253, v67, v68, v69
    v_max3_u32 v252, v252, v70, v71
    v_max_u32 v252, v252, v253
    v_cmp_eq_u32 vcc, -1, v252
    s_cbranch_vccz L_adaLN_cond__spectral_gfnet__glu_gated_bilinear__prompt_kernel_hhr_144_x
    s_add_u32 s97, s97, 1
    s_cmp_lt_u32 s97, s96
    s_cbranch_scc1 L_adaLN_cond__spectral_gfnet__glu_gated_bilinear__prompt_kernel_hhr_144
    s_mov_b32 s96, 0
L_adaLN_cond__spectral_gfnet__glu_gated_bilinear__prompt_kernel_hhr_144_x:
L_adaLN_cond__spectral_gfnet__glu_gated_bilinear__prompt_kernel_ok_143:
    s_mov_b32 s28, 0
    buffer_load_dwordx4 v[88:91], v240, s[16:19], s28 offen offset:3072 sc1
    s_mov_b32 s28, 114688
    buffer_load_dwordx4 v[92:95], v240, s[16:19], s28 offen offset:3072 sc1
    v_mfma_f32_32x32x16_bf16 v[0:15], v[64:67], v[128:131], 0
    v_mfma_f32_32x32x16_bf16 v[16:31], v[64:67], v[132:135], 0
    v_mfma_f32_32x32x16_bf16 v[32:47], v[68:71], v[128:131], 0
    v_mfma_f32_32x32x16_bf16 v[48:63], v[68:71], v[132:135], 0
    s_waitcnt vmcnt(4)
    v_max3_u32 v252, v72, v73, v74
    v_max3_u32 v253, v75, v76, v77
    v_max3_u32 v252, v252, v78, v79
    v_max_u32 v252, v252, v253
    v_cmp_eq_u32 vcc, -1, v252
    s_cbranch_vccz L_adaLN_cond__spectral_gfnet__glu_gated_bilinear__prompt_kernel_ok_145
    s_mov_b32 s97, 0
L_adaLN_cond__spectral_gfnet__glu_gated_bilinear__prompt_kernel_hhr_146:
    s_mov_b32 s28, 0
    buffer_load_dwordx4 v[72:75], v240, s[16:19], s28 offen offset:1024 sc1
    s_mov_b32 s28, 114688
    buffer_load_dwordx4 v[76:79], v240, s[16:19], s28 offen offset:1024 sc1
    s_waitcnt vmcnt(0)
    v_max3_u32 v252, v72, v73, v74
    v_max3_u32 v253, v75, v76, v77
    v_max3_u32 v252, v252, v78, v79
    v_max_u32 v252, v252, v253
    v_cmp_eq_u32 vcc, -1, v252
    s_cbranch_vccz L_adaLN_cond__spectral_gfnet__glu_gated_bilinear__prompt_kernel_hhr_146_x
    s_add_u32 s97, s97, 1
    s_cmp_lt_u32 s97, s96
    s_cbranch_scc1 L_adaLN_cond__spectral_gfnet__glu_gated_bilinear__prompt_kernel_hhr_146
    s_mov_b32 s96, 0
L_adaLN_cond__spectral_gfnet__glu_gated_bilinear__prompt_kernel_hhr_146_x:
L_adaLN_cond__spectral_gfnet__glu_gated_bilinear__prompt_kernel_ok_145:
    s_mov_b32 s28, 4096
    buffer_load_dwordx4 v[64:67], v240, s[16:19], s28 offen offset:0 sc1
    s_mov_b32 s28, 118784
    buffer_load_dwordx4 v[68:71], v240, s[16:19], s28 offen offset:0 sc1
    v_mfma_f32_32x32x16_bf16 v[0:15], v[72:75], v[136:139], v[0:15]
    v_mfma_f32_32x32x16_bf16 v[16:31], v[72:75], v[140:143], v[16:31]
    v_mfma_f32_32x32x16_bf16 v[32:47], v[76:79], v[136:139], v[32:47]
    v_mfma_f32_32x32x16_bf16 v[48:63], v[76:79], v[140:143], v[48:63]
    s_waitcnt vmcnt(4)
    v_max3_u32 v252, v80, v81, v82
    v_max3_u32 v253, v83, v84, v85
    v_max3_u32 v252, v252, v86, v87
    v_max_u32 v252, v252, v253
    v_cmp_eq_u32 vcc, -1, v252
    s_cbranch_vccz L_adaLN_cond__spectral_gfnet__glu_gated_bilinear__prompt_kernel_ok_147
    s_mov_b32 s97, 0
L_adaLN_cond__spectral_gfnet__glu_gated_bilinear__prompt_kernel_hhr_148:
    s_mov_b32 s28, 0
    buffer_load_dwordx4 v[80:83], v240, s[16:19], s28 offen offset:2048 sc1
    s_mov_b32 s28, 114688
    buffer_load_dwordx4 v[84:87], v240, s[16:19], s28 offen offset:2048 sc1
    s_waitcnt vmcnt(0)
    v_max3_u32 v252, v80, v81, v82
    v_max3_u32 v253, v83, v84, v85
    v_max3_u32 v252, v252, v86, v87
    v_max_u32 v252, v252, v253
    v_cmp_eq_u32 vcc, -1, v252
    s_cbranch_vccz L_adaLN_cond__spectral_gfnet__glu_gated_bilinear__prompt_kernel_hhr_148_x
    s_add_u32 s97, s97, 1
    s_cmp_lt_u32 s97, s96
    s_cbranch_scc1 L_adaLN_cond__spectral_gfnet__glu_gated_bilinear__prompt_kernel_hhr_148
    s_mov_b32 s96, 0
L_adaLN_cond__spectral_gfnet__glu_gated_bilinear__prompt_kernel_hhr_148_x:
L_adaLN_cond__spectral_gfnet__glu_gated_bilinear__prompt_kernel_ok_147:
    s_mov_b32 s28, 4096
    buffer_load_dwordx4 v[72:75], v240, s[16:19], s28 offen offset:1024 sc1
    s_mov_b32 s28, 118784
    buffer_load_dwordx4 v[76:79], v240, s[16:19], s28 offen offset:1024 sc1
    v_mfma_f32_32x32x16_bf16 v[0:15], v[80:83], v[144:147], v[0:15]
    v_mfma_f32_32x32x16_bf16 v[16:31], v[80:83], v[148:151], v[16:31]
    v_mfma_f32_32x32x16_bf16 v[32:47], v[84:87], v[144:147], v[32:47]
    v_mfma_f32_32x32x16_bf16 v[48:63], v[84:87], v[148:151], v[48:63]
    s_waitcnt vmcnt(4)
    v_max3_u32 v252, v88, v89, v90
    v_max3_u32 v253, v91, v92, v93
    v_max3_u32 v252, v252, v94, v95
    v_max_u32 v252, v252, v253
    v_cmp_eq_u32 vcc, -1, v252
    s_cbranch_vccz L_adaLN_cond__spectral_gfnet__glu_gated_bilinear__prompt_kernel_ok_149
    s_mov_b32 s97, 0
L_adaLN_cond__spectral_gfnet__glu_gated_bilinear__prompt_kernel_hhr_150:
    s_mov_b32 s28, 0
    buffer_load_dwordx4 v[88:91], v240, s[16:19], s28 offen offset:3072 sc1
    s_mov_b32 s28, 114688
    buffer_load_dwordx4 v[92:95], v240, s[16:19], s28 offen offset:3072 sc1
    s_waitcnt vmcnt(0)
    v_max3_u32 v252, v88, v89, v90
    v_max3_u32 v253, v91, v92, v93
    v_max3_u32 v252, v252, v94, v95
    v_max_u32 v252, v252, v253
    v_cmp_eq_u32 vcc, -1, v252
    s_cbranch_vccz L_adaLN_cond__spectral_gfnet__glu_gated_bilinear__prompt_kernel_hhr_150_x
    s_add_u32 s97, s97, 1
    s_cmp_lt_u32 s97, s96
    s_cbranch_scc1 L_adaLN_cond__spectral_gfnet__glu_gated_bilinear__prompt_kernel_hhr_150
    s_mov_b32 s96, 0
L_adaLN_cond__spectral_gfnet__glu_gated_bilinear__prompt_kernel_hhr_150_x:
L_adaLN_cond__spectral_gfnet__glu_gated_bilinear__prompt_kernel_ok_149:
    s_mov_b32 s28, 4096
    buffer_load_dwordx4 v[80:83], v240, s[16:19], s28 offen offset:2048 sc1
    s_mov_b32 s28, 118784
    buffer_load_dwordx4 v[84:87], v240, s[16:19], s28 offen offset:2048 sc1
    v_mfma_f32_32x32x16_bf16 v[0:15], v[88:91], v[152:155], v[0:15]
    v_mfma_f32_32x32x16_bf16 v[16:31], v[88:91], v[156:159], v[16:31]
    v_mfma_f32_32x32x16_bf16 v[32:47], v[92:95], v[152:155], v[32:47]
    v_mfma_f32_32x32x16_bf16 v[48:63], v[92:95], v[156:159], v[48:63]
    s_waitcnt vmcnt(4)
    v_max3_u32 v252, v64, v65, v66
    v_max3_u32 v253, v67, v68, v69
    v_max3_u32 v252, v252, v70, v71
    v_max_u32 v252, v252, v253
    v_cmp_eq_u32 vcc, -1, v252
    s_cbranch_vccz L_adaLN_cond__spectral_gfnet__glu_gated_bilinear__prompt_kernel_ok_151
    s_mov_b32 s97, 0
L_adaLN_cond__spectral_gfnet__glu_gated_bilinear__prompt_kernel_hhr_152:
    s_mov_b32 s28, 4096
    buffer_load_dwordx4 v[64:67], v240, s[16:19], s28 offen offset:0 sc1
    s_mov_b32 s28, 118784
    buffer_load_dwordx4 v[68:71], v240, s[16:19], s28 offen offset:0 sc1
    s_waitcnt vmcnt(0)
    v_max3_u32 v252, v64, v65, v66
    v_max3_u32 v253, v67, v68, v69
    v_max3_u32 v252, v252, v70, v71
    v_max_u32 v252, v252, v253
    v_cmp_eq_u32 vcc, -1, v252
    s_cbranch_vccz L_adaLN_cond__spectral_gfnet__glu_gated_bilinear__prompt_kernel_hhr_152_x
    s_add_u32 s97, s97, 1
    s_cmp_lt_u32 s97, s96
    s_cbranch_scc1 L_adaLN_cond__spectral_gfnet__glu_gated_bilinear__prompt_kernel_hhr_152
    s_mov_b32 s96, 0
L_adaLN_cond__spectral_gfnet__glu_gated_bilinear__prompt_kernel_hhr_152_x:
L_adaLN_cond__spectral_gfnet__glu_gated_bilinear__prompt_kernel_ok_151:
    s_mov_b32 s28, 4096
    buffer_load_dwordx4 v[88:91], v240, s[16:19], s28 offen offset:3072 sc1
    s_mov_b32 s28, 118784
    buffer_load_dwordx4 v[92:95], v240, s[16:19], s28 offen offset:3072 sc1
    v_mfma_f32_32x32x16_bf16 v[0:15], v[64:67], v[160:163], v[0:15]
    v_mfma_f32_32x32x16_bf16 v[16:31], v[64:67], v[164:167], v[16:31]
    v_mfma_f32_32x32x16_bf16 v[32:47], v[68:71], v[160:163], v[32:47]
    v_mfma_f32_32x32x16_bf16 v[48:63], v[68:71], v[164:167], v[48:63]
    s_waitcnt vmcnt(4)
    v_max3_u32 v252, v72, v73, v74
    v_max3_u32 v253, v75, v76, v77
    v_max3_u32 v252, v252, v78, v79
    v_max_u32 v252, v252, v253
    v_cmp_eq_u32 vcc, -1, v252
    s_cbranch_vccz L_adaLN_cond__spectral_gfnet__glu_gated_bilinear__prompt_kernel_ok_153
    s_mov_b32 s97, 0
L_adaLN_cond__spectral_gfnet__glu_gated_bilinear__prompt_kernel_hhr_154:
    s_mov_b32 s28, 4096
    buffer_load_dwordx4 v[72:75], v240, s[16:19], s28 offen offset:1024 sc1
    s_mov_b32 s28, 118784
    buffer_load_dwordx4 v[76:79], v240, s[16:19], s28 offen offset:1024 sc1
    s_waitcnt vmcnt(0)
    v_max3_u32 v252, v72, v73, v74
    v_max3_u32 v253, v75, v76, v77
    v_max3_u32 v252, v252, v78, v79
    v_max_u32 v252, v252, v253
    v_cmp_eq_u32 vcc, -1, v252
    s_cbranch_vccz L_adaLN_cond__spectral_gfnet__glu_gated_bilinear__prompt_kernel_hhr_154_x
    s_add_u32 s97, s97, 1
    s_cmp_lt_u32 s97, s96
    s_cbranch_scc1 L_adaLN_cond__spectral_gfnet__glu_gated_bilinear__prompt_kernel_hhr_154
    s_mov_b32 s96, 0
L_adaLN_cond__spectral_gfnet__glu_gated_bilinear__prompt_kernel_hhr_154_x:
L_adaLN_cond__spectral_gfnet__glu_gated_bilinear__prompt_kernel_ok_153:
    s_mov_b32 s28, 8192
    buffer_load_dwordx4 v[64:67], v240, s[16:19], s28 offen offset:0 sc1
    s_mov_b32 s28, 122880
    buffer_load_dwordx4 v[68:71], v240, s[16:19], s28 offen offset:0 sc1
    v_mfma_f32_32x32x16_bf16 v[0:15], v[72:75], v[168:171], v[0:15]
    v_mfma_f32_32x32x16_bf16 v[16:31], v[72:75], v[172:175], v[16:31]
    v_mfma_f32_32x32x16_bf16 v[32:47], v[76:79], v[168:171], v[32:47]
    v_mfma_f32_32x32x16_bf16 v[48:63], v[76:79], v[172:175], v[48:63]
    s_waitcnt vmcnt(4)
    v_max3_u32 v252, v80, v81, v82
    v_max3_u32 v253, v83, v84, v85
    v_max3_u32 v252, v252, v86, v87
    v_max_u32 v252, v252, v253
    v_cmp_eq_u32 vcc, -1, v252
    s_cbranch_vccz L_adaLN_cond__spectral_gfnet__glu_gated_bilinear__prompt_kernel_ok_155
    s_mov_b32 s97, 0
L_adaLN_cond__spectral_gfnet__glu_gated_bilinear__prompt_kernel_hhr_156:
    s_mov_b32 s28, 4096
    buffer_load_dwordx4 v[80:83], v240, s[16:19], s28 offen offset:2048 sc1
    s_mov_b32 s28, 118784
    buffer_load_dwordx4 v[84:87], v240, s[16:19], s28 offen offset:2048 sc1
    s_waitcnt vmcnt(0)
    v_max3_u32 v252, v80, v81, v82
    v_max3_u32 v253, v83, v84, v85
    v_max3_u32 v252, v252, v86, v87
    v_max_u32 v252, v252, v253
    v_cmp_eq_u32 vcc, -1, v252
    s_cbranch_vccz L_adaLN_cond__spectral_gfnet__glu_gated_bilinear__prompt_kernel_hhr_156_x
    s_add_u32 s97, s97, 1
    s_cmp_lt_u32 s97, s96
    s_cbranch_scc1 L_adaLN_cond__spectral_gfnet__glu_gated_bilinear__prompt_kernel_hhr_156
    s_mov_b32 s96, 0
L_adaLN_cond__spectral_gfnet__glu_gated_bilinear__prompt_kernel_hhr_156_x:
L_adaLN_cond__spectral_gfnet__glu_gated_bilinear__prompt_kernel_ok_155:
    s_mov_b32 s28, 8192
    buffer_load_dwordx4 v[72:75], v240, s[16:19], s28 offen offset:1024 sc1
    s_mov_b32 s28, 122880
    buffer_load_dwordx4 v[76:79], v240, s[16:19], s28 offen offset:1024 sc1
    v_mfma_f32_32x32x16_bf16 v[0:15], v[80:83], v[176:179], v[0:15]
    v_mfma_f32_32x32x16_bf16 v[16:31], v[80:83], v[180:183], v[16:31]
    v_mfma_f32_32x32x16_bf16 v[32:47], v[84:87], v[176:179], v[32:47]
    v_mfma_f32_32x32x16_bf16 v[48:63], v[84:87], v[180:183], v[48:63]
    s_waitcnt vmcnt(4)
    v_max3_u32 v252, v88, v89, v90
    v_max3_u32 v253, v91, v92, v93
    v_max3_u32 v252, v252, v94, v95
    v_max_u32 v252, v252, v253
    v_cmp_eq_u32 vcc, -1, v252
    s_cbranch_vccz L_adaLN_cond__spectral_gfnet__glu_gated_bilinear__prompt_kernel_ok_157
    s_mov_b32 s97, 0
L_adaLN_cond__spectral_gfnet__glu_gated_bilinear__prompt_kernel_hhr_158:
    s_mov_b32 s28, 4096
    buffer_load_dwordx4 v[88:91], v240, s[16:19], s28 offen offset:3072 sc1
    s_mov_b32 s28, 118784
    buffer_load_dwordx4 v[92:95], v240, s[16:19], s28 offen offset:3072 sc1
    s_waitcnt vmcnt(0)
    v_max3_u32 v252, v88, v89, v90
    v_max3_u32 v253, v91, v92, v93
    v_max3_u32 v252, v252, v94, v95
    v_max_u32 v252, v252, v253
    v_cmp_eq_u32 vcc, -1, v252
    s_cbranch_vccz L_adaLN_cond__spectral_gfnet__glu_gated_bilinear__prompt_kernel_hhr_158_x
    s_add_u32 s97, s97, 1
    s_cmp_lt_u32 s97, s96
    s_cbranch_scc1 L_adaLN_cond__spectral_gfnet__glu_gated_bilinear__prompt_kernel_hhr_158
    s_mov_b32 s96, 0
L_adaLN_cond__spectral_gfnet__glu_gated_bilinear__prompt_kernel_hhr_158_x:
L_adaLN_cond__spectral_gfnet__glu_gated_bilinear__prompt_kernel_ok_157:
    s_mov_b32 s28, 8192
    buffer_load_dwordx4 v[80:83], v240, s[16:19], s28 offen offset:2048 sc1
    s_mov_b32 s28, 122880
    buffer_load_dwordx4 v[84:87], v240, s[16:19], s28 offen offset:2048 sc1
    v_mfma_f32_32x32x16_bf16 v[0:15], v[88:91], v[184:187], v[0:15]
    v_mfma_f32_32x32x16_bf16 v[16:31], v[88:91], v[188:191], v[16:31]
    v_mfma_f32_32x32x16_bf16 v[32:47], v[92:95], v[184:187], v[32:47]
    v_mfma_f32_32x32x16_bf16 v[48:63], v[92:95], v[188:191], v[48:63]
    s_waitcnt vmcnt(4)
    v_max3_u32 v252, v64, v65, v66
    v_max3_u32 v253, v67, v68, v69
    v_max3_u32 v252, v252, v70, v71
    v_max_u32 v252, v252, v253
    v_cmp_eq_u32 vcc, -1, v252
    s_cbranch_vccz L_adaLN_cond__spectral_gfnet__glu_gated_bilinear__prompt_kernel_ok_159
    s_mov_b32 s97, 0
L_adaLN_cond__spectral_gfnet__glu_gated_bilinear__prompt_kernel_hhr_160:
    s_mov_b32 s28, 8192
    buffer_load_dwordx4 v[64:67], v240, s[16:19], s28 offen offset:0 sc1
    s_mov_b32 s28, 122880
    buffer_load_dwordx4 v[68:71], v240, s[16:19], s28 offen offset:0 sc1
    s_waitcnt vmcnt(0)
    v_max3_u32 v252, v64, v65, v66
    v_max3_u32 v253, v67, v68, v69
    v_max3_u32 v252, v252, v70, v71
    v_max_u32 v252, v252, v253
    v_cmp_eq_u32 vcc, -1, v252
    s_cbranch_vccz L_adaLN_cond__spectral_gfnet__glu_gated_bilinear__prompt_kernel_hhr_160_x
    s_add_u32 s97, s97, 1
    s_cmp_lt_u32 s97, s96
    s_cbranch_scc1 L_adaLN_cond__spectral_gfnet__glu_gated_bilinear__prompt_kernel_hhr_160
    s_mov_b32 s96, 0
L_adaLN_cond__spectral_gfnet__glu_gated_bilinear__prompt_kernel_hhr_160_x:
L_adaLN_cond__spectral_gfnet__glu_gated_bilinear__prompt_kernel_ok_159:
    s_mov_b32 s28, 8192
    buffer_load_dwordx4 v[88:91], v240, s[16:19], s28 offen offset:3072 sc1
    s_mov_b32 s28, 122880
    buffer_load_dwordx4 v[92:95], v240, s[16:19], s28 offen offset:3072 sc1
    v_mfma_f32_32x32x16_bf16 v[0:15], v[64:67], v[192:195], v[0:15]
    v_mfma_f32_32x32x16_bf16 v[16:31], v[64:67], v[196:199], v[16:31]
    v_mfma_f32_32x32x16_bf16 v[32:47], v[68:71], v[192:195], v[32:47]
    v_mfma_f32_32x32x16_bf16 v[48:63], v[68:71], v[196:199], v[48:63]
    s_waitcnt vmcnt(4)
    v_max3_u32 v252, v72, v73, v74
    v_max3_u32 v253, v75, v76, v77
    v_max3_u32 v252, v252, v78, v79
    v_max_u32 v252, v252, v253
    v_cmp_eq_u32 vcc, -1, v252
    s_cbranch_vccz L_adaLN_cond__spectral_gfnet__glu_gated_bilinear__prompt_kernel_ok_161
    s_mov_b32 s97, 0
L_adaLN_cond__spectral_gfnet__glu_gated_bilinear__prompt_kernel_hhr_162:
    s_mov_b32 s28, 8192
    buffer_load_dwordx4 v[72:75], v240, s[16:19], s28 offen offset:1024 sc1
    s_mov_b32 s28, 122880
    buffer_load_dwordx4 v[76:79], v240, s[16:19], s28 offen offset:1024 sc1
    s_waitcnt vmcnt(0)
    v_max3_u32 v252, v72, v73, v74
    v_max3_u32 v253, v75, v76, v77
    v_max3_u32 v252, v252, v78, v79
    v_max_u32 v252, v252, v253
    v_cmp_eq_u32 vcc, -1, v252
    s_cbranch_vccz L_adaLN_cond__spectral_gfnet__glu_gated_bilinear__prompt_kernel_hhr_162_x
    s_add_u32 s97, s97, 1
    s_cmp_lt_u32 s97, s96
    s_cbranch_scc1 L_adaLN_cond__spectral_gfnet__glu_gated_bilinear__prompt_kernel_hhr_162
    s_mov_b32 s96, 0
L_adaLN_cond__spectral_gfnet__glu_gated_bilinear__prompt_kernel_hhr_162_x:
L_adaLN_cond__spectral_gfnet__glu_gated_bilinear__prompt_kernel_ok_161:
    s_mov_b32 s28, 12288
    buffer_load_dwordx4 v[64:67], v240, s[16:19], s28 offen offset:0 sc1
    s_mov_b32 s28, 126976
    buffer_load_dwordx4 v[68:71], v240, s[16:19], s28 offen offset:0 sc1
    v_mfma_f32_32x32x16_bf16 v[0:15], v[72:75], v[200:203], v[0:15]
    v_mfma_f32_32x32x16_bf16 v[16:31], v[72:75], v[204:207], v[16:31]
    v_mfma_f32_32x32x16_bf16 v[32:47], v[76:79], v[200:203], v[32:47]
    v_mfma_f32_32x32x16_bf16 v[48:63], v[76:79], v[204:207], v[48:63]
    s_waitcnt vmcnt(4)
    v_max3_u32 v252, v80, v81, v82
    v_max3_u32 v253, v83, v84, v85
    v_max3_u32 v252, v252, v86, v87
    v_max_u32 v252, v252, v253
    v_cmp_eq_u32 vcc, -1, v252
    s_cbranch_vccz L_adaLN_cond__spectral_gfnet__glu_gated_bilinear__prompt_kernel_ok_163
    s_mov_b32 s97, 0
L_adaLN_cond__spectral_gfnet__glu_gated_bilinear__prompt_kernel_hhr_164:
    s_mov_b32 s28, 8192
    buffer_load_dwordx4 v[80:83], v240, s[16:19], s28 offen offset:2048 sc1
    s_mov_b32 s28, 122880
    buffer_load_dwordx4 v[84:87], v240, s[16:19], s28 offen offset:2048 sc1
    s_waitcnt vmcnt(0)
    v_max3_u32 v252, v80, v81, v82
    v_max3_u32 v253, v83, v84, v85
    v_max3_u32 v252, v252, v86, v87
    v_max_u32 v252, v252, v253
    v_cmp_eq_u32 vcc, -1, v252
    s_cbranch_vccz L_adaLN_cond__spectral_gfnet__glu_gated_bilinear__prompt_kernel_hhr_164_x
    s_add_u32 s97, s97, 1
    s_cmp_lt_u32 s97, s96
    s_cbranch_scc1 L_adaLN_cond__spectral_gfnet__glu_gated_bilinear__prompt_kernel_hhr_164
    s_mov_b32 s96, 0
L_adaLN_cond__spectral_gfnet__glu_gated_bilinear__prompt_kernel_hhr_164_x:
L_adaLN_cond__spectral_gfnet__glu_gated_bilinear__prompt_kernel_ok_163:
    s_mov_b32 s28, 12288
    buffer_load_dwordx4 v[72:75], v240, s[16:19], s28 offen offset:1024 sc1
    s_mov_b32 s28, 126976
    buffer_load_dwordx4 v[76:79], v240, s[16:19], s28 offen offset:1024 sc1
    v_mfma_f32_32x32x16_bf16 v[0:15], v[80:83], v[208:211], v[0:15]
    v_mfma_f32_32x32x16_bf16 v[16:31], v[80:83], v[212:215], v[16:31]
    v_mfma_f32_32x32x16_bf16 v[32:47], v[84:87], v[208:211], v[32:47]
    v_mfma_f32_32x32x16_bf16 v[48:63], v[84:87], v[212:215], v[48:63]
    s_waitcnt vmcnt(4)
    v_max3_u32 v252, v88, v89, v90
    v_max3_u32 v253, v91, v92, v93
    v_max3_u32 v252, v252, v94, v95
    v_max_u32 v252, v252, v253
    v_cmp_eq_u32 vcc, -1, v252
    s_cbranch_vccz L_adaLN_cond__spectral_gfnet__glu_gated_bilinear__prompt_kernel_ok_165
    s_mov_b32 s97, 0
L_adaLN_cond__spectral_gfnet__glu_gated_bilinear__prompt_kernel_hhr_166:
    s_mov_b32 s28, 8192
    buffer_load_dwordx4 v[88:91], v240, s[16:19], s28 offen offset:3072 sc1
    s_mov_b32 s28, 122880
    buffer_load_dwordx4 v[92:95], v240, s[16:19], s28 offen offset:3072 sc1
    s_waitcnt vmcnt(0)
    v_max3_u32 v252, v88, v89, v90
    v_max3_u32 v253, v91, v92, v93
    v_max3_u32 v252, v252, v94, v95
    v_max_u32 v252, v252, v253
    v_cmp_eq_u32 vcc, -1, v252
    s_cbranch_vccz L_adaLN_cond__spectral_gfnet__glu_gated_bilinear__prompt_kernel_hhr_166_x
    s_add_u32 s97, s97, 1
    s_cmp_lt_u32 s97, s96
    s_cbranch_scc1 L_adaLN_cond__spectral_gfnet__glu_gated_bilinear__prompt_kernel_hhr_166
    s_mov_b32 s96, 0
L_adaLN_cond__spectral_gfnet__glu_gated_bilinear__prompt_kernel_hhr_166_x:
L_adaLN_cond__spectral_gfnet__glu_gated_bilinear__prompt_kernel_ok_165:
    v_mfma_f32_32x32x16_bf16 v[0:15], v[88:91], v[216:219], v[0:15]
    v_mfma_f32_32x32x16_bf16 v[16:31], v[88:91], v[220:223], v[16:31]
    v_mfma_f32_32x32x16_bf16 v[32:47], v[92:95], v[216:219], v[32:47]
    v_mfma_f32_32x32x16_bf16 v[48:63], v[92:95], v[220:223], v[48:63]
    s_waitcnt vmcnt(2)
    v_max3_u32 v252, v64, v65, v66
    v_max3_u32 v253, v67, v68, v69
    v_max3_u32 v252, v252, v70, v71
    v_max_u32 v252, v252, v253
    v_cmp_eq_u32 vcc, -1, v252
    s_cbranch_vccz L_adaLN_cond__spectral_gfnet__glu_gated_bilinear__prompt_kernel_ok_167
    s_mov_b32 s97, 0
L_adaLN_cond__spectral_gfnet__glu_gated_bilinear__prompt_kernel_hhr_168:
    s_mov_b32 s28, 12288
    buffer_load_dwordx4 v[64:67], v240, s[16:19], s28 offen offset:0 sc1
    s_mov_b32 s28, 126976
    buffer_load_dwordx4 v[68:71], v240, s[16:19], s28 offen offset:0 sc1
    s_waitcnt vmcnt(0)
    v_max3_u32 v252, v64, v65, v66
    v_max3_u32 v253, v67, v68, v69
    v_max3_u32 v252, v252, v70, v71
    v_max_u32 v252, v252, v253
    v_cmp_eq_u32 vcc, -1, v252
    s_cbranch_vccz L_adaLN_cond__spectral_gfnet__glu_gated_bilinear__prompt_kernel_hhr_168_x
    s_add_u32 s97, s97, 1
    s_cmp_lt_u32 s97, s96
    s_cbranch_scc1 L_adaLN_cond__spectral_gfnet__glu_gated_bilinear__prompt_kernel_hhr_168
    s_mov_b32 s96, 0
L_adaLN_cond__spectral_gfnet__glu_gated_bilinear__prompt_kernel_hhr_168_x:
L_adaLN_cond__spectral_gfnet__glu_gated_bilinear__prompt_kernel_ok_167:
    v_mfma_f32_32x32x16_bf16 v[0:15], v[64:67], v[224:227], v[0:15]
    v_mfma_f32_32x32x16_bf16 v[16:31], v[64:67], v[228:231], v[16:31]
    v_mfma_f32_32x32x16_bf16 v[32:47], v[68:71], v[224:227], v[32:47]
    v_mfma_f32_32x32x16_bf16 v[48:63], v[68:71], v[228:231], v[48:63]
    s_waitcnt vmcnt(0)
    v_max3_u32 v252, v72, v73, v74
    v_max3_u32 v253, v75, v76, v77
    v_max3_u32 v252, v252, v78, v79
    v_max_u32 v252, v252, v253
    v_cmp_eq_u32 vcc, -1, v252
    s_cbranch_vccz L_adaLN_cond__spectral_gfnet__glu_gated_bilinear__prompt_kernel_ok_169
    s_mov_b32 s97, 0
L_adaLN_cond__spectral_gfnet__glu_gated_bilinear__prompt_kernel_hhr_170:
    s_mov_b32 s28, 12288
    buffer_load_dwordx4 v[72:75], v240, s[16:19], s28 offen offset:1024 sc1
    s_mov_b32 s28, 126976
    buffer_load_dwordx4 v[76:79], v240, s[16:19], s28 offen offset:1024 sc1
    s_waitcnt vmcnt(0)
    v_max3_u32 v252, v72, v73, v74
    v_max3_u32 v253, v75, v76, v77
    v_max3_u32 v252, v252, v78, v79
    v_max_u32 v252, v252, v253
    v_cmp_eq_u32 vcc, -1, v252
    s_cbranch_vccz L_adaLN_cond__spectral_gfnet__glu_gated_bilinear__prompt_kernel_hhr_170_x
    s_add_u32 s97, s97, 1
    s_cmp_lt_u32 s97, s96
    s_cbranch_scc1 L_adaLN_cond__spectral_gfnet__glu_gated_bilinear__prompt_kernel_hhr_170
    s_mov_b32 s96, 0
L_adaLN_cond__spectral_gfnet__glu_gated_bilinear__prompt_kernel_hhr_170_x:
L_adaLN_cond__spectral_gfnet__glu_gated_bilinear__prompt_kernel_ok_169:
    v_mfma_f32_32x32x16_bf16 v[0:15], v[72:75], v[232:235], v[0:15]
    v_mfma_f32_32x32x16_bf16 v[16:31], v[72:75], v[236:239], v[16:31]
    v_mfma_f32_32x32x16_bf16 v[32:47], v[76:79], v[232:235], v[32:47]
    v_mfma_f32_32x32x16_bf16 v[48:63], v[76:79], v[236:239], v[48:63]
    s_mul_i32 s25, s10, 16640
    s_mov_b32 m0, s25
    s_nop 7
    ds_write_addtid_b32 v0 offset:0
    ds_write_addtid_b32 v1 offset:8320
    ds_write_addtid_b32 v2 offset:256
    ds_write_addtid_b32 v3 offset:8576
    ds_write_addtid_b32 v4 offset:512
    ds_write_addtid_b32 v5 offset:8832
    ds_write_addtid_b32 v6 offset:768
    ds_write_addtid_b32 v7 offset:9088
    ds_write_addtid_b32 v8 offset:1024
    ds_write_addtid_b32 v9 offset:9344
    ds_write_addtid_b32 v10 offset:1280
    ds_write_addtid_b32 v11 offset:9600
    ds_write_addtid_b32 v12 offset:1536
    ds_write_addtid_b32 v13 offset:9856
    ds_write_addtid_b32 v14 offset:1792
    ds_write_addtid_b32 v15 offset:10112
    ds_write_addtid_b32 v16 offset:2048
    ds_write_addtid_b32 v17 offset:10368
    ds_write_addtid_b32 v18 offset:2304
    ds_write_addtid_b32 v19 offset:10624
    ds_write_addtid_b32 v20 offset:2560
    ds_write_addtid_b32 v21 offset:10880
    ds_write_addtid_b32 v22 offset:2816
    ds_write_addtid_b32 v23 offset:11136
    ds_write_addtid_b32 v24 offset:3072
    ds_write_addtid_b32 v25 offset:11392
    ds_write_addtid_b32 v26 offset:3328
    ds_write_addtid_b32 v27 offset:11648
    ds_write_addtid_b32 v28 offset:3584
    ds_write_addtid_b32 v29 offset:11904
    ds_write_addtid_b32 v30 offset:3840
    ds_write_addtid_b32 v31 offset:12160
    ds_write_addtid_b32 v32 offset:4096
    ds_write_addtid_b32 v33 offset:12416
    ds_write_addtid_b32 v34 offset:4352
    ds_write_addtid_b32 v35 offset:12672
    ds_write_addtid_b32 v36 offset:4608
    ds_write_addtid_b32 v37 offset:12928
    ds_write_addtid_b32 v38 offset:4864
    ds_write_addtid_b32 v39 offset:13184
    ds_write_addtid_b32 v40 offset:5120
    ds_write_addtid_b32 v41 offset:13440
    ds_write_addtid_b32 v42 offset:5376
    ds_write_addtid_b32 v43 offset:13696
    ds_write_addtid_b32 v44 offset:5632
    ds_write_addtid_b32 v45 offset:13952
    ds_write_addtid_b32 v46 offset:5888
    ds_write_addtid_b32 v47 offset:14208
    ds_write_addtid_b32 v48 offset:6144
    ds_write_addtid_b32 v49 offset:14464
    ds_write_addtid_b32 v50 offset:6400
    ds_write_addtid_b32 v51 offset:14720
    ds_write_addtid_b32 v52 offset:6656
    ds_write_addtid_b32 v53 offset:14976
    ds_write_addtid_b32 v54 offset:6912
    ds_write_addtid_b32 v55 offset:15232
    ds_write_addtid_b32 v56 offset:7168
    ds_write_addtid_b32 v57 offset:15488
    ds_write_addtid_b32 v58 offset:7424
    ds_write_addtid_b32 v59 offset:15744
    ds_write_addtid_b32 v60 offset:7680
    ds_write_addtid_b32 v61 offset:16000
    ds_write_addtid_b32 v62 offset:7936
    ds_write_addtid_b32 v63 offset:16256
    v_and_b32 v72, 15, v241
    v_lshrrev_b32 v73, 4, v241
    v_lshrrev_b32 v74, 3, v72
    v_lshlrev_b32 v74, 11, v74
    v_and_b32 v75, 7, v72
    v_lshlrev_b32 v75, 4, v75
    v_add_u32 v74, v74, v75
    v_lshrrev_b32 v75, 3, v73
    v_lshlrev_b32 v75, 9, v75
    v_add_u32 v74, v74, v75
    v_bfe_u32 v75, v73, 2, 1
    v_lshlrev_b32 v75, 7, v75
    v_add_u32 v74, v74, v75
    v_bfe_u32 v75, v73, 1, 1
    v_lshlrev_b32 v75, 8, v75
    v_add_u32 v74, v74, v75
    v_and_b32 v75, 1, v73
    v_mul_u32_u24 v75, 8320, v75
    v_add_u32 v74, v74, v75
    v_add_u32 v75, 65536, v74
    s_lshl_b32 s25, s38, 10
    s_lshl_b32 s26, s39, 7
    s_add_u32 s25, s25, s26
    v_lshlrev_b32 v76, 15, v73
    v_lshlrev_b32 v77, 3, v72
    v_add_u32 v76, v76, v77
    v_add_u32 v76, s25, v76
    v_add_u32 v77, 1048576, v76
    s_waitcnt vmcnt(0)
    v_xor_b32 v252, s3, v249
    v_xor_b32 v253, s3, v251
    v_or_b32 v252, v252, v253
    v_cmp_ne_u32 vcc, 0, v252
    s_cbranch_vccz L_adaLN_cond__spectral_gfnet__glu_gated_bilinear__prompt_kernel_ok_171
    s_mov_b32 s97, 0
L_adaLN_cond__spectral_gfnet__glu_gated_bilinear__prompt_kernel_gbr_172:
    global_load_dwordx4 v[248:251], v255, s[6:7] sc1
    s_waitcnt vmcnt(0)
    v_xor_b32 v252, s3, v249
    v_xor_b32 v253, s3, v251
    v_or_b32 v252, v252, v253
    v_cmp_ne_u32 vcc, 0, v252
    s_cbranch_vccz L_adaLN_cond__spectral_gfnet__glu_gated_bilinear__prompt_kernel_gbr_172_x
    s_add_u32 s97, s97, 1
    s_cmp_lt_u32 s97, s96
    s_cbranch_scc1 L_adaLN_cond__spectral_gfnet__glu_gated_bilinear__prompt_kernel_gbr_172
    s_mov_b32 s96, 0
L_adaLN_cond__spectral_gfnet__glu_gated_bilinear__prompt_kernel_gbr_172_x:
L_adaLN_cond__spectral_gfnet__glu_gated_bilinear__prompt_kernel_ok_171:
    v_and_b32 v251, 0xffff0000, v250
    v_lshlrev_b32 v250, 16, v250
    v_and_b32 v249, 0xffff0000, v248
    v_lshlrev_b32 v248, 16, v248
    s_waitcnt lgkmcnt(0)
    s_barrier
    ds_read_b128 v[80:83], v74 offset:0
    ds_read_b128 v[84:87], v74 offset:16640
    ds_read_b128 v[88:91], v74 offset:33280
    ds_read_b128 v[92:95], v74 offset:49920
    ds_read_b128 v[96:99], v75 offset:1024
    ds_read_b128 v[100:103], v75 offset:17664
    ds_read_b128 v[104:107], v75 offset:34304
    ds_read_b128 v[108:111], v75 offset:50944
    ds_read_b128 v[112:115], v74 offset:4096
    ds_read_b128 v[116:119], v74 offset:20736
    ds_read_b128 v[120:123], v74 offset:37376
    ds_read_b128 v[124:127], v74 offset:54016
    ds_read_b128 v[128:131], v75 offset:5120
    ds_read_b128 v[132:135], v75 offset:21760
    ds_read_b128 v[136:139], v75 offset:38400
    ds_read_b128 v[140:143], v75 offset:55040
    s_waitcnt lgkmcnt(8)
    v_pk_add_f32 v[80:81], v[80:81], v[84:85]
    v_pk_add_f32 v[82:83], v[82:83], v[86:87]
    v_pk_add_f32 v[88:89], v[88:89], v[92:93]
    v_pk_add_f32 v[90:91], v[90:91], v[94:95]
    v_pk_add_f32 v[96:97], v[96:97], v[100:101]
    v_pk_add_f32 v[98:99], v[98:99], v[102:103]
    v_pk_add_f32 v[104:105], v[104:105], v[108:109]
    v_pk_add_f32 v[106:107], v[106:107], v[110:111]
    v_pk_add_f32 v[80:81], v[80:81], v[88:89]
    v_pk_add_f32 v[82:83], v[82:83], v[90:91]
    v_pk_add_f32 v[96:97], v[96:97], v[104:105]
    v_pk_add_f32 v[98:99], v[98:99], v[106:107]
    v_pk_add_f32 v[80:81], v[80:81], v[96:97]
    v_pk_add_f32 v[82:83], v[82:83], v[98:99]
    v_lshlrev_b32 v64, 16, v244
    v_and_b32 v65, 0xffff0000, v244
    v_lshlrev_b32 v66, 16, v245
    v_and_b32 v67, 0xffff0000, v245
    v_pk_fma_f32 v[64:65], v[80:81], v[248:249], v[64:65]
    v_pk_fma_f32 v[66:67], v[82:83], v[250:251], v[66:67]
    v_cvt_pk_bf16_f32 v68, v64, v65
    v_cvt_pk_bf16_f32 v69, v66, v67
    global_store_dwordx2 v76, v[68:69], s[8:9] sc1
    s_waitcnt lgkmcnt(0)
    v_pk_add_f32 v[112:113], v[112:113], v[116:117]
    v_pk_add_f32 v[114:115], v[114:115], v[118:119]
    v_pk_add_f32 v[120:121], v[120:121], v[124:125]
    v_pk_add_f32 v[122:123], v[122:123], v[126:127]
    v_pk_add_f32 v[128:129], v[128:129], v[132:133]
    v_pk_add_f32 v[130:131], v[130:131], v[134:135]
    v_pk_add_f32 v[136:137], v[136:137], v[140:141]
    v_pk_add_f32 v[138:139], v[138:139], v[142:143]
    v_pk_add_f32 v[112:113], v[112:113], v[120:121]
    v_pk_add_f32 v[114:115], v[114:115], v[122:123]
    v_pk_add_f32 v[128:129], v[128:129], v[136:137]
    v_pk_add_f32 v[130:131], v[130:131], v[138:139]
    v_pk_add_f32 v[112:113], v[112:113], v[128:129]
    v_pk_add_f32 v[114:115], v[114:115], v[130:131]
    v_lshlrev_b32 v64, 16, v246
    v_and_b32 v65, 0xffff0000, v246
    v_lshlrev_b32 v66, 16, v247
    v_and_b32 v67, 0xffff0000, v247
    v_pk_fma_f32 v[64:65], v[112:113], v[248:249], v[64:65]
    v_pk_fma_f32 v[66:67], v[114:115], v[250:251], v[66:67]
    v_cvt_pk_bf16_f32 v70, v64, v65
    v_cvt_pk_bf16_f32 v71, v66, v67
    global_store_dwordx2 v77, v[70:71], s[8:9] sc1
L_fin:
    s_cmp_lg_u32 s2, 0
    s_cbranch_scc1 L_adaLN_cond__spectral_gfnet__glu_gated_bilinear__prompt_kernel_tw_173
    s_cmp_lg_u32 s10, 0
    s_cbranch_scc1 L_adaLN_cond__spectral_gfnet__glu_gated_bilinear__prompt_kernel_tw_173
    v_mov_b32 v64, 16384
    v_mov_b32 v65, s3
    s_mov_b64 exec, 1
    global_store_dword v64, v65, s[6:7] sc1
    s_mov_b64 exec, -1
L_adaLN_cond__spectral_gfnet__glu_gated_bilinear__prompt_kernel_tw_173:
L_end:
    s_endpgm
L_adaLN_cond__spectral_gfnet__glu_gated_bilinear__prompt_kernel_h2w_98:
    s_mov_b32 s97, 0
L_adaLN_cond__spectral_gfnet__glu_gated_bilinear__prompt_kernel_h2r_174:
    s_add_u32 m0, s21, 8192
    s_mov_b32 s27, 8192
    buffer_load_dwordx4 v6, s[16:19], s27 offen offset:0 sc1 lds
    buffer_load_dwordx4 v6, s[16:19], s27 offen offset:1024 sc1 lds
    buffer_load_dwordx4 v6, s[16:19], s27 offen offset:2048 sc1 lds
    buffer_load_dwordx4 v6, s[16:19], s27 offen offset:3072 sc1 lds
    s_waitcnt vmcnt(0)
    ds_read_b128 v[8:11], v7 offset:8192
    ds_read_b128 v[12:15], v7 offset:9216
    ds_read_b128 v[16:19], v7 offset:10240
    ds_read_b128 v[20:23], v7 offset:11264
    s_waitcnt lgkmcnt(0)
    v_max3_u32 v24, v8, v9, v10
    v_max3_u32 v25, v11, v12, v13
    v_max3_u32 v26, v14, v15, v16
    v_max3_u32 v27, v17, v18, v19
    v_max3_u32 v24, v24, v20, v21
    v_max3_u32 v25, v25, v22, v23
    v_max3_u32 v24, v24, v25, v26
    v_max_u32 v24, v24, v27
    v_cmp_eq_u32 vcc, -1, v24
    s_cbranch_vccz L_adaLN_cond__spectral_gfnet__glu_gated_bilinear__prompt_kernel_h2r_174_x
    s_add_u32 s97, s97, 1
    s_cmp_lt_u32 s97, s96
    s_cbranch_scc1 L_adaLN_cond__spectral_gfnet__glu_gated_bilinear__prompt_kernel_h2r_174
    s_mov_b32 s96, 0
L_adaLN_cond__spectral_gfnet__glu_gated_bilinear__prompt_kernel_h2r_174_x:
    s_branch L_adaLN_cond__spectral_gfnet__glu_gated_bilinear__prompt_kernel_ok_99
L_adaLN_cond__spectral_gfnet__glu_gated_bilinear__prompt_kernel_h2w_100:
    s_mov_b32 s97, 0
L_adaLN_cond__spectral_gfnet__glu_gated_bilinear__prompt_kernel_h2r_175:
    s_add_u32 m0, s21, 16384
    s_mov_b32 s27, 16384
    buffer_load_dwordx4 v6, s[16:19], s27 offen offset:0 sc1 lds
    buffer_load_dwordx4 v6, s[16:19], s27 offen offset:1024 sc1 lds
    buffer_load_dwordx4 v6, s[16:19], s27 offen offset:2048 sc1 lds
    buffer_load_dwordx4 v6, s[16:19], s27 offen offset:3072 sc1 lds
    s_waitcnt vmcnt(0)
    ds_read_b128 v[8:11], v7 offset:16384
    ds_read_b128 v[12:15], v7 offset:17408
    ds_read_b128 v[16:19], v7 offset:18432
    ds_read_b128 v[20:23], v7 offset:19456
    s_waitcnt lgkmcnt(0)
    v_max3_u32 v24, v8, v9, v10
    v_max3_u32 v25, v11, v12, v13
    v_max3_u32 v26, v14, v15, v16
    v_max3_u32 v27, v17, v18, v19
    v_max3_u32 v24, v24, v20, v21
    v_max3_u32 v25, v25, v22, v23
    v_max3_u32 v24, v24, v25, v26
    v_max_u32 v24, v24, v27
    v_cmp_eq_u32 vcc, -1, v24
    s_cbranch_vccz L_adaLN_cond__spectral_gfnet__glu_gated_bilinear__prompt_kernel_h2r_175_x
    s_add_u32 s97, s97, 1
    s_cmp_lt_u32 s97, s96
    s_cbranch_scc1 L_adaLN_cond__spectral_gfnet__glu_gated_bilinear__prompt_kernel_h2r_175
    s_mov_b32 s96, 0
L_adaLN_cond__spectral_gfnet__glu_gated_bilinear__prompt_kernel_h2r_175_x:
    s_branch L_adaLN_cond__spectral_gfnet__glu_gated_bilinear__prompt_kernel_ok_101
L_adaLN_cond__spectral_gfnet__glu_gated_bilinear__prompt_kernel_h2w_102:
    s_mov_b32 s97, 0
L_adaLN_cond__spectral_gfnet__glu_gated_bilinear__prompt_kernel_h2r_176:
    s_add_u32 m0, s21, 24576
    s_mov_b32 s27, 24576
    buffer_load_dwordx4 v6, s[16:19], s27 offen offset:0 sc1 lds
    buffer_load_dwordx4 v6, s[16:19], s27 offen offset:1024 sc1 lds
    buffer_load_dwordx4 v6, s[16:19], s27 offen offset:2048 sc1 lds
    buffer_load_dwordx4 v6, s[16:19], s27 offen offset:3072 sc1 lds
    s_waitcnt vmcnt(0)
    ds_read_b128 v[8:11], v7 offset:24576
    ds_read_b128 v[12:15], v7 offset:25600
    ds_read_b128 v[16:19], v7 offset:26624
    ds_read_b128 v[20:23], v7 offset:27648
    s_waitcnt lgkmcnt(0)
    v_max3_u32 v24, v8, v9, v10
    v_max3_u32 v25, v11, v12, v13
    v_max3_u32 v26, v14, v15, v16
    v_max3_u32 v27, v17, v18, v19
    v_max3_u32 v24, v24, v20, v21
    v_max3_u32 v25, v25, v22, v23
    v_max3_u32 v24, v24, v25, v26
    v_max_u32 v24, v24, v27
    v_cmp_eq_u32 vcc, -1, v24
    s_cbranch_vccz L_adaLN_cond__spectral_gfnet__glu_gated_bilinear__prompt_kernel_h2r_176_x
    s_add_u32 s97, s97, 1
    s_cmp_lt_u32 s97, s96
    s_cbranch_scc1 L_adaLN_cond__spectral_gfnet__glu_gated_bilinear__prompt_kernel_h2r_176
    s_mov_b32 s96, 0
L_adaLN_cond__spectral_gfnet__glu_gated_bilinear__prompt_kernel_h2r_176_x:
    s_branch L_adaLN_cond__spectral_gfnet__glu_gated_bilinear__prompt_kernel_ok_103

.section .rodata,"a"
.p2align 6
.amdhsa_kernel adaLN_cond__spectral_gfnet__glu_gated_bilinear__prompt_kernel
  .amdhsa_next_free_vgpr 256
  .amdhsa_next_free_sgpr 102
  .amdhsa_accum_offset 256
  .amdhsa_group_segment_fixed_size 0
  .amdhsa_kernarg_size 96
  .amdhsa_user_sgpr_count 2
  .amdhsa_user_sgpr_kernarg_segment_ptr 1
  .amdhsa_system_sgpr_workgroup_id_x 1
  .amdhsa_float_denorm_mode_32 3
.end_amdhsa_kernel
```
